```python
import torch

def _softmax(x, axis=-1):
    return torch.softmax(x, dim=axis)
def _gelu(x):
    return torch.nn.functional.gelu(x, approximate="tanh")
def _silu(x):
    return torch.nn.functional.silu(x)
def _sigmoid(x):
    return torch.sigmoid(x)
def _layernorm(x, axis=-1, eps=1e-5):
    m = x.mean(dim=axis, keepdim=True)
    v = x.var(dim=axis, keepdim=True, unbiased=False)
    return (x - m) / torch.sqrt(v + eps)
def _scatter_add(tgt, idx, src, axis=0):
    return tgt.clone().index_add_(axis, idx, src)
def _segment_sum(src, seg, n):
    out = torch.zeros((n,) + src.shape[1:], dtype=src.dtype)
    return out.index_add_(0, seg, src)
def _pad(x, pw):
    flat = tuple(v for pair in reversed(pw) for v in pair)
    return torch.nn.functional.pad(x, flat)

kernel_name = 'standalone__mha_block_cached__near_ridge'

def setup_inputs():

    _w = (lambda a: (lambda t: t.to(torch.bfloat16) if t.is_floating_point() else t)(torch.as_tensor(a)))
    B, Sq, D = 8, 192, 576
    H, Sk, Dh = 32, 1024, 128
    return {
        "x": _w((lambda *s: torch.randn(*s, dtype=torch.bfloat16) * 0.8)(B, Sq, D)),
        "k_cache": _w((lambda *s: torch.randn(*s, dtype=torch.bfloat16) * 0.8)(B, H, Sk, Dh)),
        "v_cache": _w((lambda *s: torch.randn(*s, dtype=torch.bfloat16) * 0.05)(B, H, Sk, Dh)),
        "wq": _w((lambda *s: torch.randn(*s, dtype=torch.bfloat16) * 0.8)(D, H * Dh) * (D ** -0.5)),
        "wo": _w((lambda *s: torch.randn(*s, dtype=torch.bfloat16) * 0.05)(H * Dh, D) * ((H * Dh) ** -0.5)),
    }

def reference(x, k_cache, v_cache, wq, wo):
    B, Sq, D = x.shape
    H, Dh = 32, 128
    q = (lambda x, *d: x.permute(*d))((x @ wq).reshape(B, Sq, H, Dh), 0, 2, 1, 3)
    scores = torch.einsum("bhqd,bhkd->bhqk", q, k_cache) * (Dh ** -0.5)
    p = _softmax(scores, axis=-1)
    o = torch.einsum("bhqk,bhkd->bhqd", p, v_cache)
    return (lambda x, *d: x.permute(*d))(o, 0, 2, 1, 3).reshape(B, Sq, H * Dh) @ wo
```

```asm
; @launch grid=(256,1,1) block=(256,1,1) lds=163840
.amdgcn_target "amdgcn-amd-amdhsa--gfx950"
.text
.globl standalone__mha_block_cached__near_ridge_kernel
.p2align 8
.type standalone__mha_block_cached__near_ridge_kernel,@function
standalone__mha_block_cached__near_ridge_kernel:
    s_cmp_ge_u32 s2, 256
    s_cbranch_scc1 L_end
    s_load_dwordx16 s[36:51], s[0:1], 0
    v_lshrrev_b32 v1, 6, v0
    v_and_b32 v2, 63, v0
    v_readfirstlane_b32 s24, v1
    s_and_b32 s53, s2, 1
    s_lshl_b32 s53, s53, 2
    s_bfe_u32 s54, s2, 0x20003
    s_add_u32 s25, s53, s54
    s_bfe_u32 s53, s2, 0x20001
    s_lshl_b32 s53, s53, 3
    s_lshr_b32 s55, s2, 5
    s_add_u32 s26, s53, s55
    s_lshl_b32 s54, s54, 1
    s_add_u32 s55, s55, s54
    s_cmp_ge_u32 s55, 7
    s_cselect_b32 s53, 7, 0
    s_sub_u32 s55, s55, s53
    s_cmp_ge_u32 s55, 7
    s_cselect_b32 s53, 7, 0
    s_sub_u32 s55, s55, s53
    v_and_b32 v3, 15, v2
    v_lshrrev_b32 v4, 4, v2
    v_lshlrev_b32 v5, 4, v3
    v_lshrrev_b32 v6, 3, v2
    v_and_b32 v7, 6, v6
    v_and_b32 v8, 7, v2
    v_xor_b32 v7, v7, v8
    v_lshlrev_b32 v7, 4, v7
    v_mul_u32_u24 v6, 1152, v6
    v_add_u32 v160, v6, v7
    v_lshrrev_b32 v6, 1, v4
    v_and_b32 v7, 1, v4
    v_lshl_add_u32 v161, v6, 17, v5
    v_lshl_add_u32 v161, v7, 15, v161
    s_lshr_b32 s53, s24, 1
    s_lshl_b32 s53, s53, 3
    s_and_b32 s54, s24, 1
    s_lshl_b32 s54, s54, 1
    s_add_u32 s53, s53, s54
    s_lshl_b32 s53, s53, 13
    v_add_u32 v161, s53, v161
    s_mul_i32 s35, s24, 6144
    s_mul_i32 s34, s24, 2112
    s_add_u32 s52, s34, 24576
    s_mov_b32 s60, 0
    s_mov_b32 s61, 8192
    s_mov_b32 s62, 262144
    s_mov_b32 s63, 270336
    s_mul_i32 s53, s25, 192
    s_mul_i32 s54, s24, 48
    s_add_u32 s53, s53, s54
    s_mul_i32 s53, s53, 1152
    s_lshl_b32 s54, s26, 8
    s_lshl_b32 s27, s25, 5
    s_add_u32 s27, s27, s26
    s_lshl_b32 s27, s27, 18
    s_mov_b32 s96, 0
    s_mov_b32 s97, 9216
    s_mov_b32 s98, 18432
    s_mov_b32 s99, 27648
    s_mov_b32 s100, 36864
    s_mov_b32 s101, 46080
    s_waitcnt lgkmcnt(0)
    s_add_u32 s12, s36, s53
    s_addc_u32 s13, s37, 0
    s_and_b32 s13, s13, 0xffff
    s_mov_b32 s14, 55296
    s_mov_b32 s15, 0x20000
    s_add_u32 s16, s42, s54
    s_addc_u32 s17, s43, 0
    s_and_b32 s17, s17, 0xffff
    s_mov_b32 s18, 4710656
    s_mov_b32 s19, 0x20000
    v_mov_b32 v162, v160
    v_mov_b32 v163, v161
    v_add_u32 v160, 128, v160
    v_add_u32 v161, 0x80000, v161
    s_add_u32 m0, s35, 33792
    s_nop 0
    buffer_load_dwordx4 v162, s[12:15], s96 offen lds
    s_add_u32 m0, s52, 33792
    s_nop 0
    buffer_load_dwordx4 v163, s[16:19], s60 offen lds
    s_add_u32 m0, s35, 34816
    s_nop 0
    buffer_load_dwordx4 v162, s[12:15], s97 offen lds
    s_add_u32 m0, s52, 34848
    s_nop 0
    buffer_load_dwordx4 v163, s[16:19], s61 offen lds
    s_add_u32 m0, s35, 35840
    s_nop 0
    buffer_load_dwordx4 v162, s[12:15], s98 offen lds
    s_add_u32 m0, s52, 42240
    s_nop 0
    buffer_load_dwordx4 v163, s[16:19], s62 offen lds
    s_add_u32 m0, s35, 36864
    s_nop 0
    buffer_load_dwordx4 v162, s[12:15], s99 offen lds
    s_add_u32 m0, s52, 43296
    s_nop 0
    buffer_load_dwordx4 v163, s[16:19], s63 offen lds
    s_add_u32 m0, s35, 37888
    s_nop 0
    buffer_load_dwordx4 v162, s[12:15], s100 offen lds
    s_add_u32 m0, s35, 38912
    s_nop 0
    buffer_load_dwordx4 v162, s[12:15], s101 offen lds
    s_add_u32 s4, s38, s27
    s_addc_u32 s5, s39, 0
    s_and_b32 s5, s5, 0xffff
    s_mov_b32 s6, 262144
    s_mov_b32 s7, 0x20000
    s_add_u32 s8, s40, s27
    s_addc_u32 s9, s41, 0
    s_and_b32 s9, s9, 0xffff
    s_mov_b32 s10, 262144
    s_mov_b32 s11, 0x20000
    buffer_load_dword v1, off, s[4:7], 0 nt
    buffer_load_dword v1, off, s[8:11], 0 nt
    s_cmp_lg_u32 s24, 3
    s_cbranch_scc1 L_nocpf
    s_getpc_b64 s[30:31]
L_pc:
    s_sub_u32 s30, s30, L_pc-standalone__mha_block_cached__near_ridge_kernel
    s_subb_u32 s31, s31, 0
    s_mov_b32 s20, s30
    s_and_b32 s21, s31, 0xffff
    s_mov_b32 s22, L_code_end-standalone__mha_block_cached__near_ridge_kernel
    s_mov_b32 s23, 0x20000
    s_lshr_b32 s53, s2, 3
    s_mul_i32 s53, s53, 2048
    v_lshlrev_b32 v8, 7, v2
    s_mov_b64 exec, 0xffff
    buffer_load_dword v9, v8, s[20:23], s53 offen
    s_mov_b64 exec, -1
L_nocpf:
    s_or_b32 s53, s2, s24
    s_cmp_lg_u32 s53, 0
    s_cbranch_scc1 L_notok
    s_memrealtime s[30:31]
    s_mov_b32 s20, s48
    s_and_b32 s21, s49, 0xffff
    s_mov_b32 s22, 256
    s_mov_b32 s23, 0x20000
    v_mov_b32 v8, 0
    s_waitcnt lgkmcnt(0)
    s_or_b32 s30, s30, 1
    v_mov_b32 v10, s30
    v_mov_b32 v11, s31
    s_mov_b64 exec, 1
    buffer_store_dwordx2 v[10:11], v8, s[20:23], 0 offen sc1
    s_mov_b64 exec, -1
L_notok:
    v_lshl_add_u32 v228, v4, 11, v5
    s_lshl_b32 s53, s24, 9
    s_mov_b32 s28, s34
    v_add_u32 v228, s53, v228
    v_add_u32 v229, 0x2000, v228
    s_mov_b32 s27, 0
    v_lshlrev_b32 v238, 4, v2
    v_add_u32 v238, s28, v238
    v_add_u32 v239, 67584, v238
    v_and_b32 v6, 7, v2
    v_mul_u32_u24 v6, 1056, v6
    v_bfe_u32 v7, v2, 3, 1
    v_lshl_add_u32 v6, v7, 8, v6
    v_lshl_add_u32 v226, v4, 4, v6
    v_bfe_u32 v6, v2, 2, 3
    v_mul_u32_u24 v6, 1056, v6
    v_and_b32 v7, 3, v2
    v_lshl_add_u32 v6, v7, 3, v6
    v_lshrrev_b32 v7, 5, v2
    v_lshl_add_u32 v227, v7, 8, v6
    v_add_u32 v227, 8448, v227
    v_lshl_add_u32 v6, v7, 9, v6
    v_add_u32 v170, 58368, v6
    v_add_u32 v171, 99840, v6
    v_add_u32 v172, 141312, v6
    v_and_b32 v6, 6, v3
    v_xor_b32 v6, v6, v4
    v_lshlrev_b32 v6, 4, v6
    v_lshl_add_u32 v6, v3, 7, v6
    v_add_u32 v6, s35, v6
    v_xor_b32 v7, 64, v6
    v_add_u32 v164, 33792, v6
    v_add_u32 v165, 33792, v7
    v_add_u32 v166, 75264, v6
    v_add_u32 v167, 75264, v7
    v_add_u32 v168, 116736, v6
    v_add_u32 v169, 116736, v7
    v_mov_b32 v224, v226
    v_mov_b32 v225, v227
    s_mov_b32 s32, 0x44800000
    v_and_b32 v6, 1, v4
    v_lshl_add_u32 v6, v6, 9, v5
    v_lshrrev_b32 v7, 5, v2
    v_lshl_add_u32 v230, v7, 10, v6
    v_add_u32 v231, 0x1000, v230
    s_mul_i32 s53, s25, 1572864
    s_lshl_b32 s54, s26, 13
    s_add_u32 s53, s53, s54
    s_add_u32 s20, s50, s53
    s_addc_u32 s21, s51, 0
    s_and_b32 s21, s21, 0xffff
    s_mov_b32 s22, 1318912
    s_mov_b32 s23, 0x20000
    s_mul_i32 s53, s24, 48
    s_add_u32 s53, s53, 0
    s_lshr_b32 s54, s53, 5
    s_lshl_b32 s54, s54, 18
    s_and_b32 s53, s53, 31
    s_lshl_b32 s53, s53, 4
    s_add_u32 s56, s53, s54
    s_mul_i32 s53, s24, 48
    s_add_u32 s53, s53, 16
    s_lshr_b32 s54, s53, 5
    s_lshl_b32 s54, s54, 18
    s_and_b32 s53, s53, 31
    s_lshl_b32 s53, s53, 4
    s_add_u32 s57, s53, s54
    s_mul_i32 s53, s24, 48
    s_add_u32 s53, s53, 32
    s_lshr_b32 s54, s53, 5
    s_lshl_b32 s54, s54, 18
    s_and_b32 s53, s53, 31
    s_lshl_b32 s53, s53, 4
    s_add_u32 s58, s53, s54
    v_lshlrev_b32 v246, 4, v2
    v_lshrrev_b32 v6, 3, v2
    v_and_b32 v7, 2, v6
    v_lshlrev_b32 v7, 1, v7
    v_and_b32 v8, 7, v2
    v_xor_b32 v7, v7, v8
    v_lshlrev_b32 v7, 4, v7
    v_mul_u32_u24 v6, 1152, v6
    v_add_u32 v247, v6, v7
    v_add_u32 v248, 9216, v247
    v_add_u32 v249, 18432, v247
    v_add_u32 v250, 27648, v247
    v_lshrrev_b32 v6, 5, v2
    v_bfe_u32 v7, v2, 2, 2
    v_lshl_add_u32 v6, v6, 2, v7
    v_lshlrev_b32 v6, 7, v6
    v_bfe_u32 v7, v2, 3, 1
    v_lshl_add_u32 v6, v7, 6, v6
    v_bfe_u32 v7, v2, 4, 1
    v_lshl_add_u32 v6, v7, 5, v6
    v_and_b32 v7, 3, v2
    v_lshl_add_u32 v6, v7, 3, v6
    s_lshl_b32 s53, s24, 12
    v_add_u32 v251, s53, v6
    v_xor_b32 v252, 64, v251
    v_add_u32 v242, 65536, v251
    v_add_u32 v243, 65536, v252
    v_add_u32 v244, 131072, v251
    v_add_u32 v245, 131072, v252
    s_and_b32 s53, s2, 7
    s_lshr_b32 s54, s2, 3
    s_cmp_lt_u32 s54, 27
    s_cselect_b32 s77, 1, 0
    s_mul_i32 s73, s54, 43
    s_lshr_b32 s73, s73, 8
    s_mul_i32 s72, s73, 6
    s_sub_u32 s72, s54, s72
    s_and_b32 s74, s53, 1
    s_mul_i32 s75, s74, 5
    s_add_u32 s75, s75, s73
    s_mul_i32 s74, s74, 3
    s_add_u32 s74, s74, s72
    s_cmp_ge_u32 s54, 24
    s_cselect_b32 s73, 4, s75
    s_cselect_b32 s72, s74, s72
    s_lshr_b32 s53, s53, 1
    s_mul_i32 s53, s53, 6
    s_add_u32 s72, s72, s53
    s_min_u32 s72, s72, 23
    s_min_u32 s73, s73, 8
    s_mul_i32 s53, s24, 1179648
    s_lshl_b32 s54, s73, 7
    s_add_u32 s53, s53, s54
    s_add_u32 s64, s44, s53
    s_addc_u32 s65, s45, 0
    s_and_b32 s65, s65, 0xffff
    s_mov_b32 s66, 1178624
    s_mov_b32 s67, 0x20000
    s_cmp_eq_u32 s77, 0
    s_cselect_b32 s66, 0, s66
    s_lshl_b32 s53, s72, 19
    s_lshl_b32 s54, s24, 16
    s_add_u32 s53, s53, s54
    s_add_u32 s68, s50, s53
    s_addc_u32 s69, s51, 0
    s_and_b32 s69, s69, 0xffff
    s_mov_b32 s70, 327680
    s_mov_b32 s71, 0x20000
    s_lshl_b32 s76, s24, 12
    s_mul_i32 s53, s73, 0
    s_mul_i32 s54, s72, 5
    s_add_u32 s53, s53, s54
    s_and_b32 s53, s53, 31
    s_mul_i32 s74, s53, 36864
    s_lshl_b32 s75, s53, 11
    s_mul_i32 s53, s72, 43
    s_lshr_b32 s53, s53, 7
    s_mul_i32 s54, s53, 3
    s_sub_u32 s54, s72, s54
    s_lshl_b32 s78, 0x33333333, s54
    s_lshl_b32 s53, s53, 10
    s_lshl_b32 s54, s24, 8
    s_add_u32 s53, s53, s54
    v_and_b32 v6, 31, v2
    v_lshlrev_b32 v6, 3, v6
    v_add_u32 v253, s53, v6
    v_mov_b32 v162, v160
    v_mov_b32 v163, v161
    v_add_u32 v160, 128, v160
    v_add_u32 v161, 0x80000, v161
    s_add_u32 m0, s35, 75264
    s_nop 0
    buffer_load_dwordx4 v162, s[12:15], s96 offen lds
    s_add_u32 m0, s52, 75264
    s_nop 0
    buffer_load_dwordx4 v163, s[16:19], s60 offen lds
    s_add_u32 m0, s35, 76288
    s_nop 0
    buffer_load_dwordx4 v162, s[12:15], s97 offen lds
    s_add_u32 m0, s52, 76320
    s_nop 0
    buffer_load_dwordx4 v163, s[16:19], s61 offen lds
    s_add_u32 m0, s35, 77312
    s_nop 0
    buffer_load_dwordx4 v162, s[12:15], s98 offen lds
    s_add_u32 m0, s52, 83712
    s_nop 0
    buffer_load_dwordx4 v163, s[16:19], s62 offen lds
    s_add_u32 m0, s35, 78336
    s_nop 0
    buffer_load_dwordx4 v162, s[12:15], s99 offen lds
    s_add_u32 m0, s52, 84768
    s_nop 0
    buffer_load_dwordx4 v163, s[16:19], s63 offen lds
    s_add_u32 m0, s35, 79360
    s_nop 0
    buffer_load_dwordx4 v162, s[12:15], s100 offen lds
    s_add_u32 m0, s35, 80384
    s_nop 0
    buffer_load_dwordx4 v162, s[12:15], s101 offen lds
    s_waitcnt vmcnt(10)
    s_barrier
    ds_read_b128 a[32:35], v164 offset:0
    ds_read_b128 a[36:39], v164 offset:2048
    ds_read_b128 a[40:43], v164 offset:4096
    ds_read_b64_tr_b16 a[64:65], v170 offset:0
    ds_read_b64_tr_b16 a[66:67], v170 offset:256
    ds_read_b64_tr_b16 a[68:69], v170 offset:32
    ds_read_b64_tr_b16 a[70:71], v170 offset:288
    ds_read_b64_tr_b16 a[72:73], v170 offset:64
    ds_read_b64_tr_b16 a[74:75], v170 offset:320
    ds_read_b64_tr_b16 a[76:77], v170 offset:96
    ds_read_b64_tr_b16 a[78:79], v170 offset:352
    ds_read_b64_tr_b16 a[80:81], v170 offset:128
    ds_read_b64_tr_b16 a[82:83], v170 offset:384
    ds_read_b64_tr_b16 a[84:85], v170 offset:160
    ds_read_b64_tr_b16 a[86:87], v170 offset:416
    ds_read_b64_tr_b16 a[88:89], v170 offset:192
    ds_read_b64_tr_b16 a[90:91], v170 offset:448
    ds_read_b64_tr_b16 a[92:93], v170 offset:224
    ds_read_b64_tr_b16 a[94:95], v170 offset:480
    s_waitcnt lgkmcnt(8)
    v_mfma_f32_16x16x32_bf16 v[16:19], a[64:67], a[32:35], 0
    s_lshl_b32 s53, s55, 7
    ds_read_b128 a[44:47], v165 offset:0
    s_lshl_b32 s54, s55, 19
    s_add_u32 s55, s55, 1
    s_cmp_eq_u32 s55, 7
    s_cselect_b32 s55, 0, s55
    s_add_u32 m0, s35, 116736
    v_add_u32 v162, s53, v160
    v_add_u32 v163, s54, v161
    v_mfma_f32_16x16x32_bf16 v[48:51], a[64:67], a[36:39], 0
    buffer_load_dwordx4 v162, s[12:15], s96 offen lds
    ds_read_b128 a[48:51], v165 offset:2048
    v_mfma_f32_16x16x32_bf16 v[80:83], a[64:67], a[40:43], 0
    s_add_u32 m0, s52, 116736
    ds_read_b128 a[52:55], v165 offset:4096
    v_mfma_f32_16x16x32_bf16 v[20:23], a[68:71], a[32:35], 0
    buffer_load_dwordx4 v163, s[16:19], s60 offen lds
    ds_read_b64_tr_b16 a[96:97], v170 offset:8448
    v_mfma_f32_16x16x32_bf16 v[52:55], a[68:71], a[36:39], 0
    ds_read_b64_tr_b16 a[98:99], v170 offset:8704
    v_mfma_f32_16x16x32_bf16 v[84:87], a[68:71], a[40:43], 0
    s_add_u32 m0, s35, 117760
    ds_read_b64_tr_b16 a[100:101], v170 offset:8480
    v_mfma_f32_16x16x32_bf16 v[24:27], a[72:75], a[32:35], 0
    buffer_load_dwordx4 v162, s[12:15], s97 offen lds
    ds_read_b64_tr_b16 a[102:103], v170 offset:8736
    v_mfma_f32_16x16x32_bf16 v[56:59], a[72:75], a[36:39], 0
    s_add_u32 m0, s52, 117792
    v_mfma_f32_16x16x32_bf16 v[88:91], a[72:75], a[40:43], 0
    buffer_load_dwordx4 v163, s[16:19], s61 offen lds
    ds_read_b64_tr_b16 a[104:105], v170 offset:8512
    v_mfma_f32_16x16x32_bf16 v[28:31], a[76:79], a[32:35], 0
    s_add_u32 m0, s35, 118784
    ds_read_b64_tr_b16 a[106:107], v170 offset:8768
    v_mfma_f32_16x16x32_bf16 v[60:63], a[76:79], a[36:39], 0
    buffer_load_dwordx4 v162, s[12:15], s98 offen lds
    ds_read_b64_tr_b16 a[108:109], v170 offset:8544
    v_mfma_f32_16x16x32_bf16 v[92:95], a[76:79], a[40:43], 0
    s_waitcnt lgkmcnt(10)
    ds_read_b64_tr_b16 a[110:111], v170 offset:8800
    v_mfma_f32_16x16x32_bf16 v[32:35], a[80:83], a[32:35], 0
    s_add_u32 m0, s52, 125184
    ds_read_b64_tr_b16 a[112:113], v170 offset:8576
    v_mfma_f32_16x16x32_bf16 v[64:67], a[80:83], a[36:39], 0
    buffer_load_dwordx4 v163, s[16:19], s62 offen lds
    ds_read_b64_tr_b16 a[114:115], v170 offset:8832
    v_mfma_f32_16x16x32_bf16 v[96:99], a[80:83], a[40:43], 0
    s_add_u32 m0, s35, 119808
    v_mfma_f32_16x16x32_bf16 v[36:39], a[84:87], a[32:35], 0
    buffer_load_dwordx4 v162, s[12:15], s99 offen lds
    ds_read_b64_tr_b16 a[116:117], v170 offset:8608
    v_mfma_f32_16x16x32_bf16 v[68:71], a[84:87], a[36:39], 0
    ds_read_b64_tr_b16 a[118:119], v170 offset:8864
    v_mfma_f32_16x16x32_bf16 v[100:103], a[84:87], a[40:43], 0
    s_add_u32 m0, s52, 126240
    ds_read_b64_tr_b16 a[120:121], v170 offset:8640
    v_mfma_f32_16x16x32_bf16 v[40:43], a[88:91], a[32:35], 0
    buffer_load_dwordx4 v163, s[16:19], s63 offen lds
    ds_read_b64_tr_b16 a[122:123], v170 offset:8896
    v_mfma_f32_16x16x32_bf16 v[72:75], a[88:91], a[36:39], 0
    s_add_u32 m0, s35, 120832
    ds_read_b64_tr_b16 a[124:125], v170 offset:8672
    v_mfma_f32_16x16x32_bf16 v[104:107], a[88:91], a[40:43], 0
    buffer_load_dwordx4 v162, s[12:15], s100 offen lds
    ds_read_b64_tr_b16 a[126:127], v170 offset:8928
    v_mfma_f32_16x16x32_bf16 v[44:47], a[92:95], a[32:35], 0
    s_add_u32 m0, s35, 121856
    v_mfma_f32_16x16x32_bf16 v[76:79], a[92:95], a[36:39], 0
    buffer_load_dwordx4 v162, s[12:15], s101 offen lds
    v_mfma_f32_16x16x32_bf16 v[108:111], a[92:95], a[40:43], 0
    s_waitcnt vmcnt(10) lgkmcnt(0)
    s_barrier
    v_mfma_f32_16x16x32_bf16 v[16:19], a[96:99], a[44:47], v[16:19]
    s_lshl_b32 s53, s55, 7
    ds_read_b128 a[32:35], v166 offset:0
    s_lshl_b32 s54, s55, 19
    s_add_u32 s55, s55, 1
    s_cmp_eq_u32 s55, 7
    s_cselect_b32 s55, 0, s55
    v_add_u32 v162, s53, v160
    v_add_u32 v163, s54, v161
    v_mfma_f32_16x16x32_bf16 v[48:51], a[96:99], a[48:51], v[48:51]
    s_add_u32 m0, s35, 33792
    ds_read_b128 a[36:39], v166 offset:2048
    v_mfma_f32_16x16x32_bf16 v[80:83], a[96:99], a[52:55], v[80:83]
    buffer_load_dwordx4 v162, s[12:15], s96 offen lds
    ds_read_b128 a[40:43], v166 offset:4096
    v_mfma_f32_16x16x32_bf16 v[20:23], a[100:103], a[44:47], v[20:23]
    ds_read_b64_tr_b16 a[64:65], v171 offset:0
    v_mfma_f32_16x16x32_bf16 v[52:55], a[100:103], a[48:51], v[52:55]
    ds_read_b64_tr_b16 a[66:67], v171 offset:256
    v_mfma_f32_16x16x32_bf16 v[84:87], a[100:103], a[52:55], v[84:87]
    ds_read_b64_tr_b16 a[68:69], v171 offset:32
    v_mfma_f32_16x16x32_bf16 v[24:27], a[104:107], a[44:47], v[24:27]
    s_add_u32 m0, s52, 33792
    ds_read_b64_tr_b16 a[70:71], v171 offset:288
    v_mfma_f32_16x16x32_bf16 v[56:59], a[104:107], a[48:51], v[56:59]
    buffer_load_dwordx4 v163, s[16:19], s60 offen lds
    v_mfma_f32_16x16x32_bf16 v[88:91], a[104:107], a[52:55], v[88:91]
    ds_read_b64_tr_b16 a[72:73], v171 offset:64
    v_mfma_f32_16x16x32_bf16 v[28:31], a[108:111], a[44:47], v[28:31]
    ds_read_b64_tr_b16 a[74:75], v171 offset:320
    v_mfma_f32_16x16x32_bf16 v[60:63], a[108:111], a[48:51], v[60:63]
    ds_read_b64_tr_b16 a[76:77], v171 offset:96
    v_mfma_f32_16x16x32_bf16 v[92:95], a[108:111], a[52:55], v[92:95]
    ds_read_b64_tr_b16 a[78:79], v171 offset:352
    s_add_u32 m0, s35, 34816
    v_mfma_f32_16x16x32_bf16 v[32:35], a[112:115], a[44:47], v[32:35]
    buffer_load_dwordx4 v162, s[12:15], s97 offen lds
    ds_read_b64_tr_b16 a[80:81], v171 offset:128
    v_mfma_f32_16x16x32_bf16 v[64:67], a[112:115], a[48:51], v[64:67]
    ds_read_b64_tr_b16 a[82:83], v171 offset:384
    v_mfma_f32_16x16x32_bf16 v[96:99], a[112:115], a[52:55], v[96:99]
    v_mfma_f32_16x16x32_bf16 v[36:39], a[116:119], a[44:47], v[36:39]
    s_add_u32 m0, s52, 34848
    ds_read_b64_tr_b16 a[84:85], v171 offset:160
    v_mfma_f32_16x16x32_bf16 v[68:71], a[116:119], a[48:51], v[68:71]
    buffer_load_dwordx4 v163, s[16:19], s61 offen lds
    ds_read_b64_tr_b16 a[86:87], v171 offset:416
    v_mfma_f32_16x16x32_bf16 v[100:103], a[116:119], a[52:55], v[100:103]
    ds_read_b64_tr_b16 a[88:89], v171 offset:192
    v_mfma_f32_16x16x32_bf16 v[40:43], a[120:123], a[44:47], v[40:43]
    ds_read_b64_tr_b16 a[90:91], v171 offset:448
    v_mfma_f32_16x16x32_bf16 v[72:75], a[120:123], a[48:51], v[72:75]
    ds_read_b64_tr_b16 a[92:93], v171 offset:224
    v_mfma_f32_16x16x32_bf16 v[104:107], a[120:123], a[52:55], v[104:107]
    s_add_u32 m0, s35, 35840
    ds_read_b64_tr_b16 a[94:95], v171 offset:480
    v_mfma_f32_16x16x32_bf16 v[44:47], a[124:127], a[44:47], v[44:47]
    buffer_load_dwordx4 v162, s[12:15], s98 offen lds
    v_mfma_f32_16x16x32_bf16 v[76:79], a[124:127], a[48:51], v[76:79]
    v_mfma_f32_16x16x32_bf16 v[108:111], a[124:127], a[52:55], v[108:111]
    s_waitcnt lgkmcnt(8)
    v_mfma_f32_16x16x32_bf16 v[16:19], a[64:67], a[32:35], v[16:19]
    ds_read_b128 a[44:47], v167 offset:0
    v_mfma_f32_16x16x32_bf16 v[48:51], a[64:67], a[36:39], v[48:51]
    s_add_u32 m0, s52, 42240
    ds_read_b128 a[48:51], v167 offset:2048
    v_mfma_f32_16x16x32_bf16 v[80:83], a[64:67], a[40:43], v[80:83]
    buffer_load_dwordx4 v163, s[16:19], s62 offen lds
    ds_read_b128 a[52:55], v167 offset:4096
    v_mfma_f32_16x16x32_bf16 v[20:23], a[68:71], a[32:35], v[20:23]
    ds_read_b64_tr_b16 a[96:97], v171 offset:8448
    v_mfma_f32_16x16x32_bf16 v[52:55], a[68:71], a[36:39], v[52:55]
    ds_read_b64_tr_b16 a[98:99], v171 offset:8704
    v_mfma_f32_16x16x32_bf16 v[84:87], a[68:71], a[40:43], v[84:87]
    ds_read_b64_tr_b16 a[100:101], v171 offset:8480
    v_mfma_f32_16x16x32_bf16 v[24:27], a[72:75], a[32:35], v[24:27]
    s_add_u32 m0, s35, 36864
    ds_read_b64_tr_b16 a[102:103], v171 offset:8736
    v_mfma_f32_16x16x32_bf16 v[56:59], a[72:75], a[36:39], v[56:59]
    buffer_load_dwordx4 v162, s[12:15], s99 offen lds
    v_mfma_f32_16x16x32_bf16 v[88:91], a[72:75], a[40:43], v[88:91]
    ds_read_b64_tr_b16 a[104:105], v171 offset:8512
    v_mfma_f32_16x16x32_bf16 v[28:31], a[76:79], a[32:35], v[28:31]
    ds_read_b64_tr_b16 a[106:107], v171 offset:8768
    v_mfma_f32_16x16x32_bf16 v[60:63], a[76:79], a[36:39], v[60:63]
    ds_read_b64_tr_b16 a[108:109], v171 offset:8544
    v_mfma_f32_16x16x32_bf16 v[92:95], a[76:79], a[40:43], v[92:95]
    s_waitcnt lgkmcnt(10)
    ds_read_b64_tr_b16 a[110:111], v171 offset:8800
    s_add_u32 m0, s52, 43296
    v_mfma_f32_16x16x32_bf16 v[32:35], a[80:83], a[32:35], v[32:35]
    buffer_load_dwordx4 v163, s[16:19], s63 offen lds
    ds_read_b64_tr_b16 a[112:113], v171 offset:8576
    v_mfma_f32_16x16x32_bf16 v[64:67], a[80:83], a[36:39], v[64:67]
    ds_read_b64_tr_b16 a[114:115], v171 offset:8832
    v_mfma_f32_16x16x32_bf16 v[96:99], a[80:83], a[40:43], v[96:99]
    v_mfma_f32_16x16x32_bf16 v[36:39], a[84:87], a[32:35], v[36:39]
    s_add_u32 m0, s35, 37888
    ds_read_b64_tr_b16 a[116:117], v171 offset:8608
    v_mfma_f32_16x16x32_bf16 v[68:71], a[84:87], a[36:39], v[68:71]
    buffer_load_dwordx4 v162, s[12:15], s100 offen lds
    ds_read_b64_tr_b16 a[118:119], v171 offset:8864
    v_mfma_f32_16x16x32_bf16 v[100:103], a[84:87], a[40:43], v[100:103]
    ds_read_b64_tr_b16 a[120:121], v171 offset:8640
    v_mfma_f32_16x16x32_bf16 v[40:43], a[88:91], a[32:35], v[40:43]
    ds_read_b64_tr_b16 a[122:123], v171 offset:8896
    v_mfma_f32_16x16x32_bf16 v[72:75], a[88:91], a[36:39], v[72:75]
    ds_read_b64_tr_b16 a[124:125], v171 offset:8672
    v_mfma_f32_16x16x32_bf16 v[104:107], a[88:91], a[40:43], v[104:107]
    s_add_u32 m0, s35, 38912
    ds_read_b64_tr_b16 a[126:127], v171 offset:8928
    v_mfma_f32_16x16x32_bf16 v[44:47], a[92:95], a[32:35], v[44:47]
    buffer_load_dwordx4 v162, s[12:15], s101 offen lds
    v_mfma_f32_16x16x32_bf16 v[76:79], a[92:95], a[36:39], v[76:79]
    v_mfma_f32_16x16x32_bf16 v[108:111], a[92:95], a[40:43], v[108:111]
    s_waitcnt vmcnt(10) lgkmcnt(0)
    s_barrier
    v_mfma_f32_16x16x32_bf16 v[16:19], a[96:99], a[44:47], v[16:19]
    s_lshl_b32 s53, s55, 7
    ds_read_b128 a[32:35], v168 offset:0
    s_lshl_b32 s54, s55, 19
    s_add_u32 s55, s55, 1
    s_cmp_eq_u32 s55, 7
    s_cselect_b32 s55, 0, s55
    v_add_u32 v162, s53, v160
    v_add_u32 v163, s54, v161
    v_mfma_f32_16x16x32_bf16 v[48:51], a[96:99], a[48:51], v[48:51]
    s_add_u32 m0, s35, 75264
    ds_read_b128 a[36:39], v168 offset:2048
    v_mfma_f32_16x16x32_bf16 v[80:83], a[96:99], a[52:55], v[80:83]
    buffer_load_dwordx4 v162, s[12:15], s96 offen lds
    ds_read_b128 a[40:43], v168 offset:4096
    v_mfma_f32_16x16x32_bf16 v[20:23], a[100:103], a[44:47], v[20:23]
    ds_read_b64_tr_b16 a[64:65], v172 offset:0
    v_mfma_f32_16x16x32_bf16 v[52:55], a[100:103], a[48:51], v[52:55]
    ds_read_b64_tr_b16 a[66:67], v172 offset:256
    v_mfma_f32_16x16x32_bf16 v[84:87], a[100:103], a[52:55], v[84:87]
    ds_read_b64_tr_b16 a[68:69], v172 offset:32
    v_mfma_f32_16x16x32_bf16 v[24:27], a[104:107], a[44:47], v[24:27]
    s_add_u32 m0, s52, 75264
    ds_read_b64_tr_b16 a[70:71], v172 offset:288
    v_mfma_f32_16x16x32_bf16 v[56:59], a[104:107], a[48:51], v[56:59]
    buffer_load_dwordx4 v163, s[16:19], s60 offen lds
    v_mfma_f32_16x16x32_bf16 v[88:91], a[104:107], a[52:55], v[88:91]
    ds_read_b64_tr_b16 a[72:73], v172 offset:64
    v_mfma_f32_16x16x32_bf16 v[28:31], a[108:111], a[44:47], v[28:31]
    ds_read_b64_tr_b16 a[74:75], v172 offset:320
    v_mfma_f32_16x16x32_bf16 v[60:63], a[108:111], a[48:51], v[60:63]
    ds_read_b64_tr_b16 a[76:77], v172 offset:96
    v_mfma_f32_16x16x32_bf16 v[92:95], a[108:111], a[52:55], v[92:95]
    ds_read_b64_tr_b16 a[78:79], v172 offset:352
    s_add_u32 m0, s35, 76288
    v_mfma_f32_16x16x32_bf16 v[32:35], a[112:115], a[44:47], v[32:35]
    buffer_load_dwordx4 v162, s[12:15], s97 offen lds
    ds_read_b64_tr_b16 a[80:81], v172 offset:128
    v_mfma_f32_16x16x32_bf16 v[64:67], a[112:115], a[48:51], v[64:67]
    ds_read_b64_tr_b16 a[82:83], v172 offset:384
    v_mfma_f32_16x16x32_bf16 v[96:99], a[112:115], a[52:55], v[96:99]
    v_mfma_f32_16x16x32_bf16 v[36:39], a[116:119], a[44:47], v[36:39]
    s_add_u32 m0, s52, 76320
    ds_read_b64_tr_b16 a[84:85], v172 offset:160
    v_mfma_f32_16x16x32_bf16 v[68:71], a[116:119], a[48:51], v[68:71]
    buffer_load_dwordx4 v163, s[16:19], s61 offen lds
    ds_read_b64_tr_b16 a[86:87], v172 offset:416
    v_mfma_f32_16x16x32_bf16 v[100:103], a[116:119], a[52:55], v[100:103]
    ds_read_b64_tr_b16 a[88:89], v172 offset:192
    v_mfma_f32_16x16x32_bf16 v[40:43], a[120:123], a[44:47], v[40:43]
    ds_read_b64_tr_b16 a[90:91], v172 offset:448
    v_mfma_f32_16x16x32_bf16 v[72:75], a[120:123], a[48:51], v[72:75]
    ds_read_b64_tr_b16 a[92:93], v172 offset:224
    v_mfma_f32_16x16x32_bf16 v[104:107], a[120:123], a[52:55], v[104:107]
    s_add_u32 m0, s35, 77312
    ds_read_b64_tr_b16 a[94:95], v172 offset:480
    v_mfma_f32_16x16x32_bf16 v[44:47], a[124:127], a[44:47], v[44:47]
    buffer_load_dwordx4 v162, s[12:15], s98 offen lds
    v_mfma_f32_16x16x32_bf16 v[76:79], a[124:127], a[48:51], v[76:79]
    v_mfma_f32_16x16x32_bf16 v[108:111], a[124:127], a[52:55], v[108:111]
    s_waitcnt lgkmcnt(8)
    v_mfma_f32_16x16x32_bf16 v[16:19], a[64:67], a[32:35], v[16:19]
    ds_read_b128 a[44:47], v169 offset:0
    v_mfma_f32_16x16x32_bf16 v[48:51], a[64:67], a[36:39], v[48:51]
    s_add_u32 m0, s52, 83712
    ds_read_b128 a[48:51], v169 offset:2048
    v_mfma_f32_16x16x32_bf16 v[80:83], a[64:67], a[40:43], v[80:83]
    buffer_load_dwordx4 v163, s[16:19], s62 offen lds
    ds_read_b128 a[52:55], v169 offset:4096
    v_mfma_f32_16x16x32_bf16 v[20:23], a[68:71], a[32:35], v[20:23]
    ds_read_b64_tr_b16 a[96:97], v172 offset:8448
    v_mfma_f32_16x16x32_bf16 v[52:55], a[68:71], a[36:39], v[52:55]
    ds_read_b64_tr_b16 a[98:99], v172 offset:8704
    v_mfma_f32_16x16x32_bf16 v[84:87], a[68:71], a[40:43], v[84:87]
    ds_read_b64_tr_b16 a[100:101], v172 offset:8480
    v_mfma_f32_16x16x32_bf16 v[24:27], a[72:75], a[32:35], v[24:27]
    s_add_u32 m0, s35, 78336
    ds_read_b64_tr_b16 a[102:103], v172 offset:8736
    v_mfma_f32_16x16x32_bf16 v[56:59], a[72:75], a[36:39], v[56:59]
    buffer_load_dwordx4 v162, s[12:15], s99 offen lds
    v_mfma_f32_16x16x32_bf16 v[88:91], a[72:75], a[40:43], v[88:91]
    ds_read_b64_tr_b16 a[104:105], v172 offset:8512
    v_mfma_f32_16x16x32_bf16 v[28:31], a[76:79], a[32:35], v[28:31]
    ds_read_b64_tr_b16 a[106:107], v172 offset:8768
    v_mfma_f32_16x16x32_bf16 v[60:63], a[76:79], a[36:39], v[60:63]
    ds_read_b64_tr_b16 a[108:109], v172 offset:8544
    v_mfma_f32_16x16x32_bf16 v[92:95], a[76:79], a[40:43], v[92:95]
    s_waitcnt lgkmcnt(10)
    ds_read_b64_tr_b16 a[110:111], v172 offset:8800
    s_add_u32 m0, s52, 84768
    v_mfma_f32_16x16x32_bf16 v[32:35], a[80:83], a[32:35], v[32:35]
    buffer_load_dwordx4 v163, s[16:19], s63 offen lds
    ds_read_b64_tr_b16 a[112:113], v172 offset:8576
    v_mfma_f32_16x16x32_bf16 v[64:67], a[80:83], a[36:39], v[64:67]
    ds_read_b64_tr_b16 a[114:115], v172 offset:8832
    v_mfma_f32_16x16x32_bf16 v[96:99], a[80:83], a[40:43], v[96:99]
    v_mfma_f32_16x16x32_bf16 v[36:39], a[84:87], a[32:35], v[36:39]
    s_add_u32 m0, s35, 79360
    ds_read_b64_tr_b16 a[116:117], v172 offset:8608
    v_mfma_f32_16x16x32_bf16 v[68:71], a[84:87], a[36:39], v[68:71]
    buffer_load_dwordx4 v162, s[12:15], s100 offen lds
    ds_read_b64_tr_b16 a[118:119], v172 offset:8864
    v_mfma_f32_16x16x32_bf16 v[100:103], a[84:87], a[40:43], v[100:103]
    ds_read_b64_tr_b16 a[120:121], v172 offset:8640
    v_mfma_f32_16x16x32_bf16 v[40:43], a[88:91], a[32:35], v[40:43]
    ds_read_b64_tr_b16 a[122:123], v172 offset:8896
    v_mfma_f32_16x16x32_bf16 v[72:75], a[88:91], a[36:39], v[72:75]
    ds_read_b64_tr_b16 a[124:125], v172 offset:8672
    v_mfma_f32_16x16x32_bf16 v[104:107], a[88:91], a[40:43], v[104:107]
    s_add_u32 m0, s35, 80384
    ds_read_b64_tr_b16 a[126:127], v172 offset:8928
    v_mfma_f32_16x16x32_bf16 v[44:47], a[92:95], a[32:35], v[44:47]
    buffer_load_dwordx4 v162, s[12:15], s101 offen lds
    v_mfma_f32_16x16x32_bf16 v[76:79], a[92:95], a[36:39], v[76:79]
    v_mfma_f32_16x16x32_bf16 v[108:111], a[92:95], a[40:43], v[108:111]
    s_waitcnt vmcnt(10) lgkmcnt(0)
    s_barrier
    v_mfma_f32_16x16x32_bf16 v[16:19], a[96:99], a[44:47], v[16:19]
    s_lshl_b32 s53, s55, 7
    ds_read_b128 a[32:35], v164 offset:0
    s_lshl_b32 s54, s55, 19
    s_add_u32 s55, s55, 1
    s_cmp_eq_u32 s55, 7
    s_cselect_b32 s55, 0, s55
    v_add_u32 v162, s53, v160
    v_add_u32 v163, s54, v161
    v_mfma_f32_16x16x32_bf16 v[48:51], a[96:99], a[48:51], v[48:51]
    s_add_u32 m0, s35, 116736
    ds_read_b128 a[36:39], v164 offset:2048
    v_mfma_f32_16x16x32_bf16 v[80:83], a[96:99], a[52:55], v[80:83]
    buffer_load_dwordx4 v162, s[12:15], s96 offen lds
    ds_read_b128 a[40:43], v164 offset:4096
    v_mfma_f32_16x16x32_bf16 v[20:23], a[100:103], a[44:47], v[20:23]
    ds_read_b64_tr_b16 a[64:65], v170 offset:0
    v_mfma_f32_16x16x32_bf16 v[52:55], a[100:103], a[48:51], v[52:55]
    ds_read_b64_tr_b16 a[66:67], v170 offset:256
    v_mfma_f32_16x16x32_bf16 v[84:87], a[100:103], a[52:55], v[84:87]
    ds_read_b64_tr_b16 a[68:69], v170 offset:32
    v_mfma_f32_16x16x32_bf16 v[24:27], a[104:107], a[44:47], v[24:27]
    s_add_u32 m0, s52, 116736
    ds_read_b64_tr_b16 a[70:71], v170 offset:288
    v_mfma_f32_16x16x32_bf16 v[56:59], a[104:107], a[48:51], v[56:59]
    buffer_load_dwordx4 v163, s[16:19], s60 offen lds
    v_mfma_f32_16x16x32_bf16 v[88:91], a[104:107], a[52:55], v[88:91]
    ds_read_b64_tr_b16 a[72:73], v170 offset:64
    v_mfma_f32_16x16x32_bf16 v[28:31], a[108:111], a[44:47], v[28:31]
    ds_read_b64_tr_b16 a[74:75], v170 offset:320
    v_mfma_f32_16x16x32_bf16 v[60:63], a[108:111], a[48:51], v[60:63]
    ds_read_b64_tr_b16 a[76:77], v170 offset:96
    v_mfma_f32_16x16x32_bf16 v[92:95], a[108:111], a[52:55], v[92:95]
    ds_read_b64_tr_b16 a[78:79], v170 offset:352
    s_add_u32 m0, s35, 117760
    v_mfma_f32_16x16x32_bf16 v[32:35], a[112:115], a[44:47], v[32:35]
    buffer_load_dwordx4 v162, s[12:15], s97 offen lds
    ds_read_b64_tr_b16 a[80:81], v170 offset:128
    v_mfma_f32_16x16x32_bf16 v[64:67], a[112:115], a[48:51], v[64:67]
    ds_read_b64_tr_b16 a[82:83], v170 offset:384
    v_mfma_f32_16x16x32_bf16 v[96:99], a[112:115], a[52:55], v[96:99]
    v_mfma_f32_16x16x32_bf16 v[36:39], a[116:119], a[44:47], v[36:39]
    s_add_u32 m0, s52, 117792
    ds_read_b64_tr_b16 a[84:85], v170 offset:160
    v_mfma_f32_16x16x32_bf16 v[68:71], a[116:119], a[48:51], v[68:71]
    buffer_load_dwordx4 v163, s[16:19], s61 offen lds
    ds_read_b64_tr_b16 a[86:87], v170 offset:416
    v_mfma_f32_16x16x32_bf16 v[100:103], a[116:119], a[52:55], v[100:103]
    ds_read_b64_tr_b16 a[88:89], v170 offset:192
    v_mfma_f32_16x16x32_bf16 v[40:43], a[120:123], a[44:47], v[40:43]
    ds_read_b64_tr_b16 a[90:91], v170 offset:448
    v_mfma_f32_16x16x32_bf16 v[72:75], a[120:123], a[48:51], v[72:75]
    ds_read_b64_tr_b16 a[92:93], v170 offset:224
    v_mfma_f32_16x16x32_bf16 v[104:107], a[120:123], a[52:55], v[104:107]
    s_add_u32 m0, s35, 118784
    ds_read_b64_tr_b16 a[94:95], v170 offset:480
    v_mfma_f32_16x16x32_bf16 v[44:47], a[124:127], a[44:47], v[44:47]
    buffer_load_dwordx4 v162, s[12:15], s98 offen lds
    v_mfma_f32_16x16x32_bf16 v[76:79], a[124:127], a[48:51], v[76:79]
    v_mfma_f32_16x16x32_bf16 v[108:111], a[124:127], a[52:55], v[108:111]
    s_waitcnt lgkmcnt(8)
    v_mfma_f32_16x16x32_bf16 v[16:19], a[64:67], a[32:35], v[16:19]
    ds_read_b128 a[44:47], v165 offset:0
    v_mfma_f32_16x16x32_bf16 v[48:51], a[64:67], a[36:39], v[48:51]
    s_add_u32 m0, s52, 125184
    ds_read_b128 a[48:51], v165 offset:2048
    v_mfma_f32_16x16x32_bf16 v[80:83], a[64:67], a[40:43], v[80:83]
    buffer_load_dwordx4 v163, s[16:19], s62 offen lds
    ds_read_b128 a[52:55], v165 offset:4096
    v_mfma_f32_16x16x32_bf16 v[20:23], a[68:71], a[32:35], v[20:23]
    ds_read_b64_tr_b16 a[96:97], v170 offset:8448
    v_mfma_f32_16x16x32_bf16 v[52:55], a[68:71], a[36:39], v[52:55]
    ds_read_b64_tr_b16 a[98:99], v170 offset:8704
    v_mfma_f32_16x16x32_bf16 v[84:87], a[68:71], a[40:43], v[84:87]
    ds_read_b64_tr_b16 a[100:101], v170 offset:8480
    v_mfma_f32_16x16x32_bf16 v[24:27], a[72:75], a[32:35], v[24:27]
    s_add_u32 m0, s35, 119808
    ds_read_b64_tr_b16 a[102:103], v170 offset:8736
    v_mfma_f32_16x16x32_bf16 v[56:59], a[72:75], a[36:39], v[56:59]
    buffer_load_dwordx4 v162, s[12:15], s99 offen lds
    v_mfma_f32_16x16x32_bf16 v[88:91], a[72:75], a[40:43], v[88:91]
    ds_read_b64_tr_b16 a[104:105], v170 offset:8512
    v_mfma_f32_16x16x32_bf16 v[28:31], a[76:79], a[32:35], v[28:31]
    ds_read_b64_tr_b16 a[106:107], v170 offset:8768
    v_mfma_f32_16x16x32_bf16 v[60:63], a[76:79], a[36:39], v[60:63]
    ds_read_b64_tr_b16 a[108:109], v170 offset:8544
    v_mfma_f32_16x16x32_bf16 v[92:95], a[76:79], a[40:43], v[92:95]
    s_waitcnt lgkmcnt(10)
    ds_read_b64_tr_b16 a[110:111], v170 offset:8800
    s_add_u32 m0, s52, 126240
    v_mfma_f32_16x16x32_bf16 v[32:35], a[80:83], a[32:35], v[32:35]
    buffer_load_dwordx4 v163, s[16:19], s63 offen lds
    ds_read_b64_tr_b16 a[112:113], v170 offset:8576
    v_mfma_f32_16x16x32_bf16 v[64:67], a[80:83], a[36:39], v[64:67]
    ds_read_b64_tr_b16 a[114:115], v170 offset:8832
    v_mfma_f32_16x16x32_bf16 v[96:99], a[80:83], a[40:43], v[96:99]
    v_mfma_f32_16x16x32_bf16 v[36:39], a[84:87], a[32:35], v[36:39]
    s_add_u32 m0, s35, 120832
    ds_read_b64_tr_b16 a[116:117], v170 offset:8608
    v_mfma_f32_16x16x32_bf16 v[68:71], a[84:87], a[36:39], v[68:71]
    buffer_load_dwordx4 v162, s[12:15], s100 offen lds
    ds_read_b64_tr_b16 a[118:119], v170 offset:8864
    v_mfma_f32_16x16x32_bf16 v[100:103], a[84:87], a[40:43], v[100:103]
    ds_read_b64_tr_b16 a[120:121], v170 offset:8640
    v_mfma_f32_16x16x32_bf16 v[40:43], a[88:91], a[32:35], v[40:43]
    ds_read_b64_tr_b16 a[122:123], v170 offset:8896
    v_mfma_f32_16x16x32_bf16 v[72:75], a[88:91], a[36:39], v[72:75]
    ds_read_b64_tr_b16 a[124:125], v170 offset:8672
    v_mfma_f32_16x16x32_bf16 v[104:107], a[88:91], a[40:43], v[104:107]
    s_add_u32 m0, s35, 121856
    ds_read_b64_tr_b16 a[126:127], v170 offset:8928
    v_mfma_f32_16x16x32_bf16 v[44:47], a[92:95], a[32:35], v[44:47]
    buffer_load_dwordx4 v162, s[12:15], s101 offen lds
    v_mfma_f32_16x16x32_bf16 v[76:79], a[92:95], a[36:39], v[76:79]
    v_mfma_f32_16x16x32_bf16 v[108:111], a[92:95], a[40:43], v[108:111]
    s_waitcnt vmcnt(10) lgkmcnt(0)
    s_barrier
    v_mfma_f32_16x16x32_bf16 v[16:19], a[96:99], a[44:47], v[16:19]
    s_lshl_b32 s53, s55, 7
    ds_read_b128 a[32:35], v166 offset:0
    s_lshl_b32 s54, s55, 19
    s_add_u32 s55, s55, 1
    s_cmp_eq_u32 s55, 7
    s_cselect_b32 s55, 0, s55
    v_add_u32 v162, s53, v160
    v_add_u32 v163, s54, v161
    v_mfma_f32_16x16x32_bf16 v[48:51], a[96:99], a[48:51], v[48:51]
    s_add_u32 m0, s35, 33792
    ds_read_b128 a[36:39], v166 offset:2048
    v_mfma_f32_16x16x32_bf16 v[80:83], a[96:99], a[52:55], v[80:83]
    buffer_load_dwordx4 v162, s[12:15], s96 offen lds
    ds_read_b128 a[40:43], v166 offset:4096
    v_mfma_f32_16x16x32_bf16 v[20:23], a[100:103], a[44:47], v[20:23]
    ds_read_b64_tr_b16 a[64:65], v171 offset:0
    v_mfma_f32_16x16x32_bf16 v[52:55], a[100:103], a[48:51], v[52:55]
    ds_read_b64_tr_b16 a[66:67], v171 offset:256
    v_mfma_f32_16x16x32_bf16 v[84:87], a[100:103], a[52:55], v[84:87]
    ds_read_b64_tr_b16 a[68:69], v171 offset:32
    v_mfma_f32_16x16x32_bf16 v[24:27], a[104:107], a[44:47], v[24:27]
    s_add_u32 m0, s52, 33792
    ds_read_b64_tr_b16 a[70:71], v171 offset:288
    v_mfma_f32_16x16x32_bf16 v[56:59], a[104:107], a[48:51], v[56:59]
    buffer_load_dwordx4 v163, s[16:19], s60 offen lds
    v_mfma_f32_16x16x32_bf16 v[88:91], a[104:107], a[52:55], v[88:91]
    ds_read_b64_tr_b16 a[72:73], v171 offset:64
    v_mfma_f32_16x16x32_bf16 v[28:31], a[108:111], a[44:47], v[28:31]
    ds_read_b64_tr_b16 a[74:75], v171 offset:320
    v_mfma_f32_16x16x32_bf16 v[60:63], a[108:111], a[48:51], v[60:63]
    ds_read_b64_tr_b16 a[76:77], v171 offset:96
    v_mfma_f32_16x16x32_bf16 v[92:95], a[108:111], a[52:55], v[92:95]
    ds_read_b64_tr_b16 a[78:79], v171 offset:352
    s_add_u32 m0, s35, 34816
    v_mfma_f32_16x16x32_bf16 v[32:35], a[112:115], a[44:47], v[32:35]
    buffer_load_dwordx4 v162, s[12:15], s97 offen lds
    ds_read_b64_tr_b16 a[80:81], v171 offset:128
    v_mfma_f32_16x16x32_bf16 v[64:67], a[112:115], a[48:51], v[64:67]
    ds_read_b64_tr_b16 a[82:83], v171 offset:384
    v_mfma_f32_16x16x32_bf16 v[96:99], a[112:115], a[52:55], v[96:99]
    v_mfma_f32_16x16x32_bf16 v[36:39], a[116:119], a[44:47], v[36:39]
    s_add_u32 m0, s52, 34848
    ds_read_b64_tr_b16 a[84:85], v171 offset:160
    v_mfma_f32_16x16x32_bf16 v[68:71], a[116:119], a[48:51], v[68:71]
    buffer_load_dwordx4 v163, s[16:19], s61 offen lds
    ds_read_b64_tr_b16 a[86:87], v171 offset:416
    v_mfma_f32_16x16x32_bf16 v[100:103], a[116:119], a[52:55], v[100:103]
    ds_read_b64_tr_b16 a[88:89], v171 offset:192
    v_mfma_f32_16x16x32_bf16 v[40:43], a[120:123], a[44:47], v[40:43]
    ds_read_b64_tr_b16 a[90:91], v171 offset:448
    v_mfma_f32_16x16x32_bf16 v[72:75], a[120:123], a[48:51], v[72:75]
    ds_read_b64_tr_b16 a[92:93], v171 offset:224
    v_mfma_f32_16x16x32_bf16 v[104:107], a[120:123], a[52:55], v[104:107]
    s_add_u32 m0, s35, 35840
    ds_read_b64_tr_b16 a[94:95], v171 offset:480
    v_mfma_f32_16x16x32_bf16 v[44:47], a[124:127], a[44:47], v[44:47]
    buffer_load_dwordx4 v162, s[12:15], s98 offen lds
    v_mfma_f32_16x16x32_bf16 v[76:79], a[124:127], a[48:51], v[76:79]
    v_mfma_f32_16x16x32_bf16 v[108:111], a[124:127], a[52:55], v[108:111]
    s_waitcnt lgkmcnt(8)
    v_mfma_f32_16x16x32_bf16 v[16:19], a[64:67], a[32:35], v[16:19]
    ds_read_b128 a[44:47], v167 offset:0
    v_mfma_f32_16x16x32_bf16 v[48:51], a[64:67], a[36:39], v[48:51]
    s_add_u32 m0, s52, 42240
    ds_read_b128 a[48:51], v167 offset:2048
    v_mfma_f32_16x16x32_bf16 v[80:83], a[64:67], a[40:43], v[80:83]
    buffer_load_dwordx4 v163, s[16:19], s62 offen lds
    ds_read_b128 a[52:55], v167 offset:4096
    v_mfma_f32_16x16x32_bf16 v[20:23], a[68:71], a[32:35], v[20:23]
    ds_read_b64_tr_b16 a[96:97], v171 offset:8448
    v_mfma_f32_16x16x32_bf16 v[52:55], a[68:71], a[36:39], v[52:55]
    ds_read_b64_tr_b16 a[98:99], v171 offset:8704
    v_mfma_f32_16x16x32_bf16 v[84:87], a[68:71], a[40:43], v[84:87]
    ds_read_b64_tr_b16 a[100:101], v171 offset:8480
    v_mfma_f32_16x16x32_bf16 v[24:27], a[72:75], a[32:35], v[24:27]
    s_add_u32 m0, s35, 36864
    ds_read_b64_tr_b16 a[102:103], v171 offset:8736
    v_mfma_f32_16x16x32_bf16 v[56:59], a[72:75], a[36:39], v[56:59]
    buffer_load_dwordx4 v162, s[12:15], s99 offen lds
    v_mfma_f32_16x16x32_bf16 v[88:91], a[72:75], a[40:43], v[88:91]
    ds_read_b64_tr_b16 a[104:105], v171 offset:8512
    v_mfma_f32_16x16x32_bf16 v[28:31], a[76:79], a[32:35], v[28:31]
    ds_read_b64_tr_b16 a[106:107], v171 offset:8768
    v_mfma_f32_16x16x32_bf16 v[60:63], a[76:79], a[36:39], v[60:63]
    ds_read_b64_tr_b16 a[108:109], v171 offset:8544
    v_mfma_f32_16x16x32_bf16 v[92:95], a[76:79], a[40:43], v[92:95]
    s_waitcnt lgkmcnt(10)
    ds_read_b64_tr_b16 a[110:111], v171 offset:8800
    s_add_u32 m0, s52, 43296
    v_mfma_f32_16x16x32_bf16 v[32:35], a[80:83], a[32:35], v[32:35]
    buffer_load_dwordx4 v163, s[16:19], s63 offen lds
    ds_read_b64_tr_b16 a[112:113], v171 offset:8576
    v_mfma_f32_16x16x32_bf16 v[64:67], a[80:83], a[36:39], v[64:67]
    ds_read_b64_tr_b16 a[114:115], v171 offset:8832
    v_mfma_f32_16x16x32_bf16 v[96:99], a[80:83], a[40:43], v[96:99]
    v_mfma_f32_16x16x32_bf16 v[36:39], a[84:87], a[32:35], v[36:39]
    s_add_u32 m0, s35, 37888
    ds_read_b64_tr_b16 a[116:117], v171 offset:8608
    v_mfma_f32_16x16x32_bf16 v[68:71], a[84:87], a[36:39], v[68:71]
    buffer_load_dwordx4 v162, s[12:15], s100 offen lds
    ds_read_b64_tr_b16 a[118:119], v171 offset:8864
    v_mfma_f32_16x16x32_bf16 v[100:103], a[84:87], a[40:43], v[100:103]
    ds_read_b64_tr_b16 a[120:121], v171 offset:8640
    v_mfma_f32_16x16x32_bf16 v[40:43], a[88:91], a[32:35], v[40:43]
    ds_read_b64_tr_b16 a[122:123], v171 offset:8896
    v_mfma_f32_16x16x32_bf16 v[72:75], a[88:91], a[36:39], v[72:75]
    ds_read_b64_tr_b16 a[124:125], v171 offset:8672
    v_mfma_f32_16x16x32_bf16 v[104:107], a[88:91], a[40:43], v[104:107]
    s_add_u32 m0, s35, 38912
    ds_read_b64_tr_b16 a[126:127], v171 offset:8928
    v_mfma_f32_16x16x32_bf16 v[44:47], a[92:95], a[32:35], v[44:47]
    buffer_load_dwordx4 v162, s[12:15], s101 offen lds
    v_mfma_f32_16x16x32_bf16 v[76:79], a[92:95], a[36:39], v[76:79]
    v_mfma_f32_16x16x32_bf16 v[108:111], a[92:95], a[40:43], v[108:111]
    s_waitcnt vmcnt(10) lgkmcnt(0)
    s_barrier
    v_mfma_f32_16x16x32_bf16 v[16:19], a[96:99], a[44:47], v[16:19]
    s_lshl_b32 s53, s55, 7
    ds_read_b128 a[32:35], v168 offset:0
    s_lshl_b32 s54, s55, 19
    s_add_u32 s55, s55, 1
    s_cmp_eq_u32 s55, 7
    s_cselect_b32 s55, 0, s55
    v_add_u32 v162, s53, v160
    v_add_u32 v163, s54, v161
    v_mfma_f32_16x16x32_bf16 v[48:51], a[96:99], a[48:51], v[48:51]
    s_add_u32 m0, s35, 75264
    ds_read_b128 a[36:39], v168 offset:2048
    v_mfma_f32_16x16x32_bf16 v[80:83], a[96:99], a[52:55], v[80:83]
    buffer_load_dwordx4 v162, s[12:15], s96 offen lds
    ds_read_b128 a[40:43], v168 offset:4096
    v_mfma_f32_16x16x32_bf16 v[20:23], a[100:103], a[44:47], v[20:23]
    ds_read_b64_tr_b16 a[64:65], v172 offset:0
    v_mfma_f32_16x16x32_bf16 v[52:55], a[100:103], a[48:51], v[52:55]
    ds_read_b64_tr_b16 a[66:67], v172 offset:256
    v_mfma_f32_16x16x32_bf16 v[84:87], a[100:103], a[52:55], v[84:87]
    s_add_u32 m0, s52, 75264
    ds_read_b64_tr_b16 a[68:69], v172 offset:32
    v_mfma_f32_16x16x32_bf16 v[24:27], a[104:107], a[44:47], v[24:27]
    buffer_load_dwordx4 v163, s[16:19], s60 offen lds
    ds_read_b64_tr_b16 a[70:71], v172 offset:288
    v_mfma_f32_16x16x32_bf16 v[56:59], a[104:107], a[48:51], v[56:59]
    v_mfma_f32_16x16x32_bf16 v[88:91], a[104:107], a[52:55], v[88:91]
    ds_read_b64_tr_b16 a[72:73], v172 offset:64
    v_mfma_f32_16x16x32_bf16 v[28:31], a[108:111], a[44:47], v[28:31]
    s_add_u32 m0, s35, 76288
    ds_read_b64_tr_b16 a[74:75], v172 offset:320
    v_mfma_f32_16x16x32_bf16 v[60:63], a[108:111], a[48:51], v[60:63]
    buffer_load_dwordx4 v162, s[12:15], s97 offen lds
    ds_read_b64_tr_b16 a[76:77], v172 offset:96
    v_mfma_f32_16x16x32_bf16 v[92:95], a[108:111], a[52:55], v[92:95]
    ds_read_b64_tr_b16 a[78:79], v172 offset:352
    v_mfma_f32_16x16x32_bf16 v[32:35], a[112:115], a[44:47], v[32:35]
    ds_read_b64_tr_b16 a[80:81], v172 offset:128
    v_mfma_f32_16x16x32_bf16 v[64:67], a[112:115], a[48:51], v[64:67]
    s_add_u32 m0, s52, 76320
    ds_read_b64_tr_b16 a[82:83], v172 offset:384
    v_mfma_f32_16x16x32_bf16 v[96:99], a[112:115], a[52:55], v[96:99]
    buffer_load_dwordx4 v163, s[16:19], s61 offen lds
    v_mfma_f32_16x16x32_bf16 v[36:39], a[116:119], a[44:47], v[36:39]
    ds_read_b64_tr_b16 a[84:85], v172 offset:160
    v_mfma_f32_16x16x32_bf16 v[68:71], a[116:119], a[48:51], v[68:71]
    ds_read_b64_tr_b16 a[86:87], v172 offset:416
    v_mfma_f32_16x16x32_bf16 v[100:103], a[116:119], a[52:55], v[100:103]
    s_add_u32 m0, s35, 77312
    ds_read_b64_tr_b16 a[88:89], v172 offset:192
    v_mfma_f32_16x16x32_bf16 v[40:43], a[120:123], a[44:47], v[40:43]
    buffer_load_dwordx4 v162, s[12:15], s98 offen lds
    ds_read_b64_tr_b16 a[90:91], v172 offset:448
    v_mfma_f32_16x16x32_bf16 v[72:75], a[120:123], a[48:51], v[72:75]
    ds_read_b64_tr_b16 a[92:93], v172 offset:224
    v_mfma_f32_16x16x32_bf16 v[104:107], a[120:123], a[52:55], v[104:107]
    ds_read_b64_tr_b16 a[94:95], v172 offset:480
    v_mfma_f32_16x16x32_bf16 v[44:47], a[124:127], a[44:47], v[44:47]
    s_add_u32 m0, s28, 0
    v_mfma_f32_16x16x32_bf16 v[76:79], a[124:127], a[48:51], v[76:79]
    buffer_load_dwordx4 v228, s[4:7], s27 offen nt lds
    v_mfma_f32_16x16x32_bf16 v[108:111], a[124:127], a[52:55], v[108:111]
    s_waitcnt lgkmcnt(8)
    v_mfma_f32_16x16x32_bf16 v[16:19], a[64:67], a[32:35], v[16:19]
    ds_read_b128 a[44:47], v169 offset:0
    v_mfma_f32_16x16x32_bf16 v[48:51], a[64:67], a[36:39], v[48:51]
    s_add_u32 m0, s52, 83712
    ds_read_b128 a[48:51], v169 offset:2048
    v_mfma_f32_16x16x32_bf16 v[80:83], a[64:67], a[40:43], v[80:83]
    buffer_load_dwordx4 v163, s[16:19], s62 offen lds
    ds_read_b128 a[52:55], v169 offset:4096
    v_mfma_f32_16x16x32_bf16 v[20:23], a[68:71], a[32:35], v[20:23]
    ds_read_b64_tr_b16 a[96:97], v172 offset:8448
    v_mfma_f32_16x16x32_bf16 v[52:55], a[68:71], a[36:39], v[52:55]
    ds_read_b64_tr_b16 a[98:99], v172 offset:8704
    v_mfma_f32_16x16x32_bf16 v[84:87], a[68:71], a[40:43], v[84:87]
    s_add_u32 m0, s35, 78336
    ds_read_b64_tr_b16 a[100:101], v172 offset:8480
    v_mfma_f32_16x16x32_bf16 v[24:27], a[72:75], a[32:35], v[24:27]
    buffer_load_dwordx4 v162, s[12:15], s99 offen lds
    ds_read_b64_tr_b16 a[102:103], v172 offset:8736
    v_mfma_f32_16x16x32_bf16 v[56:59], a[72:75], a[36:39], v[56:59]
    v_mfma_f32_16x16x32_bf16 v[88:91], a[72:75], a[40:43], v[88:91]
    ds_read_b64_tr_b16 a[104:105], v172 offset:8512
    v_mfma_f32_16x16x32_bf16 v[28:31], a[76:79], a[32:35], v[28:31]
    s_add_u32 m0, s52, 84768
    ds_read_b64_tr_b16 a[106:107], v172 offset:8768
    v_mfma_f32_16x16x32_bf16 v[60:63], a[76:79], a[36:39], v[60:63]
    buffer_load_dwordx4 v163, s[16:19], s63 offen lds
    ds_read_b64_tr_b16 a[108:109], v172 offset:8544
    v_mfma_f32_16x16x32_bf16 v[92:95], a[76:79], a[40:43], v[92:95]
    s_waitcnt lgkmcnt(10)
    ds_read_b64_tr_b16 a[110:111], v172 offset:8800
    v_mfma_f32_16x16x32_bf16 v[32:35], a[80:83], a[32:35], v[32:35]
    ds_read_b64_tr_b16 a[112:113], v172 offset:8576
    v_mfma_f32_16x16x32_bf16 v[64:67], a[80:83], a[36:39], v[64:67]
    s_add_u32 m0, s35, 79360
    ds_read_b64_tr_b16 a[114:115], v172 offset:8832
    v_mfma_f32_16x16x32_bf16 v[96:99], a[80:83], a[40:43], v[96:99]
    buffer_load_dwordx4 v162, s[12:15], s100 offen lds
    v_mfma_f32_16x16x32_bf16 v[36:39], a[84:87], a[32:35], v[36:39]
    ds_read_b64_tr_b16 a[116:117], v172 offset:8608
    v_mfma_f32_16x16x32_bf16 v[68:71], a[84:87], a[36:39], v[68:71]
    ds_read_b64_tr_b16 a[118:119], v172 offset:8864
    v_mfma_f32_16x16x32_bf16 v[100:103], a[84:87], a[40:43], v[100:103]
    s_add_u32 m0, s35, 80384
    ds_read_b64_tr_b16 a[120:121], v172 offset:8640
    v_mfma_f32_16x16x32_bf16 v[40:43], a[88:91], a[32:35], v[40:43]
    buffer_load_dwordx4 v162, s[12:15], s101 offen lds
    ds_read_b64_tr_b16 a[122:123], v172 offset:8896
    v_mfma_f32_16x16x32_bf16 v[72:75], a[88:91], a[36:39], v[72:75]
    ds_read_b64_tr_b16 a[124:125], v172 offset:8672
    v_mfma_f32_16x16x32_bf16 v[104:107], a[88:91], a[40:43], v[104:107]
    ds_read_b64_tr_b16 a[126:127], v172 offset:8928
    v_mfma_f32_16x16x32_bf16 v[44:47], a[92:95], a[32:35], v[44:47]
    s_add_u32 m0, s28, 800
    v_mfma_f32_16x16x32_bf16 v[76:79], a[92:95], a[36:39], v[76:79]
    buffer_load_dwordx4 v228, s[4:7], s27 offen offset:256 nt lds
    v_mfma_f32_16x16x32_bf16 v[108:111], a[92:95], a[40:43], v[108:111]
    s_waitcnt vmcnt(12) lgkmcnt(0)
    s_barrier
    v_mfma_f32_16x16x32_bf16 v[16:19], a[96:99], a[44:47], v[16:19]
    s_lshl_b32 s53, s55, 7
    ds_read_b128 a[32:35], v164 offset:0
    s_lshl_b32 s54, s55, 19
    s_add_u32 s55, s55, 1
    s_cmp_eq_u32 s55, 7
    s_cselect_b32 s55, 0, s55
    s_add_u32 m0, s35, 116736
    v_add_u32 v162, s53, v160
    v_add_u32 v163, s54, v161
    v_mfma_f32_16x16x32_bf16 v[48:51], a[96:99], a[48:51], v[48:51]
    buffer_load_dwordx4 v162, s[12:15], s96 offen lds
    ds_read_b128 a[36:39], v164 offset:2048
    v_mfma_f32_16x16x32_bf16 v[80:83], a[96:99], a[52:55], v[80:83]
    ds_read_b128 a[40:43], v164 offset:4096
    v_mfma_f32_16x16x32_bf16 v[20:23], a[100:103], a[44:47], v[20:23]
    ds_read_b64_tr_b16 a[64:65], v170 offset:0
    v_mfma_f32_16x16x32_bf16 v[52:55], a[100:103], a[48:51], v[52:55]
    s_add_u32 m0, s52, 116736
    ds_read_b64_tr_b16 a[66:67], v170 offset:256
    v_mfma_f32_16x16x32_bf16 v[84:87], a[100:103], a[52:55], v[84:87]
    buffer_load_dwordx4 v163, s[16:19], s60 offen lds
    ds_read_b64_tr_b16 a[68:69], v170 offset:32
    v_mfma_f32_16x16x32_bf16 v[24:27], a[104:107], a[44:47], v[24:27]
    ds_read_b64_tr_b16 a[70:71], v170 offset:288
    v_mfma_f32_16x16x32_bf16 v[56:59], a[104:107], a[48:51], v[56:59]
    s_add_u32 m0, s35, 117760
    v_mfma_f32_16x16x32_bf16 v[88:91], a[104:107], a[52:55], v[88:91]
    buffer_load_dwordx4 v162, s[12:15], s97 offen lds
    ds_read_b64_tr_b16 a[72:73], v170 offset:64
    v_mfma_f32_16x16x32_bf16 v[28:31], a[108:111], a[44:47], v[28:31]
    ds_read_b64_tr_b16 a[74:75], v170 offset:320
    v_mfma_f32_16x16x32_bf16 v[60:63], a[108:111], a[48:51], v[60:63]
    ds_read_b64_tr_b16 a[76:77], v170 offset:96
    v_mfma_f32_16x16x32_bf16 v[92:95], a[108:111], a[52:55], v[92:95]
    ds_read_b64_tr_b16 a[78:79], v170 offset:352
    s_add_u32 m0, s52, 117792
    v_mfma_f32_16x16x32_bf16 v[32:35], a[112:115], a[44:47], v[32:35]
    buffer_load_dwordx4 v163, s[16:19], s61 offen lds
    ds_read_b64_tr_b16 a[80:81], v170 offset:128
    v_mfma_f32_16x16x32_bf16 v[64:67], a[112:115], a[48:51], v[64:67]
    ds_read_b64_tr_b16 a[82:83], v170 offset:384
    v_mfma_f32_16x16x32_bf16 v[96:99], a[112:115], a[52:55], v[96:99]
    s_add_u32 m0, s35, 118784
    v_mfma_f32_16x16x32_bf16 v[36:39], a[116:119], a[44:47], v[36:39]
    buffer_load_dwordx4 v162, s[12:15], s98 offen lds
    ds_read_b64_tr_b16 a[84:85], v170 offset:160
    v_mfma_f32_16x16x32_bf16 v[68:71], a[116:119], a[48:51], v[68:71]
    ds_read_b64_tr_b16 a[86:87], v170 offset:416
    v_mfma_f32_16x16x32_bf16 v[100:103], a[116:119], a[52:55], v[100:103]
    s_add_u32 m0, s28, 8448
    ds_read_b64_tr_b16 a[88:89], v170 offset:192
    v_mfma_f32_16x16x32_bf16 v[40:43], a[120:123], a[44:47], v[40:43]
    buffer_load_dwordx4 v228, s[8:11], s27 offen nt lds
    ds_read_b64_tr_b16 a[90:91], v170 offset:448
    v_mfma_f32_16x16x32_bf16 v[72:75], a[120:123], a[48:51], v[72:75]
    ds_read_b64_tr_b16 a[92:93], v170 offset:224
    v_mfma_f32_16x16x32_bf16 v[104:107], a[120:123], a[52:55], v[104:107]
    ds_read_b64_tr_b16 a[94:95], v170 offset:480
    v_mfma_f32_16x16x32_bf16 v[44:47], a[124:127], a[44:47], v[44:47]
    s_add_u32 m0, s28, 9248
    v_mfma_f32_16x16x32_bf16 v[76:79], a[124:127], a[48:51], v[76:79]
    buffer_load_dwordx4 v228, s[8:11], s27 offen offset:256 nt lds
    v_mfma_f32_16x16x32_bf16 v[108:111], a[124:127], a[52:55], v[108:111]
    s_waitcnt lgkmcnt(8)
    v_mfma_f32_16x16x32_bf16 v[16:19], a[64:67], a[32:35], v[16:19]
    s_add_u32 m0, s52, 125184
    ds_read_b128 a[44:47], v165 offset:0
    v_mfma_f32_16x16x32_bf16 v[48:51], a[64:67], a[36:39], v[48:51]
    buffer_load_dwordx4 v163, s[16:19], s62 offen lds
    ds_read_b128 a[48:51], v165 offset:2048
    v_mfma_f32_16x16x32_bf16 v[80:83], a[64:67], a[40:43], v[80:83]
    ds_read_b128 a[52:55], v165 offset:4096
    v_mfma_f32_16x16x32_bf16 v[20:23], a[68:71], a[32:35], v[20:23]
    ds_read_b64_tr_b16 a[96:97], v170 offset:8448
    v_mfma_f32_16x16x32_bf16 v[52:55], a[68:71], a[36:39], v[52:55]
    s_add_u32 m0, s35, 119808
    ds_read_b64_tr_b16 a[98:99], v170 offset:8704
    v_mfma_f32_16x16x32_bf16 v[84:87], a[68:71], a[40:43], v[84:87]
    buffer_load_dwordx4 v162, s[12:15], s99 offen lds
    ds_read_b64_tr_b16 a[100:101], v170 offset:8480
    v_mfma_f32_16x16x32_bf16 v[24:27], a[72:75], a[32:35], v[24:27]
    ds_read_b64_tr_b16 a[102:103], v170 offset:8736
    v_mfma_f32_16x16x32_bf16 v[56:59], a[72:75], a[36:39], v[56:59]
    s_add_u32 m0, s52, 126240
    v_mfma_f32_16x16x32_bf16 v[88:91], a[72:75], a[40:43], v[88:91]
    buffer_load_dwordx4 v163, s[16:19], s63 offen lds
    ds_read_b64_tr_b16 a[104:105], v170 offset:8512
    v_mfma_f32_16x16x32_bf16 v[28:31], a[76:79], a[32:35], v[28:31]
    ds_read_b64_tr_b16 a[106:107], v170 offset:8768
    v_mfma_f32_16x16x32_bf16 v[60:63], a[76:79], a[36:39], v[60:63]
    ds_read_b64_tr_b16 a[108:109], v170 offset:8544
    v_mfma_f32_16x16x32_bf16 v[92:95], a[76:79], a[40:43], v[92:95]
    s_waitcnt lgkmcnt(10)
    ds_read_b64_tr_b16 a[110:111], v170 offset:8800
    s_add_u32 m0, s35, 120832
    v_mfma_f32_16x16x32_bf16 v[32:35], a[80:83], a[32:35], v[32:35]
    buffer_load_dwordx4 v162, s[12:15], s100 offen lds
    ds_read_b64_tr_b16 a[112:113], v170 offset:8576
    v_mfma_f32_16x16x32_bf16 v[64:67], a[80:83], a[36:39], v[64:67]
    ds_read_b64_tr_b16 a[114:115], v170 offset:8832
    v_mfma_f32_16x16x32_bf16 v[96:99], a[80:83], a[40:43], v[96:99]
    s_add_u32 m0, s35, 121856
    v_mfma_f32_16x16x32_bf16 v[36:39], a[84:87], a[32:35], v[36:39]
    buffer_load_dwordx4 v162, s[12:15], s101 offen lds
    ds_read_b64_tr_b16 a[116:117], v170 offset:8608
    v_mfma_f32_16x16x32_bf16 v[68:71], a[84:87], a[36:39], v[68:71]
    ds_read_b64_tr_b16 a[118:119], v170 offset:8864
    v_mfma_f32_16x16x32_bf16 v[100:103], a[84:87], a[40:43], v[100:103]
    s_add_u32 m0, s28, 16896
    ds_read_b64_tr_b16 a[120:121], v170 offset:8640
    v_mfma_f32_16x16x32_bf16 v[40:43], a[88:91], a[32:35], v[40:43]
    buffer_load_dwordx4 v229, s[4:7], s27 offen nt lds
    ds_read_b64_tr_b16 a[122:123], v170 offset:8896
    v_mfma_f32_16x16x32_bf16 v[72:75], a[88:91], a[36:39], v[72:75]
    ds_read_b64_tr_b16 a[124:125], v170 offset:8672
    v_mfma_f32_16x16x32_bf16 v[104:107], a[88:91], a[40:43], v[104:107]
    ds_read_b64_tr_b16 a[126:127], v170 offset:8928
    v_mfma_f32_16x16x32_bf16 v[44:47], a[92:95], a[32:35], v[44:47]
    s_add_u32 m0, s28, 17696
    v_mfma_f32_16x16x32_bf16 v[76:79], a[92:95], a[36:39], v[76:79]
    buffer_load_dwordx4 v229, s[4:7], s27 offen offset:256 nt lds
    v_mfma_f32_16x16x32_bf16 v[108:111], a[92:95], a[40:43], v[108:111]
    s_waitcnt vmcnt(15) lgkmcnt(0)
    s_barrier
    v_mfma_f32_16x16x32_bf16 v[16:19], a[96:99], a[44:47], v[16:19]
    ds_read_b128 a[32:35], v166 offset:0
    v_mfma_f32_16x16x32_bf16 v[48:51], a[96:99], a[48:51], v[48:51]
    ds_read_b128 a[36:39], v166 offset:2048
    v_mfma_f32_16x16x32_bf16 v[80:83], a[96:99], a[52:55], v[80:83]
    ds_read_b128 a[40:43], v166 offset:4096
    v_mfma_f32_16x16x32_bf16 v[20:23], a[100:103], a[44:47], v[20:23]
    ds_read_b64_tr_b16 a[64:65], v171 offset:0
    v_mfma_f32_16x16x32_bf16 v[52:55], a[100:103], a[48:51], v[52:55]
    ds_read_b64_tr_b16 a[66:67], v171 offset:256
    v_mfma_f32_16x16x32_bf16 v[84:87], a[100:103], a[52:55], v[84:87]
    s_add_u32 m0, s28, 25344
    ds_read_b64_tr_b16 a[68:69], v171 offset:32
    v_mfma_f32_16x16x32_bf16 v[24:27], a[104:107], a[44:47], v[24:27]
    buffer_load_dwordx4 v229, s[8:11], s27 offen nt lds
    v_mfma_f32_16x16x32_bf16 v[56:59], a[104:107], a[48:51], v[56:59]
    ds_read_b64_tr_b16 a[70:71], v171 offset:288
    v_mfma_f32_16x16x32_bf16 v[88:91], a[104:107], a[52:55], v[88:91]
    ds_read_b64_tr_b16 a[72:73], v171 offset:64
    v_mfma_f32_16x16x32_bf16 v[28:31], a[108:111], a[44:47], v[28:31]
    ds_read_b64_tr_b16 a[74:75], v171 offset:320
    v_mfma_f32_16x16x32_bf16 v[60:63], a[108:111], a[48:51], v[60:63]
    ds_read_b64_tr_b16 a[76:77], v171 offset:96
    v_mfma_f32_16x16x32_bf16 v[92:95], a[108:111], a[52:55], v[92:95]
    v_mfma_f32_16x16x32_bf16 v[32:35], a[112:115], a[44:47], v[32:35]
    ds_read_b64_tr_b16 a[78:79], v171 offset:352
    v_mfma_f32_16x16x32_bf16 v[64:67], a[112:115], a[48:51], v[64:67]
    ds_read_b64_tr_b16 a[80:81], v171 offset:128
    v_mfma_f32_16x16x32_bf16 v[96:99], a[112:115], a[52:55], v[96:99]
    ds_read_b64_tr_b16 a[82:83], v171 offset:384
    v_mfma_f32_16x16x32_bf16 v[36:39], a[116:119], a[44:47], v[36:39]
    ds_read_b64_tr_b16 a[84:85], v171 offset:160
    v_mfma_f32_16x16x32_bf16 v[68:71], a[116:119], a[48:51], v[68:71]
    ds_read_b64_tr_b16 a[86:87], v171 offset:416
    v_mfma_f32_16x16x32_bf16 v[100:103], a[116:119], a[52:55], v[100:103]
    s_add_u32 m0, s28, 26144
    ds_read_b64_tr_b16 a[88:89], v171 offset:192
    v_mfma_f32_16x16x32_bf16 v[40:43], a[120:123], a[44:47], v[40:43]
    buffer_load_dwordx4 v229, s[8:11], s27 offen offset:256 nt lds
    v_mfma_f32_16x16x32_bf16 v[72:75], a[120:123], a[48:51], v[72:75]
    ds_read_b64_tr_b16 a[90:91], v171 offset:448
    v_mfma_f32_16x16x32_bf16 v[104:107], a[120:123], a[52:55], v[104:107]
    ds_read_b64_tr_b16 a[92:93], v171 offset:224
    v_mfma_f32_16x16x32_bf16 v[44:47], a[124:127], a[44:47], v[44:47]
    ds_read_b64_tr_b16 a[94:95], v171 offset:480
    v_mfma_f32_16x16x32_bf16 v[76:79], a[124:127], a[48:51], v[76:79]
    v_mfma_f32_16x16x32_bf16 v[108:111], a[124:127], a[52:55], v[108:111]
    s_waitcnt lgkmcnt(8)
    v_mfma_f32_16x16x32_bf16 v[16:19], a[64:67], a[32:35], v[16:19]
    ds_read_b128 a[44:47], v167 offset:0
    v_mfma_f32_16x16x32_bf16 v[48:51], a[64:67], a[36:39], v[48:51]
    ds_read_b128 a[48:51], v167 offset:2048
    v_mfma_f32_16x16x32_bf16 v[80:83], a[64:67], a[40:43], v[80:83]
    ds_read_b128 a[52:55], v167 offset:4096
    v_mfma_f32_16x16x32_bf16 v[20:23], a[68:71], a[32:35], v[20:23]
    ds_read_b64_tr_b16 a[96:97], v171 offset:8448
    v_mfma_f32_16x16x32_bf16 v[52:55], a[68:71], a[36:39], v[52:55]
    s_mov_b32 s27, 16384
    ds_read_b64_tr_b16 a[98:99], v171 offset:8704
    v_mfma_f32_16x16x32_bf16 v[84:87], a[68:71], a[40:43], v[84:87]
    s_add_u32 m0, s28, 33792
    ds_read_b64_tr_b16 a[100:101], v171 offset:8480
    v_mfma_f32_16x16x32_bf16 v[24:27], a[72:75], a[32:35], v[24:27]
    buffer_load_dwordx4 v228, s[4:7], s27 offen nt lds
    v_mfma_f32_16x16x32_bf16 v[56:59], a[72:75], a[36:39], v[56:59]
    ds_read_b64_tr_b16 a[102:103], v171 offset:8736
    v_mfma_f32_16x16x32_bf16 v[88:91], a[72:75], a[40:43], v[88:91]
    ds_read_b64_tr_b16 a[104:105], v171 offset:8512
    v_mfma_f32_16x16x32_bf16 v[28:31], a[76:79], a[32:35], v[28:31]
    ds_read_b64_tr_b16 a[106:107], v171 offset:8768
    v_mfma_f32_16x16x32_bf16 v[60:63], a[76:79], a[36:39], v[60:63]
    ds_read_b64_tr_b16 a[108:109], v171 offset:8544
    v_mfma_f32_16x16x32_bf16 v[92:95], a[76:79], a[40:43], v[92:95]
    s_waitcnt lgkmcnt(10)
    v_mfma_f32_16x16x32_bf16 v[32:35], a[80:83], a[32:35], v[32:35]
    ds_read_b64_tr_b16 a[110:111], v171 offset:8800
    v_mfma_f32_16x16x32_bf16 v[64:67], a[80:83], a[36:39], v[64:67]
    ds_read_b64_tr_b16 a[112:113], v171 offset:8576
    v_mfma_f32_16x16x32_bf16 v[96:99], a[80:83], a[40:43], v[96:99]
    ds_read_b64_tr_b16 a[114:115], v171 offset:8832
    v_mfma_f32_16x16x32_bf16 v[36:39], a[84:87], a[32:35], v[36:39]
    ds_read_b64_tr_b16 a[116:117], v171 offset:8608
    v_mfma_f32_16x16x32_bf16 v[68:71], a[84:87], a[36:39], v[68:71]
    ds_read_b64_tr_b16 a[118:119], v171 offset:8864
    v_mfma_f32_16x16x32_bf16 v[100:103], a[84:87], a[40:43], v[100:103]
    s_add_u32 m0, s28, 34592
    ds_read_b64_tr_b16 a[120:121], v171 offset:8640
    v_mfma_f32_16x16x32_bf16 v[40:43], a[88:91], a[32:35], v[40:43]
    buffer_load_dwordx4 v228, s[4:7], s27 offen offset:256 nt lds
    v_mfma_f32_16x16x32_bf16 v[72:75], a[88:91], a[36:39], v[72:75]
    ds_read_b64_tr_b16 a[122:123], v171 offset:8896
    v_mfma_f32_16x16x32_bf16 v[104:107], a[88:91], a[40:43], v[104:107]
    ds_read_b64_tr_b16 a[124:125], v171 offset:8672
    v_mfma_f32_16x16x32_bf16 v[44:47], a[92:95], a[32:35], v[44:47]
    ds_read_b64_tr_b16 a[126:127], v171 offset:8928
    v_mfma_f32_16x16x32_bf16 v[76:79], a[92:95], a[36:39], v[76:79]
    v_mfma_f32_16x16x32_bf16 v[108:111], a[92:95], a[40:43], v[108:111]
    s_waitcnt vmcnt(6) lgkmcnt(0)
    s_barrier
    v_mfma_f32_16x16x32_bf16 v[16:19], a[96:99], a[44:47], v[16:19]
    ds_read_b128 a[32:35], v168 offset:0
    v_mfma_f32_16x16x32_bf16 v[48:51], a[96:99], a[48:51], v[48:51]
    ds_read_b128 a[36:39], v168 offset:2048
    v_mfma_f32_16x16x32_bf16 v[80:83], a[96:99], a[52:55], v[80:83]
    ds_read_b128 a[40:43], v168 offset:4096
    v_mfma_f32_16x16x32_bf16 v[20:23], a[100:103], a[44:47], v[20:23]
    ds_read_b64_tr_b16 a[64:65], v172 offset:0
    v_mfma_f32_16x16x32_bf16 v[52:55], a[100:103], a[48:51], v[52:55]
    ds_read_b64_tr_b16 a[66:67], v172 offset:256
    v_mfma_f32_16x16x32_bf16 v[84:87], a[100:103], a[52:55], v[84:87]
    s_add_u32 m0, s28, 42240
    ds_read_b64_tr_b16 a[68:69], v172 offset:32
    v_mfma_f32_16x16x32_bf16 v[24:27], a[104:107], a[44:47], v[24:27]
    buffer_load_dwordx4 v228, s[8:11], s27 offen nt lds
    v_mfma_f32_16x16x32_bf16 v[56:59], a[104:107], a[48:51], v[56:59]
    ds_read_b64_tr_b16 a[70:71], v172 offset:288
    v_mfma_f32_16x16x32_bf16 v[88:91], a[104:107], a[52:55], v[88:91]
    ds_read_b64_tr_b16 a[72:73], v172 offset:64
    v_mfma_f32_16x16x32_bf16 v[28:31], a[108:111], a[44:47], v[28:31]
    ds_read_b64_tr_b16 a[74:75], v172 offset:320
    v_mfma_f32_16x16x32_bf16 v[60:63], a[108:111], a[48:51], v[60:63]
    ds_read_b64_tr_b16 a[76:77], v172 offset:96
    v_mfma_f32_16x16x32_bf16 v[92:95], a[108:111], a[52:55], v[92:95]
    v_mfma_f32_16x16x32_bf16 v[32:35], a[112:115], a[44:47], v[32:35]
    ds_read_b64_tr_b16 a[78:79], v172 offset:352
    v_mfma_f32_16x16x32_bf16 v[64:67], a[112:115], a[48:51], v[64:67]
    ds_read_b64_tr_b16 a[80:81], v172 offset:128
    v_mfma_f32_16x16x32_bf16 v[96:99], a[112:115], a[52:55], v[96:99]
    ds_read_b64_tr_b16 a[82:83], v172 offset:384
    v_mfma_f32_16x16x32_bf16 v[36:39], a[116:119], a[44:47], v[36:39]
    ds_read_b64_tr_b16 a[84:85], v172 offset:160
    v_mfma_f32_16x16x32_bf16 v[68:71], a[116:119], a[48:51], v[68:71]
    ds_read_b64_tr_b16 a[86:87], v172 offset:416
    v_mfma_f32_16x16x32_bf16 v[100:103], a[116:119], a[52:55], v[100:103]
    s_add_u32 m0, s28, 43040
    ds_read_b64_tr_b16 a[88:89], v172 offset:192
    v_mfma_f32_16x16x32_bf16 v[40:43], a[120:123], a[44:47], v[40:43]
    buffer_load_dwordx4 v228, s[8:11], s27 offen offset:256 nt lds
    v_mfma_f32_16x16x32_bf16 v[72:75], a[120:123], a[48:51], v[72:75]
    ds_read_b64_tr_b16 a[90:91], v172 offset:448
    v_mfma_f32_16x16x32_bf16 v[104:107], a[120:123], a[52:55], v[104:107]
    ds_read_b64_tr_b16 a[92:93], v172 offset:224
    v_mfma_f32_16x16x32_bf16 v[44:47], a[124:127], a[44:47], v[44:47]
    ds_read_b64_tr_b16 a[94:95], v172 offset:480
    v_mfma_f32_16x16x32_bf16 v[76:79], a[124:127], a[48:51], v[76:79]
    v_mfma_f32_16x16x32_bf16 v[108:111], a[124:127], a[52:55], v[108:111]
    s_waitcnt lgkmcnt(8)
    v_mfma_f32_16x16x32_bf16 v[16:19], a[64:67], a[32:35], v[16:19]
    ds_read_b128 a[44:47], v169 offset:0
    v_mfma_f32_16x16x32_bf16 v[48:51], a[64:67], a[36:39], v[48:51]
    ds_read_b128 a[48:51], v169 offset:2048
    v_mfma_f32_16x16x32_bf16 v[80:83], a[64:67], a[40:43], v[80:83]
    ds_read_b128 a[52:55], v169 offset:4096
    v_mfma_f32_16x16x32_bf16 v[20:23], a[68:71], a[32:35], v[20:23]
    ds_read_b64_tr_b16 a[96:97], v172 offset:8448
    v_mfma_f32_16x16x32_bf16 v[52:55], a[68:71], a[36:39], v[52:55]
    ds_read_b64_tr_b16 a[98:99], v172 offset:8704
    v_mfma_f32_16x16x32_bf16 v[84:87], a[68:71], a[40:43], v[84:87]
    s_add_u32 m0, s28, 50688
    ds_read_b64_tr_b16 a[100:101], v172 offset:8480
    v_mfma_f32_16x16x32_bf16 v[24:27], a[72:75], a[32:35], v[24:27]
    buffer_load_dwordx4 v229, s[4:7], s27 offen nt lds
    v_mfma_f32_16x16x32_bf16 v[56:59], a[72:75], a[36:39], v[56:59]
    ds_read_b64_tr_b16 a[102:103], v172 offset:8736
    v_mfma_f32_16x16x32_bf16 v[88:91], a[72:75], a[40:43], v[88:91]
    ds_read_b64_tr_b16 a[104:105], v172 offset:8512
    v_mfma_f32_16x16x32_bf16 v[28:31], a[76:79], a[32:35], v[28:31]
    ds_read_b64_tr_b16 a[106:107], v172 offset:8768
    v_mfma_f32_16x16x32_bf16 v[60:63], a[76:79], a[36:39], v[60:63]
    ds_read_b64_tr_b16 a[108:109], v172 offset:8544
    v_mfma_f32_16x16x32_bf16 v[92:95], a[76:79], a[40:43], v[92:95]
    s_waitcnt lgkmcnt(10)
    v_mfma_f32_16x16x32_bf16 v[32:35], a[80:83], a[32:35], v[32:35]
    ds_read_b64_tr_b16 a[110:111], v172 offset:8800
    v_mfma_f32_16x16x32_bf16 v[64:67], a[80:83], a[36:39], v[64:67]
    ds_read_b64_tr_b16 a[112:113], v172 offset:8576
    v_mfma_f32_16x16x32_bf16 v[96:99], a[80:83], a[40:43], v[96:99]
    ds_read_b64_tr_b16 a[114:115], v172 offset:8832
    v_mfma_f32_16x16x32_bf16 v[36:39], a[84:87], a[32:35], v[36:39]
    ds_read_b64_tr_b16 a[116:117], v172 offset:8608
    v_mfma_f32_16x16x32_bf16 v[68:71], a[84:87], a[36:39], v[68:71]
    ds_read_b64_tr_b16 a[118:119], v172 offset:8864
    v_mfma_f32_16x16x32_bf16 v[100:103], a[84:87], a[40:43], v[100:103]
    s_add_u32 m0, s28, 51488
    ds_read_b64_tr_b16 a[120:121], v172 offset:8640
    v_mfma_f32_16x16x32_bf16 v[40:43], a[88:91], a[32:35], v[40:43]
    buffer_load_dwordx4 v229, s[4:7], s27 offen offset:256 nt lds
    v_mfma_f32_16x16x32_bf16 v[72:75], a[88:91], a[36:39], v[72:75]
    ds_read_b64_tr_b16 a[122:123], v172 offset:8896
    v_mfma_f32_16x16x32_bf16 v[104:107], a[88:91], a[40:43], v[104:107]
    ds_read_b64_tr_b16 a[124:125], v172 offset:8672
    v_mfma_f32_16x16x32_bf16 v[44:47], a[92:95], a[32:35], v[44:47]
    ds_read_b64_tr_b16 a[126:127], v172 offset:8928
    v_mfma_f32_16x16x32_bf16 v[76:79], a[92:95], a[36:39], v[76:79]
    v_mfma_f32_16x16x32_bf16 v[108:111], a[92:95], a[40:43], v[108:111]
    s_waitcnt vmcnt(6) lgkmcnt(0)
    s_barrier
    v_mfma_f32_16x16x32_bf16 v[16:19], a[96:99], a[44:47], v[16:19]
    ds_read_b128 a[0:3], v224 offset:0
    v_mfma_f32_16x16x32_bf16 v[48:51], a[96:99], a[48:51], v[48:51]
    v_mfma_f32_16x16x32_bf16 v[80:83], a[96:99], a[52:55], v[80:83]
    ds_read_b128 a[16:19], v224 offset:512
    v_mfma_f32_16x16x32_bf16 v[20:23], a[100:103], a[44:47], v[20:23]
    v_mfma_f32_16x16x32_bf16 v[52:55], a[100:103], a[48:51], v[52:55]
    v_mfma_f32_16x16x32_bf16 v[84:87], a[100:103], a[52:55], v[84:87]
    s_add_u32 m0, s28, 59136
    ds_read_b128 a[4:7], v224 offset:64
    v_mfma_f32_16x16x32_bf16 v[24:27], a[104:107], a[44:47], v[24:27]
    buffer_load_dwordx4 v229, s[8:11], s27 offen nt lds
    v_mfma_f32_16x16x32_bf16 v[56:59], a[104:107], a[48:51], v[56:59]
    v_mfma_f32_16x16x32_bf16 v[88:91], a[104:107], a[52:55], v[88:91]
    ds_read_b128 a[20:23], v224 offset:576
    v_mfma_f32_16x16x32_bf16 v[28:31], a[108:111], a[44:47], v[28:31]
    v_mfma_f32_16x16x32_bf16 v[60:63], a[108:111], a[48:51], v[60:63]
    v_mfma_f32_16x16x32_bf16 v[92:95], a[108:111], a[52:55], v[92:95]
    ds_read_b128 a[8:11], v224 offset:128
    v_mfma_f32_16x16x32_bf16 v[32:35], a[112:115], a[44:47], v[32:35]
    v_mfma_f32_16x16x32_bf16 v[64:67], a[112:115], a[48:51], v[64:67]
    v_mfma_f32_16x16x32_bf16 v[96:99], a[112:115], a[52:55], v[96:99]
    ds_read_b128 a[24:27], v224 offset:640
    v_mfma_f32_16x16x32_bf16 v[36:39], a[116:119], a[44:47], v[36:39]
    v_mfma_f32_16x16x32_bf16 v[68:71], a[116:119], a[48:51], v[68:71]
    ds_read_b128 a[12:15], v224 offset:192
    v_mfma_f32_16x16x32_bf16 v[100:103], a[116:119], a[52:55], v[100:103]
    s_add_u32 m0, s28, 59936
    v_mfma_f32_16x16x32_bf16 v[40:43], a[120:123], a[44:47], v[40:43]
    buffer_load_dwordx4 v229, s[8:11], s27 offen offset:256 nt lds
    v_mfma_f32_16x16x32_bf16 v[72:75], a[120:123], a[48:51], v[72:75]
    v_mfma_f32_16x16x32_bf16 v[104:107], a[120:123], a[52:55], v[104:107]
    ds_read_b128 a[28:31], v224 offset:704
    v_mfma_f32_16x16x32_bf16 v[44:47], a[124:127], a[44:47], v[44:47]
    v_mfma_f32_16x16x32_bf16 v[76:79], a[124:127], a[48:51], v[76:79]
    v_mfma_f32_16x16x32_bf16 v[108:111], a[124:127], a[52:55], v[108:111]
    v_mov_b32 v208, 0x3e0293ee
    s_mov_b32 s27, 32768
    s_add_u32 m0, s28, 67584
    s_nop 0
    buffer_load_dwordx4 v228, s[4:7], s27 offen nt lds
    v_pk_mul_f32 v[16:17], v[16:17], v[208:209] op_sel_hi:[1,0]
    v_pk_mul_f32 v[18:19], v[18:19], v[208:209] op_sel_hi:[1,0]
    v_pk_mul_f32 v[20:21], v[20:21], v[208:209] op_sel_hi:[1,0]
    v_pk_mul_f32 v[22:23], v[22:23], v[208:209] op_sel_hi:[1,0]
    v_pk_mul_f32 v[24:25], v[24:25], v[208:209] op_sel_hi:[1,0]
    v_pk_mul_f32 v[26:27], v[26:27], v[208:209] op_sel_hi:[1,0]
    v_pk_mul_f32 v[28:29], v[28:29], v[208:209] op_sel_hi:[1,0]
    v_pk_mul_f32 v[30:31], v[30:31], v[208:209] op_sel_hi:[1,0]
    v_pk_mul_f32 v[32:33], v[32:33], v[208:209] op_sel_hi:[1,0]
    v_pk_mul_f32 v[34:35], v[34:35], v[208:209] op_sel_hi:[1,0]
    v_pk_mul_f32 v[36:37], v[36:37], v[208:209] op_sel_hi:[1,0]
    v_pk_mul_f32 v[38:39], v[38:39], v[208:209] op_sel_hi:[1,0]
    v_pk_mul_f32 v[40:41], v[40:41], v[208:209] op_sel_hi:[1,0]
    v_pk_mul_f32 v[42:43], v[42:43], v[208:209] op_sel_hi:[1,0]
    v_pk_mul_f32 v[44:45], v[44:45], v[208:209] op_sel_hi:[1,0]
    v_pk_mul_f32 v[46:47], v[46:47], v[208:209] op_sel_hi:[1,0]
    v_cvt_pk_bf16_f32 v112, v16, v17
    v_cvt_pk_bf16_f32 v113, v18, v19
    v_cvt_pk_bf16_f32 v114, v20, v21
    v_cvt_pk_bf16_f32 v115, v22, v23
    v_cvt_pk_bf16_f32 v116, v24, v25
    v_cvt_pk_bf16_f32 v117, v26, v27
    v_cvt_pk_bf16_f32 v118, v28, v29
    v_cvt_pk_bf16_f32 v119, v30, v31
    v_cvt_pk_bf16_f32 v120, v32, v33
    v_cvt_pk_bf16_f32 v121, v34, v35
    v_cvt_pk_bf16_f32 v122, v36, v37
    v_cvt_pk_bf16_f32 v123, v38, v39
    v_cvt_pk_bf16_f32 v124, v40, v41
    v_cvt_pk_bf16_f32 v125, v42, v43
    v_cvt_pk_bf16_f32 v126, v44, v45
    v_cvt_pk_bf16_f32 v127, v46, v47
    v_permlane32_swap_b32 v112, v114
    v_permlane32_swap_b32 v113, v115
    v_permlane32_swap_b32 v116, v118
    v_permlane32_swap_b32 v117, v119
    v_permlane32_swap_b32 v120, v122
    v_permlane32_swap_b32 v121, v123
    v_permlane32_swap_b32 v124, v126
    v_permlane32_swap_b32 v125, v127
    v_permlane16_swap_b32 v112, v114
    v_permlane16_swap_b32 v113, v115
    v_permlane16_swap_b32 v116, v118
    v_permlane16_swap_b32 v117, v119
    v_permlane16_swap_b32 v120, v122
    v_permlane16_swap_b32 v121, v123
    v_permlane16_swap_b32 v124, v126
    v_permlane16_swap_b32 v125, v127
    s_add_u32 m0, s28, 68384
    s_nop 0
    buffer_load_dwordx4 v228, s[4:7], s27 offen offset:256 nt lds
    s_add_u32 m0, s28, 76032
    s_nop 0
    buffer_load_dwordx4 v228, s[8:11], s27 offen nt lds
    v_pk_mul_f32 v[48:49], v[48:49], v[208:209] op_sel_hi:[1,0]
    v_pk_mul_f32 v[50:51], v[50:51], v[208:209] op_sel_hi:[1,0]
    v_pk_mul_f32 v[52:53], v[52:53], v[208:209] op_sel_hi:[1,0]
    v_pk_mul_f32 v[54:55], v[54:55], v[208:209] op_sel_hi:[1,0]
    v_pk_mul_f32 v[56:57], v[56:57], v[208:209] op_sel_hi:[1,0]
    v_pk_mul_f32 v[58:59], v[58:59], v[208:209] op_sel_hi:[1,0]
    v_pk_mul_f32 v[60:61], v[60:61], v[208:209] op_sel_hi:[1,0]
    v_pk_mul_f32 v[62:63], v[62:63], v[208:209] op_sel_hi:[1,0]
    v_pk_mul_f32 v[64:65], v[64:65], v[208:209] op_sel_hi:[1,0]
    v_pk_mul_f32 v[66:67], v[66:67], v[208:209] op_sel_hi:[1,0]
    v_pk_mul_f32 v[68:69], v[68:69], v[208:209] op_sel_hi:[1,0]
    v_pk_mul_f32 v[70:71], v[70:71], v[208:209] op_sel_hi:[1,0]
    v_pk_mul_f32 v[72:73], v[72:73], v[208:209] op_sel_hi:[1,0]
    v_pk_mul_f32 v[74:75], v[74:75], v[208:209] op_sel_hi:[1,0]
    v_pk_mul_f32 v[76:77], v[76:77], v[208:209] op_sel_hi:[1,0]
    v_pk_mul_f32 v[78:79], v[78:79], v[208:209] op_sel_hi:[1,0]
    v_cvt_pk_bf16_f32 v128, v48, v49
    v_cvt_pk_bf16_f32 v129, v50, v51
    v_cvt_pk_bf16_f32 v130, v52, v53
    v_cvt_pk_bf16_f32 v131, v54, v55
    v_cvt_pk_bf16_f32 v132, v56, v57
    v_cvt_pk_bf16_f32 v133, v58, v59
    v_cvt_pk_bf16_f32 v134, v60, v61
    v_cvt_pk_bf16_f32 v135, v62, v63
    v_cvt_pk_bf16_f32 v136, v64, v65
    v_cvt_pk_bf16_f32 v137, v66, v67
    v_cvt_pk_bf16_f32 v138, v68, v69
    v_cvt_pk_bf16_f32 v139, v70, v71
    v_cvt_pk_bf16_f32 v140, v72, v73
    v_cvt_pk_bf16_f32 v141, v74, v75
    v_cvt_pk_bf16_f32 v142, v76, v77
    v_cvt_pk_bf16_f32 v143, v78, v79
    v_permlane32_swap_b32 v128, v130
    v_permlane32_swap_b32 v129, v131
    v_permlane32_swap_b32 v132, v134
    v_permlane32_swap_b32 v133, v135
    v_permlane32_swap_b32 v136, v138
    v_permlane32_swap_b32 v137, v139
    v_permlane32_swap_b32 v140, v142
    v_permlane32_swap_b32 v141, v143
    v_permlane16_swap_b32 v128, v130
    v_permlane16_swap_b32 v129, v131
    v_permlane16_swap_b32 v132, v134
    v_permlane16_swap_b32 v133, v135
    v_permlane16_swap_b32 v136, v138
    v_permlane16_swap_b32 v137, v139
    v_permlane16_swap_b32 v140, v142
    v_permlane16_swap_b32 v141, v143
    v_pk_mul_f32 v[80:81], v[80:81], v[208:209] op_sel_hi:[1,0]
    v_pk_mul_f32 v[82:83], v[82:83], v[208:209] op_sel_hi:[1,0]
    v_pk_mul_f32 v[84:85], v[84:85], v[208:209] op_sel_hi:[1,0]
    v_pk_mul_f32 v[86:87], v[86:87], v[208:209] op_sel_hi:[1,0]
    v_pk_mul_f32 v[88:89], v[88:89], v[208:209] op_sel_hi:[1,0]
    v_pk_mul_f32 v[90:91], v[90:91], v[208:209] op_sel_hi:[1,0]
    v_pk_mul_f32 v[92:93], v[92:93], v[208:209] op_sel_hi:[1,0]
    v_pk_mul_f32 v[94:95], v[94:95], v[208:209] op_sel_hi:[1,0]
    v_pk_mul_f32 v[96:97], v[96:97], v[208:209] op_sel_hi:[1,0]
    v_pk_mul_f32 v[98:99], v[98:99], v[208:209] op_sel_hi:[1,0]
    v_pk_mul_f32 v[100:101], v[100:101], v[208:209] op_sel_hi:[1,0]
    v_pk_mul_f32 v[102:103], v[102:103], v[208:209] op_sel_hi:[1,0]
    v_pk_mul_f32 v[104:105], v[104:105], v[208:209] op_sel_hi:[1,0]
    v_pk_mul_f32 v[106:107], v[106:107], v[208:209] op_sel_hi:[1,0]
    v_pk_mul_f32 v[108:109], v[108:109], v[208:209] op_sel_hi:[1,0]
    v_pk_mul_f32 v[110:111], v[110:111], v[208:209] op_sel_hi:[1,0]
    v_cvt_pk_bf16_f32 v144, v80, v81
    v_cvt_pk_bf16_f32 v145, v82, v83
    v_cvt_pk_bf16_f32 v146, v84, v85
    v_cvt_pk_bf16_f32 v147, v86, v87
    v_cvt_pk_bf16_f32 v148, v88, v89
    v_cvt_pk_bf16_f32 v149, v90, v91
    v_cvt_pk_bf16_f32 v150, v92, v93
    v_cvt_pk_bf16_f32 v151, v94, v95
    v_cvt_pk_bf16_f32 v152, v96, v97
    v_cvt_pk_bf16_f32 v153, v98, v99
    v_cvt_pk_bf16_f32 v154, v100, v101
    v_cvt_pk_bf16_f32 v155, v102, v103
    v_cvt_pk_bf16_f32 v156, v104, v105
    v_cvt_pk_bf16_f32 v157, v106, v107
    v_cvt_pk_bf16_f32 v158, v108, v109
    v_cvt_pk_bf16_f32 v159, v110, v111
    v_permlane32_swap_b32 v144, v146
    v_permlane32_swap_b32 v145, v147
    v_permlane32_swap_b32 v148, v150
    v_permlane32_swap_b32 v149, v151
    v_permlane32_swap_b32 v152, v154
    v_permlane32_swap_b32 v153, v155
    v_permlane32_swap_b32 v156, v158
    v_permlane32_swap_b32 v157, v159
    v_permlane16_swap_b32 v144, v146
    v_permlane16_swap_b32 v145, v147
    v_permlane16_swap_b32 v148, v150
    v_permlane16_swap_b32 v149, v151
    v_permlane16_swap_b32 v152, v154
    v_permlane16_swap_b32 v153, v155
    v_permlane16_swap_b32 v156, v158
    v_permlane16_swap_b32 v157, v159
    s_waitcnt lgkmcnt(0)
    v_mfma_f32_16x16x32_bf16 v[160:163], a[0:3], v[112:115], 0
    ds_read_b64_tr_b16 a[64:65], v225 offset:0
    v_mfma_f32_16x16x32_bf16 v[164:167], a[16:19], v[112:115], 0
    ds_read_b64_tr_b16 a[66:67], v225 offset:512
    v_mfma_f32_16x16x32_bf16 v[160:163], a[4:7], v[116:119], v[160:163]
    ds_read_b64_tr_b16 a[68:69], v225 offset:32
    v_mfma_f32_16x16x32_bf16 v[164:167], a[20:23], v[116:119], v[164:167]
    ds_read_b64_tr_b16 a[70:71], v225 offset:544
    v_mfma_f32_16x16x32_bf16 v[160:163], a[8:11], v[120:123], v[160:163]
    ds_read_b64_tr_b16 a[72:73], v225 offset:64
    v_mfma_f32_16x16x32_bf16 v[164:167], a[24:27], v[120:123], v[164:167]
    ds_read_b64_tr_b16 a[74:75], v225 offset:576
    v_mfma_f32_16x16x32_bf16 v[160:163], a[12:15], v[124:127], v[160:163]
    ds_read_b64_tr_b16 a[76:77], v225 offset:96
    v_mfma_f32_16x16x32_bf16 v[164:167], a[28:31], v[124:127], v[164:167]
    ds_read_b64_tr_b16 a[78:79], v225 offset:608
    ds_read_b64_tr_b16 a[80:81], v225 offset:128
    ds_read_b64_tr_b16 a[82:83], v225 offset:640
    ds_read_b64_tr_b16 a[84:85], v225 offset:160
    ds_read_b64_tr_b16 a[86:87], v225 offset:672
    ds_read_b64_tr_b16 a[88:89], v225 offset:192
    ds_read_b64_tr_b16 a[90:91], v225 offset:704
    ds_read_b64_tr_b16 a[92:93], v225 offset:224
    ds_read_b64_tr_b16 a[94:95], v225 offset:736
    v_mfma_f32_16x16x32_bf16 v[168:171], a[0:3], v[128:131], 0
    s_add_u32 m0, s28, 76832
    v_mfma_f32_16x16x32_bf16 v[172:175], a[16:19], v[128:131], 0
    s_waitcnt vmcnt(3)
    buffer_load_dwordx4 v228, s[8:11], s27 offen offset:256 nt lds
    v_max3_f32 v12, v160, v161, v162
    v_max3_f32 v13, v163, v164, v165
    v_max3_f32 v12, v12, v166, v167
    v_mfma_f32_16x16x32_bf16 v[168:171], a[4:7], v[132:135], v[168:171]
    v_max_f32 v12, v12, v13
    v_mov_b32 v13, v12
    s_nop 1
    v_permlane32_swap_b32 v12, v13
    v_mfma_f32_16x16x32_bf16 v[172:175], a[20:23], v[132:135], v[172:175]
    v_max_f32 v12, v12, v13
    v_mov_b32 v13, v12
    s_nop 1
    v_permlane16_swap_b32 v12, v13
    v_mfma_f32_16x16x32_bf16 v[168:171], a[8:11], v[136:139], v[168:171]
    v_max_f32 v12, v12, v13
    v_sub_f32 v196, 0, v12
    v_sub_f32 v197, 0, v12
    v_mfma_f32_16x16x32_bf16 v[172:175], a[24:27], v[136:139], v[172:175]
    v_sub_f32 v198, 0, v12
    v_sub_f32 v199, 0, v12
    v_sub_f32 v160, v160, v12
    v_mfma_f32_16x16x32_bf16 v[168:171], a[12:15], v[140:143], v[168:171]
    ds_read_b128 a[32:35], v224 offset:16896
    v_sub_f32 v161, v161, v12
    v_sub_f32 v162, v162, v12
    v_sub_f32 v163, v163, v12
    v_mfma_f32_16x16x32_bf16 v[172:175], a[28:31], v[140:143], v[172:175]
    ds_read_b128 a[48:51], v224 offset:17408
    ds_read_b128 a[36:39], v224 offset:16960
    ds_read_b128 a[52:55], v224 offset:17472
    ds_read_b128 a[40:43], v224 offset:17024
    v_sub_f32 v164, v164, v12
    v_sub_f32 v165, v165, v12
    v_sub_f32 v166, v166, v12
    v_mfma_f32_16x16x32_bf16 v[176:179], a[0:3], v[144:147], 0
    ds_read_b128 a[56:59], v224 offset:17536
    v_sub_f32 v167, v167, v12
    v_exp_f32 v4, v160
    v_exp_f32 v5, v161
    v_mfma_f32_16x16x32_bf16 v[180:183], a[16:19], v[144:147], 0
    v_exp_f32 v6, v162
    v_exp_f32 v7, v163
    v_exp_f32 v8, v164
    v_mfma_f32_16x16x32_bf16 v[176:179], a[4:7], v[148:151], v[176:179]
    ds_read_b128 a[44:47], v224 offset:17088
    v_exp_f32 v9, v165
    v_exp_f32 v10, v166
    v_exp_f32 v11, v167
    v_mfma_f32_16x16x32_bf16 v[180:183], a[20:23], v[148:151], v[180:183]
    v_add_f32 v232, v4, v5
    v_cvt_pk_bf16_f32 v184, v4, v5
    v_add_f32 v13, v6, v7
    v_mfma_f32_16x16x32_bf16 v[176:179], a[8:11], v[152:155], v[176:179]
    s_add_u32 m0, s28, 84480
    ds_read_b128 a[60:63], v224 offset:17600
    v_cvt_pk_bf16_f32 v185, v6, v7
    v_add_f32 v232, v232, v13
    v_add_f32 v14, v8, v9
    v_mfma_f32_16x16x32_bf16 v[180:183], a[24:27], v[152:155], v[180:183]
    s_waitcnt vmcnt(3)
    buffer_load_dwordx4 v229, s[4:7], s27 offen nt lds
    v_cvt_pk_bf16_f32 v186, v8, v9
    v_add_f32 v232, v232, v14
    v_add_f32 v15, v10, v11
    v_mfma_f32_16x16x32_bf16 v[176:179], a[12:15], v[156:159], v[176:179]
    ds_read_b64_tr_b16 a[96:97], v225 offset:16896
    v_cvt_pk_bf16_f32 v187, v10, v11
    v_add_f32 v232, v232, v15
    v_mov_b32 v220, v232
    v_mfma_f32_16x16x32_bf16 v[180:183], a[28:31], v[156:159], v[180:183]
    s_waitcnt lgkmcnt(9)
    ds_read_b64_tr_b16 a[98:99], v225 offset:17408
    v_max3_f32 v12, v168, v169, v170
    v_max3_f32 v13, v171, v172, v173
    v_max3_f32 v12, v12, v174, v175
    v_mfma_f32_16x16x32_bf16 v[16:19], a[64:67], v[184:187], 0
    ds_read_b64_tr_b16 a[100:101], v225 offset:16928
    v_max_f32 v12, v12, v13
    v_mov_b32 v13, v12
    s_nop 1
    v_permlane32_swap_b32 v12, v13
    v_mfma_f32_16x16x32_bf16 v[20:23], a[68:71], v[184:187], 0
    v_max_f32 v12, v12, v13
    v_mov_b32 v13, v12
    v_mfma_f32_16x16x32_bf16 v[24:27], a[72:75], v[184:187], 0
    ds_read_b64_tr_b16 a[102:103], v225 offset:17440
    v_permlane16_swap_b32 v12, v13
    v_max_f32 v12, v12, v13
    v_sub_f32 v200, 0, v12
    v_mfma_f32_16x16x32_bf16 v[28:31], a[76:79], v[184:187], 0
    ds_read_b64_tr_b16 a[104:105], v225 offset:16960
    v_sub_f32 v201, 0, v12
    v_sub_f32 v202, 0, v12
    v_sub_f32 v203, 0, v12
    v_mfma_f32_16x16x32_bf16 v[32:35], a[80:83], v[184:187], 0
    ds_read_b64_tr_b16 a[106:107], v225 offset:17472
    v_sub_f32 v168, v168, v12
    v_sub_f32 v169, v169, v12
    v_mfma_f32_16x16x32_bf16 v[36:39], a[84:87], v[184:187], 0
    v_sub_f32 v170, v170, v12
    v_sub_f32 v171, v171, v12
    v_sub_f32 v172, v172, v12
    v_mfma_f32_16x16x32_bf16 v[40:43], a[88:91], v[184:187], 0
    ds_read_b64_tr_b16 a[108:109], v225 offset:16992
    v_sub_f32 v173, v173, v12
    v_sub_f32 v174, v174, v12
    v_mfma_f32_16x16x32_bf16 v[44:47], a[92:95], v[184:187], 0
    s_waitcnt lgkmcnt(7)
    v_sub_f32 v175, v175, v12
    v_exp_f32 v4, v168
    v_exp_f32 v5, v169
    v_mfma_f32_16x16x32_bf16 v[160:163], a[32:35], v[112:115], v[196:199]
    s_add_u32 m0, s28, 85280
    ds_read_b64_tr_b16 a[110:111], v225 offset:17504
    v_exp_f32 v6, v170
    v_exp_f32 v7, v171
    v_exp_f32 v8, v172
    v_mfma_f32_16x16x32_bf16 v[164:167], a[48:51], v[112:115], v[196:199]
    s_waitcnt vmcnt(3)
    buffer_load_dwordx4 v229, s[4:7], s27 offen offset:256 nt lds
    v_exp_f32 v9, v173
    v_exp_f32 v10, v174
    v_mfma_f32_16x16x32_bf16 v[160:163], a[36:39], v[116:119], v[160:163]
    ds_read_b64_tr_b16 a[112:113], v225 offset:17024
    v_exp_f32 v11, v175
    v_add_f32 v233, v4, v5
    v_cvt_pk_bf16_f32 v188, v4, v5
    v_mfma_f32_16x16x32_bf16 v[164:167], a[52:55], v[116:119], v[164:167]
    v_add_f32 v13, v6, v7
    v_cvt_pk_bf16_f32 v189, v6, v7
    v_add_f32 v233, v233, v13
    v_mfma_f32_16x16x32_bf16 v[160:163], a[40:43], v[120:123], v[160:163]
    ds_read_b64_tr_b16 a[114:115], v225 offset:17536
    v_add_f32 v14, v8, v9
    v_cvt_pk_bf16_f32 v190, v8, v9
    v_mfma_f32_16x16x32_bf16 v[164:167], a[56:59], v[120:123], v[164:167]
    ds_read_b64_tr_b16 a[116:117], v225 offset:17056
    v_add_f32 v233, v233, v14
    v_add_f32 v15, v10, v11
    v_cvt_pk_bf16_f32 v191, v10, v11
    v_mfma_f32_16x16x32_bf16 v[160:163], a[44:47], v[124:127], v[160:163]
    ds_read_b64_tr_b16 a[118:119], v225 offset:17568
    v_add_f32 v233, v233, v15
    v_mov_b32 v221, v233
    v_mfma_f32_16x16x32_bf16 v[164:167], a[60:63], v[124:127], v[164:167]
    v_max3_f32 v12, v176, v177, v178
    v_max3_f32 v13, v179, v180, v181
    v_max3_f32 v12, v12, v182, v183
    v_mfma_f32_16x16x32_bf16 v[48:51], a[64:67], v[188:191], 0
    ds_read_b64_tr_b16 a[120:121], v225 offset:17088
    v_max_f32 v12, v12, v13
    v_mov_b32 v13, v12
    s_nop 1
    v_permlane32_swap_b32 v12, v13
    v_mfma_f32_16x16x32_bf16 v[52:55], a[68:71], v[188:191], 0
    v_max_f32 v12, v12, v13
    v_mov_b32 v13, v12
    v_mfma_f32_16x16x32_bf16 v[56:59], a[72:75], v[188:191], 0
    ds_read_b64_tr_b16 a[122:123], v225 offset:17600
    v_permlane16_swap_b32 v12, v13
    v_max_f32 v12, v12, v13
    v_sub_f32 v204, 0, v12
    v_mfma_f32_16x16x32_bf16 v[60:63], a[76:79], v[188:191], 0
    v_sub_f32 v205, 0, v12
    v_sub_f32 v206, 0, v12
    v_sub_f32 v207, 0, v12
    v_mfma_f32_16x16x32_bf16 v[64:67], a[80:83], v[188:191], 0
    s_add_u32 m0, s28, 92928
    ds_read_b64_tr_b16 a[124:125], v225 offset:17120
    v_sub_f32 v176, v176, v12
    v_sub_f32 v177, v177, v12
    v_mfma_f32_16x16x32_bf16 v[68:71], a[84:87], v[188:191], 0
    s_waitcnt vmcnt(3)
    buffer_load_dwordx4 v229, s[8:11], s27 offen nt lds
    v_sub_f32 v178, v178, v12
    v_sub_f32 v179, v179, v12
    v_sub_f32 v180, v180, v12
    v_mfma_f32_16x16x32_bf16 v[72:75], a[88:91], v[188:191], 0
    ds_read_b64_tr_b16 a[126:127], v225 offset:17632
    v_sub_f32 v181, v181, v12
    v_sub_f32 v182, v182, v12
    v_mfma_f32_16x16x32_bf16 v[76:79], a[92:95], v[188:191], 0
    v_sub_f32 v183, v183, v12
    v_exp_f32 v4, v176
    v_exp_f32 v5, v177
    v_mfma_f32_16x16x32_bf16 v[168:171], a[32:35], v[128:131], v[200:203]
    v_exp_f32 v6, v178
    v_exp_f32 v7, v179
    v_exp_f32 v8, v180
    v_mfma_f32_16x16x32_bf16 v[172:175], a[48:51], v[128:131], v[200:203]
    v_add_u32 v224, 33792, v226
    v_exp_f32 v9, v181
    v_exp_f32 v10, v182
    v_mfma_f32_16x16x32_bf16 v[168:171], a[36:39], v[132:135], v[168:171]
    v_add_u32 v225, 33792, v227
    v_exp_f32 v11, v183
    v_add_f32 v234, v4, v5
    v_cvt_pk_bf16_f32 v192, v4, v5
    v_mfma_f32_16x16x32_bf16 v[172:175], a[52:55], v[132:135], v[172:175]
    s_waitcnt lgkmcnt(0)
    s_barrier
    v_add_f32 v13, v6, v7
    v_cvt_pk_bf16_f32 v193, v6, v7
    v_add_f32 v234, v234, v13
    v_mfma_f32_16x16x32_bf16 v[168:171], a[40:43], v[136:139], v[168:171]
    ds_read_b128 a[0:3], v224 offset:0
    v_add_f32 v14, v8, v9
    v_cvt_pk_bf16_f32 v194, v8, v9
    v_mfma_f32_16x16x32_bf16 v[172:175], a[56:59], v[136:139], v[172:175]
    v_add_f32 v234, v234, v14
    v_add_f32 v15, v10, v11
    v_cvt_pk_bf16_f32 v195, v10, v11
    v_mfma_f32_16x16x32_bf16 v[168:171], a[44:47], v[140:143], v[168:171]
    ds_read_b128 a[16:19], v224 offset:512
    v_add_f32 v234, v234, v15
    v_mov_b32 v222, v234
    v_mfma_f32_16x16x32_bf16 v[172:175], a[60:63], v[140:143], v[172:175]
    v_exp_f32 v208, v160
    v_exp_f32 v209, v161
    v_mfma_f32_16x16x32_bf16 v[80:83], a[64:67], v[192:195], 0
    s_add_u32 m0, s28, 93728
    ds_read_b128 a[4:7], v224 offset:64
    v_add_f32 v232, v208, v209
    v_exp_f32 v210, v162
    v_mfma_f32_16x16x32_bf16 v[84:87], a[68:71], v[192:195], 0
    s_waitcnt vmcnt(3)
    buffer_load_dwordx4 v229, s[8:11], s27 offen offset:256 nt lds
    v_mfma_f32_16x16x32_bf16 v[88:91], a[72:75], v[192:195], 0
    ds_read_b128 a[20:23], v224 offset:576
    v_cvt_pk_bf16_f32 v184, v208, v209
    v_exp_f32 v211, v163
    v_mfma_f32_16x16x32_bf16 v[92:95], a[76:79], v[192:195], 0
    v_add_f32 v217, v210, v211
    v_cvt_pk_bf16_f32 v185, v210, v211
    v_exp_f32 v212, v164
    v_mfma_f32_16x16x32_bf16 v[96:99], a[80:83], v[192:195], 0
    ds_read_b128 a[8:11], v224 offset:128
    v_add_f32 v232, v232, v217
    v_exp_f32 v213, v165
    v_mfma_f32_16x16x32_bf16 v[100:103], a[84:87], v[192:195], 0
    v_add_f32 v218, v212, v213
    v_cvt_pk_bf16_f32 v186, v212, v213
    v_exp_f32 v214, v166
    v_mfma_f32_16x16x32_bf16 v[104:107], a[88:91], v[192:195], 0
    ds_read_b128 a[24:27], v224 offset:640
    v_add_f32 v232, v232, v218
    v_exp_f32 v215, v167
    v_mfma_f32_16x16x32_bf16 v[108:111], a[92:95], v[192:195], 0
    v_add_f32 v219, v214, v215
    v_cvt_pk_bf16_f32 v187, v214, v215
    v_add_f32 v232, v232, v219
    v_cmp_nge_f32 vcc, s32, v232
    v_mfma_f32_16x16x32_bf16 v[176:179], a[32:35], v[144:147], v[204:207]
    ds_read_b128 a[12:15], v224 offset:192
    v_exp_f32 v208, v168
    v_mfma_f32_16x16x32_bf16 v[180:183], a[48:51], v[144:147], v[204:207]
    s_cbranch_vccnz L_stub_1
L_back_2:
    v_add_f32 v220, v220, v232
    v_mfma_f32_16x16x32_bf16 v[176:179], a[36:39], v[148:151], v[176:179]
    ds_read_b128 a[28:31], v224 offset:704
    v_exp_f32 v209, v169
    v_mfma_f32_16x16x32_bf16 v[180:183], a[52:55], v[148:151], v[180:183]
    s_mov_b32 s27, 49152
    v_exp_f32 v210, v170
    v_mfma_f32_16x16x32_bf16 v[176:179], a[40:43], v[152:155], v[176:179]
    s_add_u32 m0, s28, 0
    ds_read_b64_tr_b16 a[64:65], v225 offset:0
    v_add_f32 v233, v208, v209
    v_mfma_f32_16x16x32_bf16 v[180:183], a[56:59], v[152:155], v[180:183]
    s_waitcnt vmcnt(3)
    buffer_load_dwordx4 v228, s[4:7], s27 offen nt lds
    v_mfma_f32_16x16x32_bf16 v[176:179], a[44:47], v[156:159], v[176:179]
    ds_read_b64_tr_b16 a[66:67], v225 offset:512
    v_cvt_pk_bf16_f32 v188, v208, v209
    v_mfma_f32_16x16x32_bf16 v[180:183], a[60:63], v[156:159], v[180:183]
    v_exp_f32 v211, v171
    v_mfma_f32_16x16x32_bf16 v[16:19], a[96:99], v[184:187], v[16:19]
    ds_read_b64_tr_b16 a[68:69], v225 offset:32
    v_add_f32 v217, v210, v211
    v_mfma_f32_16x16x32_bf16 v[20:23], a[100:103], v[184:187], v[20:23]
    v_cvt_pk_bf16_f32 v189, v210, v211
    v_add_f32 v233, v233, v217
    v_mfma_f32_16x16x32_bf16 v[24:27], a[104:107], v[184:187], v[24:27]
    ds_read_b64_tr_b16 a[70:71], v225 offset:544
    v_exp_f32 v212, v172
    v_mfma_f32_16x16x32_bf16 v[28:31], a[108:111], v[184:187], v[28:31]
    v_exp_f32 v213, v173
    v_mfma_f32_16x16x32_bf16 v[32:35], a[112:115], v[184:187], v[32:35]
    ds_read_b64_tr_b16 a[72:73], v225 offset:64
    v_exp_f32 v214, v174
    v_mfma_f32_16x16x32_bf16 v[36:39], a[116:119], v[184:187], v[36:39]
    v_add_f32 v218, v212, v213
    v_exp_f32 v215, v175
    v_mfma_f32_16x16x32_bf16 v[40:43], a[120:123], v[184:187], v[40:43]
    v_cvt_pk_bf16_f32 v190, v212, v213
    v_add_f32 v233, v233, v218
    v_add_f32 v219, v214, v215
    v_mfma_f32_16x16x32_bf16 v[44:47], a[124:127], v[184:187], v[44:47]
    s_waitcnt lgkmcnt(5)
    v_cvt_pk_bf16_f32 v191, v214, v215
    v_add_f32 v233, v233, v219
    v_cmp_nge_f32 vcc, s32, v233
    v_mfma_f32_16x16x32_bf16 v[160:163], a[0:3], v[112:115], v[196:199]
    s_add_u32 m0, s28, 800
    ds_read_b64_tr_b16 a[74:75], v225 offset:576
    v_exp_f32 v208, v176
    v_mfma_f32_16x16x32_bf16 v[164:167], a[16:19], v[112:115], v[196:199]
    s_waitcnt vmcnt(3)
    s_cbranch_vccnz L_stub_3
L_back_4:
    buffer_load_dwordx4 v228, s[4:7], s27 offen offset:256 nt lds
    v_mfma_f32_16x16x32_bf16 v[160:163], a[4:7], v[116:119], v[160:163]
    ds_read_b64_tr_b16 a[76:77], v225 offset:96
    v_exp_f32 v209, v177
    v_mfma_f32_16x16x32_bf16 v[164:167], a[20:23], v[116:119], v[164:167]
    v_add_f32 v221, v221, v233
    v_add_f32 v234, v208, v209
    v_mfma_f32_16x16x32_bf16 v[160:163], a[8:11], v[120:123], v[160:163]
    ds_read_b64_tr_b16 a[78:79], v225 offset:608
    v_cvt_pk_bf16_f32 v192, v208, v209
    v_mfma_f32_16x16x32_bf16 v[164:167], a[24:27], v[120:123], v[164:167]
    v_exp_f32 v210, v178
    v_mfma_f32_16x16x32_bf16 v[160:163], a[12:15], v[124:127], v[160:163]
    ds_read_b64_tr_b16 a[80:81], v225 offset:128
    v_exp_f32 v211, v179
    v_mfma_f32_16x16x32_bf16 v[164:167], a[28:31], v[124:127], v[164:167]
    v_add_f32 v217, v210, v211
    v_cvt_pk_bf16_f32 v193, v210, v211
    v_mfma_f32_16x16x32_bf16 v[48:51], a[96:99], v[188:191], v[48:51]
    ds_read_b64_tr_b16 a[82:83], v225 offset:640
    v_exp_f32 v212, v180
    v_mfma_f32_16x16x32_bf16 v[52:55], a[100:103], v[188:191], v[52:55]
    v_exp_f32 v213, v181
    v_mfma_f32_16x16x32_bf16 v[56:59], a[104:107], v[188:191], v[56:59]
    ds_read_b64_tr_b16 a[84:85], v225 offset:160
    v_add_f32 v234, v234, v217
    v_add_f32 v218, v212, v213
    v_mfma_f32_16x16x32_bf16 v[60:63], a[108:111], v[188:191], v[60:63]
    v_cvt_pk_bf16_f32 v194, v212, v213
    v_exp_f32 v214, v182
    v_mfma_f32_16x16x32_bf16 v[64:67], a[112:115], v[188:191], v[64:67]
    s_add_u32 m0, s28, 8448
    ds_read_b64_tr_b16 a[86:87], v225 offset:672
    v_exp_f32 v215, v183
    v_mfma_f32_16x16x32_bf16 v[68:71], a[116:119], v[188:191], v[68:71]
    s_waitcnt vmcnt(3)
    buffer_load_dwordx4 v228, s[8:11], s27 offen nt lds
    v_mfma_f32_16x16x32_bf16 v[72:75], a[120:123], v[188:191], v[72:75]
    ds_read_b64_tr_b16 a[88:89], v225 offset:192
    v_add_f32 v234, v234, v218
    v_add_f32 v219, v214, v215
    v_mfma_f32_16x16x32_bf16 v[76:79], a[124:127], v[188:191], v[76:79]
    v_cvt_pk_bf16_f32 v195, v214, v215
    v_add_f32 v234, v234, v219
    v_cmp_nge_f32 vcc, s32, v234
    v_mfma_f32_16x16x32_bf16 v[168:171], a[0:3], v[128:131], v[200:203]
    ds_read_b64_tr_b16 a[90:91], v225 offset:704
    v_exp_f32 v208, v160
    v_mfma_f32_16x16x32_bf16 v[172:175], a[16:19], v[128:131], v[200:203]
    s_cbranch_vccnz L_stub_5
L_back_6:
    v_add_f32 v222, v222, v234
    v_mfma_f32_16x16x32_bf16 v[168:171], a[4:7], v[132:135], v[168:171]
    ds_read_b64_tr_b16 a[92:93], v225 offset:224
    v_exp_f32 v209, v161
    v_mfma_f32_16x16x32_bf16 v[172:175], a[20:23], v[132:135], v[172:175]
    v_add_f32 v232, v208, v209
    v_cvt_pk_bf16_f32 v184, v208, v209
    v_mfma_f32_16x16x32_bf16 v[168:171], a[8:11], v[136:139], v[168:171]
    ds_read_b64_tr_b16 a[94:95], v225 offset:736
    v_exp_f32 v210, v162
    v_mfma_f32_16x16x32_bf16 v[172:175], a[24:27], v[136:139], v[172:175]
    v_exp_f32 v211, v163
    v_mfma_f32_16x16x32_bf16 v[168:171], a[12:15], v[140:143], v[168:171]
    ds_read_b128 a[32:35], v224 offset:16896
    v_add_f32 v217, v210, v211
    v_mfma_f32_16x16x32_bf16 v[172:175], a[28:31], v[140:143], v[172:175]
    v_exp_f32 v212, v164
    v_mfma_f32_16x16x32_bf16 v[80:83], a[96:99], v[192:195], v[80:83]
    s_add_u32 m0, s28, 9248
    ds_read_b128 a[48:51], v224 offset:17408
    v_cvt_pk_bf16_f32 v185, v210, v211
    v_mfma_f32_16x16x32_bf16 v[84:87], a[100:103], v[192:195], v[84:87]
    s_waitcnt vmcnt(3)
    buffer_load_dwordx4 v228, s[8:11], s27 offen offset:256 nt lds
    v_mfma_f32_16x16x32_bf16 v[88:91], a[104:107], v[192:195], v[88:91]
    ds_read_b128 a[36:39], v224 offset:16960
    v_exp_f32 v213, v165
    v_mfma_f32_16x16x32_bf16 v[92:95], a[108:111], v[192:195], v[92:95]
    v_add_f32 v232, v232, v217
    v_add_f32 v218, v212, v213
    v_mfma_f32_16x16x32_bf16 v[96:99], a[112:115], v[192:195], v[96:99]
    ds_read_b128 a[52:55], v224 offset:17472
    v_exp_f32 v214, v166
    v_mfma_f32_16x16x32_bf16 v[100:103], a[116:119], v[192:195], v[100:103]
    v_cvt_pk_bf16_f32 v186, v212, v213
    v_exp_f32 v215, v167
    v_mfma_f32_16x16x32_bf16 v[104:107], a[120:123], v[192:195], v[104:107]
    ds_read_b128 a[40:43], v224 offset:17024
    v_add_f32 v232, v232, v218
    v_add_f32 v219, v214, v215
    v_mfma_f32_16x16x32_bf16 v[108:111], a[124:127], v[192:195], v[108:111]
    v_cvt_pk_bf16_f32 v187, v214, v215
    v_add_f32 v232, v232, v219
    v_cmp_nge_f32 vcc, s32, v232
    v_mfma_f32_16x16x32_bf16 v[176:179], a[0:3], v[144:147], v[204:207]
    ds_read_b128 a[56:59], v224 offset:17536
    v_exp_f32 v208, v168
    v_mfma_f32_16x16x32_bf16 v[180:183], a[16:19], v[144:147], v[204:207]
    s_cbranch_vccnz L_stub_7
L_back_8:
    v_exp_f32 v209, v169
    v_mfma_f32_16x16x32_bf16 v[176:179], a[4:7], v[148:151], v[176:179]
    ds_read_b128 a[44:47], v224 offset:17088
    v_add_f32 v220, v220, v232
    v_add_f32 v233, v208, v209
    v_mfma_f32_16x16x32_bf16 v[180:183], a[20:23], v[148:151], v[180:183]
    v_exp_f32 v210, v170
    v_mfma_f32_16x16x32_bf16 v[176:179], a[8:11], v[152:155], v[176:179]
    s_add_u32 m0, s28, 16896
    ds_read_b128 a[60:63], v224 offset:17600
    v_cvt_pk_bf16_f32 v188, v208, v209
    v_mfma_f32_16x16x32_bf16 v[180:183], a[24:27], v[152:155], v[180:183]
    s_waitcnt vmcnt(3)
    buffer_load_dwordx4 v229, s[4:7], s27 offen nt lds
    v_mfma_f32_16x16x32_bf16 v[176:179], a[12:15], v[156:159], v[176:179]
    ds_read_b64_tr_b16 a[96:97], v225 offset:16896
    v_exp_f32 v211, v171
    v_mfma_f32_16x16x32_bf16 v[180:183], a[28:31], v[156:159], v[180:183]
    s_waitcnt lgkmcnt(9)
    ds_read_b64_tr_b16 a[98:99], v225 offset:17408
    v_add_f32 v217, v210, v211
    v_mfma_f32_16x16x32_bf16 v[16:19], a[64:67], v[184:187], v[16:19]
    ds_read_b64_tr_b16 a[100:101], v225 offset:16928
    v_cvt_pk_bf16_f32 v189, v210, v211
    v_mfma_f32_16x16x32_bf16 v[20:23], a[68:71], v[184:187], v[20:23]
    v_exp_f32 v212, v172
    v_mfma_f32_16x16x32_bf16 v[24:27], a[72:75], v[184:187], v[24:27]
    ds_read_b64_tr_b16 a[102:103], v225 offset:17440
    v_exp_f32 v213, v173
    v_mfma_f32_16x16x32_bf16 v[28:31], a[76:79], v[184:187], v[28:31]
    ds_read_b64_tr_b16 a[104:105], v225 offset:16960
    v_add_f32 v233, v233, v217
    v_add_f32 v218, v212, v213
    v_mfma_f32_16x16x32_bf16 v[32:35], a[80:83], v[184:187], v[32:35]
    ds_read_b64_tr_b16 a[106:107], v225 offset:17472
    v_exp_f32 v214, v174
    v_mfma_f32_16x16x32_bf16 v[36:39], a[84:87], v[184:187], v[36:39]
    v_cvt_pk_bf16_f32 v190, v212, v213
    v_exp_f32 v215, v175
    v_mfma_f32_16x16x32_bf16 v[40:43], a[88:91], v[184:187], v[40:43]
    ds_read_b64_tr_b16 a[108:109], v225 offset:16992
    v_add_f32 v233, v233, v218
    v_add_f32 v219, v214, v215
    v_mfma_f32_16x16x32_bf16 v[44:47], a[92:95], v[184:187], v[44:47]
    s_waitcnt lgkmcnt(7)
    v_cvt_pk_bf16_f32 v191, v214, v215
    v_add_f32 v233, v233, v219
    v_cmp_nge_f32 vcc, s32, v233
    v_mfma_f32_16x16x32_bf16 v[160:163], a[32:35], v[112:115], v[196:199]
    s_add_u32 m0, s28, 17696
    ds_read_b64_tr_b16 a[110:111], v225 offset:17504
    v_exp_f32 v208, v176
    v_mfma_f32_16x16x32_bf16 v[164:167], a[48:51], v[112:115], v[196:199]
    s_waitcnt vmcnt(3)
    s_cbranch_vccnz L_stub_9
L_back_10:
    buffer_load_dwordx4 v229, s[4:7], s27 offen offset:256 nt lds
    v_mfma_f32_16x16x32_bf16 v[160:163], a[36:39], v[116:119], v[160:163]
    ds_read_b64_tr_b16 a[112:113], v225 offset:17024
    v_exp_f32 v209, v177
    v_mfma_f32_16x16x32_bf16 v[164:167], a[52:55], v[116:119], v[164:167]
    v_add_f32 v221, v221, v233
    v_add_f32 v234, v208, v209
    v_mfma_f32_16x16x32_bf16 v[160:163], a[40:43], v[120:123], v[160:163]
    ds_read_b64_tr_b16 a[114:115], v225 offset:17536
    v_cvt_pk_bf16_f32 v192, v208, v209
    v_mfma_f32_16x16x32_bf16 v[164:167], a[56:59], v[120:123], v[164:167]
    ds_read_b64_tr_b16 a[116:117], v225 offset:17056
    v_exp_f32 v210, v178
    v_mfma_f32_16x16x32_bf16 v[160:163], a[44:47], v[124:127], v[160:163]
    ds_read_b64_tr_b16 a[118:119], v225 offset:17568
    v_exp_f32 v211, v179
    v_mfma_f32_16x16x32_bf16 v[164:167], a[60:63], v[124:127], v[164:167]
    v_add_f32 v217, v210, v211
    v_cvt_pk_bf16_f32 v193, v210, v211
    v_mfma_f32_16x16x32_bf16 v[48:51], a[64:67], v[188:191], v[48:51]
    ds_read_b64_tr_b16 a[120:121], v225 offset:17088
    v_exp_f32 v212, v180
    v_mfma_f32_16x16x32_bf16 v[52:55], a[68:71], v[188:191], v[52:55]
    v_exp_f32 v213, v181
    v_mfma_f32_16x16x32_bf16 v[56:59], a[72:75], v[188:191], v[56:59]
    ds_read_b64_tr_b16 a[122:123], v225 offset:17600
    v_add_f32 v234, v234, v217
    v_add_f32 v218, v212, v213
    v_mfma_f32_16x16x32_bf16 v[60:63], a[76:79], v[188:191], v[60:63]
    v_cvt_pk_bf16_f32 v194, v212, v213
    v_exp_f32 v214, v182
    v_mfma_f32_16x16x32_bf16 v[64:67], a[80:83], v[188:191], v[64:67]
    s_add_u32 m0, s28, 25344
    ds_read_b64_tr_b16 a[124:125], v225 offset:17120
    v_exp_f32 v215, v183
    v_mfma_f32_16x16x32_bf16 v[68:71], a[84:87], v[188:191], v[68:71]
    s_waitcnt vmcnt(3)
    buffer_load_dwordx4 v229, s[8:11], s27 offen nt lds
    v_mfma_f32_16x16x32_bf16 v[72:75], a[88:91], v[188:191], v[72:75]
    ds_read_b64_tr_b16 a[126:127], v225 offset:17632
    v_add_f32 v234, v234, v218
    v_add_f32 v219, v214, v215
    v_mfma_f32_16x16x32_bf16 v[76:79], a[92:95], v[188:191], v[76:79]
    v_cvt_pk_bf16_f32 v195, v214, v215
    v_add_f32 v234, v234, v219
    v_cmp_nge_f32 vcc, s32, v234
    v_mfma_f32_16x16x32_bf16 v[168:171], a[32:35], v[128:131], v[200:203]
    v_exp_f32 v208, v160
    v_mfma_f32_16x16x32_bf16 v[172:175], a[48:51], v[128:131], v[200:203]
    s_cbranch_vccnz L_stub_11
L_back_12:
    v_add_u32 v224, 67584, v226
    v_add_f32 v222, v222, v234
    v_mfma_f32_16x16x32_bf16 v[168:171], a[36:39], v[132:135], v[168:171]
    v_add_u32 v225, 67584, v227
    v_exp_f32 v209, v161
    v_mfma_f32_16x16x32_bf16 v[172:175], a[52:55], v[132:135], v[172:175]
    s_waitcnt lgkmcnt(0)
    s_barrier
    v_mfma_f32_16x16x32_bf16 v[168:171], a[40:43], v[136:139], v[168:171]
    ds_read_b128 a[0:3], v224 offset:0
    v_add_f32 v232, v208, v209
    v_mfma_f32_16x16x32_bf16 v[172:175], a[56:59], v[136:139], v[172:175]
    v_exp_f32 v210, v162
    v_mfma_f32_16x16x32_bf16 v[168:171], a[44:47], v[140:143], v[168:171]
    ds_read_b128 a[16:19], v224 offset:512
    v_exp_f32 v211, v163
    v_mfma_f32_16x16x32_bf16 v[172:175], a[60:63], v[140:143], v[172:175]
    v_cvt_pk_bf16_f32 v184, v208, v209
    v_add_f32 v217, v210, v211
    v_mfma_f32_16x16x32_bf16 v[80:83], a[64:67], v[192:195], v[80:83]
    s_add_u32 m0, s28, 26144
    ds_read_b128 a[4:7], v224 offset:64
    v_exp_f32 v212, v164
    v_mfma_f32_16x16x32_bf16 v[84:87], a[68:71], v[192:195], v[84:87]
    s_waitcnt vmcnt(3)
    buffer_load_dwordx4 v229, s[8:11], s27 offen offset:256 nt lds
    v_mfma_f32_16x16x32_bf16 v[88:91], a[72:75], v[192:195], v[88:91]
    ds_read_b128 a[20:23], v224 offset:576
    v_exp_f32 v213, v165
    v_mfma_f32_16x16x32_bf16 v[92:95], a[76:79], v[192:195], v[92:95]
    v_cvt_pk_bf16_f32 v185, v210, v211
    v_add_f32 v232, v232, v217
    v_add_f32 v218, v212, v213
    v_mfma_f32_16x16x32_bf16 v[96:99], a[80:83], v[192:195], v[96:99]
    ds_read_b128 a[8:11], v224 offset:128
    v_exp_f32 v214, v166
    v_mfma_f32_16x16x32_bf16 v[100:103], a[84:87], v[192:195], v[100:103]
    v_cvt_pk_bf16_f32 v186, v212, v213
    v_exp_f32 v215, v167
    v_mfma_f32_16x16x32_bf16 v[104:107], a[88:91], v[192:195], v[104:107]
    ds_read_b128 a[24:27], v224 offset:640
    v_add_f32 v232, v232, v218
    v_add_f32 v219, v214, v215
    v_mfma_f32_16x16x32_bf16 v[108:111], a[92:95], v[192:195], v[108:111]
    v_cvt_pk_bf16_f32 v187, v214, v215
    v_add_f32 v232, v232, v219
    v_cmp_nge_f32 vcc, s32, v232
    v_mfma_f32_16x16x32_bf16 v[176:179], a[32:35], v[144:147], v[204:207]
    ds_read_b128 a[12:15], v224 offset:192
    v_exp_f32 v208, v168
    v_mfma_f32_16x16x32_bf16 v[180:183], a[48:51], v[144:147], v[204:207]
    s_cbranch_vccnz L_stub_13
L_back_14:
    v_add_f32 v220, v220, v232
    v_mfma_f32_16x16x32_bf16 v[176:179], a[36:39], v[148:151], v[176:179]
    ds_read_b128 a[28:31], v224 offset:704
    v_exp_f32 v209, v169
    v_mfma_f32_16x16x32_bf16 v[180:183], a[52:55], v[148:151], v[180:183]
    s_mov_b32 s27, 65536
    v_exp_f32 v210, v170
    v_mfma_f32_16x16x32_bf16 v[176:179], a[40:43], v[152:155], v[176:179]
    s_add_u32 m0, s28, 33792
    ds_read_b64_tr_b16 a[64:65], v225 offset:0
    v_add_f32 v233, v208, v209
    v_mfma_f32_16x16x32_bf16 v[180:183], a[56:59], v[152:155], v[180:183]
    s_waitcnt vmcnt(3)
    buffer_load_dwordx4 v228, s[4:7], s27 offen nt lds
    v_mfma_f32_16x16x32_bf16 v[176:179], a[44:47], v[156:159], v[176:179]
    ds_read_b64_tr_b16 a[66:67], v225 offset:512
    v_cvt_pk_bf16_f32 v188, v208, v209
    v_mfma_f32_16x16x32_bf16 v[180:183], a[60:63], v[156:159], v[180:183]
    v_exp_f32 v211, v171
    v_mfma_f32_16x16x32_bf16 v[16:19], a[96:99], v[184:187], v[16:19]
    ds_read_b64_tr_b16 a[68:69], v225 offset:32
    v_add_f32 v217, v210, v211
    v_mfma_f32_16x16x32_bf16 v[20:23], a[100:103], v[184:187], v[20:23]
    v_cvt_pk_bf16_f32 v189, v210, v211
    v_add_f32 v233, v233, v217
    v_mfma_f32_16x16x32_bf16 v[24:27], a[104:107], v[184:187], v[24:27]
    ds_read_b64_tr_b16 a[70:71], v225 offset:544
    v_exp_f32 v212, v172
    v_mfma_f32_16x16x32_bf16 v[28:31], a[108:111], v[184:187], v[28:31]
    v_exp_f32 v213, v173
    v_mfma_f32_16x16x32_bf16 v[32:35], a[112:115], v[184:187], v[32:35]
    ds_read_b64_tr_b16 a[72:73], v225 offset:64
    v_exp_f32 v214, v174
    v_mfma_f32_16x16x32_bf16 v[36:39], a[116:119], v[184:187], v[36:39]
    v_add_f32 v218, v212, v213
    v_exp_f32 v215, v175
    v_mfma_f32_16x16x32_bf16 v[40:43], a[120:123], v[184:187], v[40:43]
    v_cvt_pk_bf16_f32 v190, v212, v213
    v_add_f32 v233, v233, v218
    v_add_f32 v219, v214, v215
    v_mfma_f32_16x16x32_bf16 v[44:47], a[124:127], v[184:187], v[44:47]
    s_waitcnt lgkmcnt(5)
    v_cvt_pk_bf16_f32 v191, v214, v215
    v_add_f32 v233, v233, v219
    v_cmp_nge_f32 vcc, s32, v233
    v_mfma_f32_16x16x32_bf16 v[160:163], a[0:3], v[112:115], v[196:199]
    s_add_u32 m0, s28, 34592
    ds_read_b64_tr_b16 a[74:75], v225 offset:576
    v_exp_f32 v208, v176
    v_mfma_f32_16x16x32_bf16 v[164:167], a[16:19], v[112:115], v[196:199]
    s_waitcnt vmcnt(3)
    s_cbranch_vccnz L_stub_15
L_back_16:
    buffer_load_dwordx4 v228, s[4:7], s27 offen offset:256 nt lds
    v_mfma_f32_16x16x32_bf16 v[160:163], a[4:7], v[116:119], v[160:163]
    ds_read_b64_tr_b16 a[76:77], v225 offset:96
    v_exp_f32 v209, v177
    v_mfma_f32_16x16x32_bf16 v[164:167], a[20:23], v[116:119], v[164:167]
    v_add_f32 v221, v221, v233
    v_add_f32 v234, v208, v209
    v_mfma_f32_16x16x32_bf16 v[160:163], a[8:11], v[120:123], v[160:163]
    ds_read_b64_tr_b16 a[78:79], v225 offset:608
    v_cvt_pk_bf16_f32 v192, v208, v209
    v_mfma_f32_16x16x32_bf16 v[164:167], a[24:27], v[120:123], v[164:167]
    v_exp_f32 v210, v178
    v_mfma_f32_16x16x32_bf16 v[160:163], a[12:15], v[124:127], v[160:163]
    ds_read_b64_tr_b16 a[80:81], v225 offset:128
    v_exp_f32 v211, v179
    v_mfma_f32_16x16x32_bf16 v[164:167], a[28:31], v[124:127], v[164:167]
    v_add_f32 v217, v210, v211
    v_cvt_pk_bf16_f32 v193, v210, v211
    v_mfma_f32_16x16x32_bf16 v[48:51], a[96:99], v[188:191], v[48:51]
    ds_read_b64_tr_b16 a[82:83], v225 offset:640
    v_exp_f32 v212, v180
    v_mfma_f32_16x16x32_bf16 v[52:55], a[100:103], v[188:191], v[52:55]
    v_exp_f32 v213, v181
    v_mfma_f32_16x16x32_bf16 v[56:59], a[104:107], v[188:191], v[56:59]
    ds_read_b64_tr_b16 a[84:85], v225 offset:160
    v_add_f32 v234, v234, v217
    v_add_f32 v218, v212, v213
    v_mfma_f32_16x16x32_bf16 v[60:63], a[108:111], v[188:191], v[60:63]
    v_cvt_pk_bf16_f32 v194, v212, v213
    v_exp_f32 v214, v182
    v_mfma_f32_16x16x32_bf16 v[64:67], a[112:115], v[188:191], v[64:67]
    s_add_u32 m0, s28, 42240
    ds_read_b64_tr_b16 a[86:87], v225 offset:672
    v_exp_f32 v215, v183
    v_mfma_f32_16x16x32_bf16 v[68:71], a[116:119], v[188:191], v[68:71]
    s_waitcnt vmcnt(3)
    buffer_load_dwordx4 v228, s[8:11], s27 offen nt lds
    v_mfma_f32_16x16x32_bf16 v[72:75], a[120:123], v[188:191], v[72:75]
    ds_read_b64_tr_b16 a[88:89], v225 offset:192
    v_add_f32 v234, v234, v218
    v_add_f32 v219, v214, v215
    v_mfma_f32_16x16x32_bf16 v[76:79], a[124:127], v[188:191], v[76:79]
    v_cvt_pk_bf16_f32 v195, v214, v215
    v_add_f32 v234, v234, v219
    v_cmp_nge_f32 vcc, s32, v234
    v_mfma_f32_16x16x32_bf16 v[168:171], a[0:3], v[128:131], v[200:203]
    ds_read_b64_tr_b16 a[90:91], v225 offset:704
    v_exp_f32 v208, v160
    v_mfma_f32_16x16x32_bf16 v[172:175], a[16:19], v[128:131], v[200:203]
    s_cbranch_vccnz L_stub_17
L_back_18:
    v_add_f32 v222, v222, v234
    v_mfma_f32_16x16x32_bf16 v[168:171], a[4:7], v[132:135], v[168:171]
    ds_read_b64_tr_b16 a[92:93], v225 offset:224
    v_exp_f32 v209, v161
    v_mfma_f32_16x16x32_bf16 v[172:175], a[20:23], v[132:135], v[172:175]
    v_add_f32 v232, v208, v209
    v_cvt_pk_bf16_f32 v184, v208, v209
    v_mfma_f32_16x16x32_bf16 v[168:171], a[8:11], v[136:139], v[168:171]
    ds_read_b64_tr_b16 a[94:95], v225 offset:736
    v_exp_f32 v210, v162
    v_mfma_f32_16x16x32_bf16 v[172:175], a[24:27], v[136:139], v[172:175]
    v_exp_f32 v211, v163
    v_mfma_f32_16x16x32_bf16 v[168:171], a[12:15], v[140:143], v[168:171]
    ds_read_b128 a[32:35], v224 offset:16896
    v_add_f32 v217, v210, v211
    v_mfma_f32_16x16x32_bf16 v[172:175], a[28:31], v[140:143], v[172:175]
    v_exp_f32 v212, v164
    v_mfma_f32_16x16x32_bf16 v[80:83], a[96:99], v[192:195], v[80:83]
    s_add_u32 m0, s28, 43040
    ds_read_b128 a[48:51], v224 offset:17408
    v_cvt_pk_bf16_f32 v185, v210, v211
    v_mfma_f32_16x16x32_bf16 v[84:87], a[100:103], v[192:195], v[84:87]
    s_waitcnt vmcnt(3)
    buffer_load_dwordx4 v228, s[8:11], s27 offen offset:256 nt lds
    v_mfma_f32_16x16x32_bf16 v[88:91], a[104:107], v[192:195], v[88:91]
    ds_read_b128 a[36:39], v224 offset:16960
    v_exp_f32 v213, v165
    v_mfma_f32_16x16x32_bf16 v[92:95], a[108:111], v[192:195], v[92:95]
    v_add_f32 v232, v232, v217
    v_add_f32 v218, v212, v213
    v_mfma_f32_16x16x32_bf16 v[96:99], a[112:115], v[192:195], v[96:99]
    ds_read_b128 a[52:55], v224 offset:17472
    v_exp_f32 v214, v166
    v_mfma_f32_16x16x32_bf16 v[100:103], a[116:119], v[192:195], v[100:103]
    v_cvt_pk_bf16_f32 v186, v212, v213
    v_exp_f32 v215, v167
    v_mfma_f32_16x16x32_bf16 v[104:107], a[120:123], v[192:195], v[104:107]
    ds_read_b128 a[40:43], v224 offset:17024
    v_add_f32 v232, v232, v218
    v_add_f32 v219, v214, v215
    v_mfma_f32_16x16x32_bf16 v[108:111], a[124:127], v[192:195], v[108:111]
    v_cvt_pk_bf16_f32 v187, v214, v215
    v_add_f32 v232, v232, v219
    v_cmp_nge_f32 vcc, s32, v232
    v_mfma_f32_16x16x32_bf16 v[176:179], a[0:3], v[144:147], v[204:207]
    ds_read_b128 a[56:59], v224 offset:17536
    v_exp_f32 v208, v168
    v_mfma_f32_16x16x32_bf16 v[180:183], a[16:19], v[144:147], v[204:207]
    s_cbranch_vccnz L_stub_19
L_back_20:
    v_exp_f32 v209, v169
    v_mfma_f32_16x16x32_bf16 v[176:179], a[4:7], v[148:151], v[176:179]
    ds_read_b128 a[44:47], v224 offset:17088
    v_add_f32 v220, v220, v232
    v_add_f32 v233, v208, v209
    v_mfma_f32_16x16x32_bf16 v[180:183], a[20:23], v[148:151], v[180:183]
    v_exp_f32 v210, v170
    v_mfma_f32_16x16x32_bf16 v[176:179], a[8:11], v[152:155], v[176:179]
    s_add_u32 m0, s28, 50688
    ds_read_b128 a[60:63], v224 offset:17600
    v_cvt_pk_bf16_f32 v188, v208, v209
    v_mfma_f32_16x16x32_bf16 v[180:183], a[24:27], v[152:155], v[180:183]
    s_waitcnt vmcnt(3)
    buffer_load_dwordx4 v229, s[4:7], s27 offen nt lds
    v_mfma_f32_16x16x32_bf16 v[176:179], a[12:15], v[156:159], v[176:179]
    ds_read_b64_tr_b16 a[96:97], v225 offset:16896
    v_exp_f32 v211, v171
    v_mfma_f32_16x16x32_bf16 v[180:183], a[28:31], v[156:159], v[180:183]
    s_waitcnt lgkmcnt(9)
    ds_read_b64_tr_b16 a[98:99], v225 offset:17408
    v_add_f32 v217, v210, v211
    v_mfma_f32_16x16x32_bf16 v[16:19], a[64:67], v[184:187], v[16:19]
    ds_read_b64_tr_b16 a[100:101], v225 offset:16928
    v_cvt_pk_bf16_f32 v189, v210, v211
    v_mfma_f32_16x16x32_bf16 v[20:23], a[68:71], v[184:187], v[20:23]
    v_exp_f32 v212, v172
    v_mfma_f32_16x16x32_bf16 v[24:27], a[72:75], v[184:187], v[24:27]
    ds_read_b64_tr_b16 a[102:103], v225 offset:17440
    v_exp_f32 v213, v173
    v_mfma_f32_16x16x32_bf16 v[28:31], a[76:79], v[184:187], v[28:31]
    ds_read_b64_tr_b16 a[104:105], v225 offset:16960
    v_add_f32 v233, v233, v217
    v_add_f32 v218, v212, v213
    v_mfma_f32_16x16x32_bf16 v[32:35], a[80:83], v[184:187], v[32:35]
    ds_read_b64_tr_b16 a[106:107], v225 offset:17472
    v_exp_f32 v214, v174
    v_mfma_f32_16x16x32_bf16 v[36:39], a[84:87], v[184:187], v[36:39]
    v_cvt_pk_bf16_f32 v190, v212, v213
    v_exp_f32 v215, v175
    v_mfma_f32_16x16x32_bf16 v[40:43], a[88:91], v[184:187], v[40:43]
    ds_read_b64_tr_b16 a[108:109], v225 offset:16992
    v_add_f32 v233, v233, v218
    v_add_f32 v219, v214, v215
    v_mfma_f32_16x16x32_bf16 v[44:47], a[92:95], v[184:187], v[44:47]
    s_waitcnt lgkmcnt(7)
    v_cvt_pk_bf16_f32 v191, v214, v215
    v_add_f32 v233, v233, v219
    v_cmp_nge_f32 vcc, s32, v233
    v_mfma_f32_16x16x32_bf16 v[160:163], a[32:35], v[112:115], v[196:199]
    s_add_u32 m0, s28, 51488
    ds_read_b64_tr_b16 a[110:111], v225 offset:17504
    v_exp_f32 v208, v176
    v_mfma_f32_16x16x32_bf16 v[164:167], a[48:51], v[112:115], v[196:199]
    s_waitcnt vmcnt(3)
    s_cbranch_vccnz L_stub_21
L_back_22:
    buffer_load_dwordx4 v229, s[4:7], s27 offen offset:256 nt lds
    v_mfma_f32_16x16x32_bf16 v[160:163], a[36:39], v[116:119], v[160:163]
    ds_read_b64_tr_b16 a[112:113], v225 offset:17024
    v_exp_f32 v209, v177
    v_mfma_f32_16x16x32_bf16 v[164:167], a[52:55], v[116:119], v[164:167]
    v_add_f32 v221, v221, v233
    v_add_f32 v234, v208, v209
    v_mfma_f32_16x16x32_bf16 v[160:163], a[40:43], v[120:123], v[160:163]
    ds_read_b64_tr_b16 a[114:115], v225 offset:17536
    v_cvt_pk_bf16_f32 v192, v208, v209
    v_mfma_f32_16x16x32_bf16 v[164:167], a[56:59], v[120:123], v[164:167]
    ds_read_b64_tr_b16 a[116:117], v225 offset:17056
    v_exp_f32 v210, v178
    v_mfma_f32_16x16x32_bf16 v[160:163], a[44:47], v[124:127], v[160:163]
    ds_read_b64_tr_b16 a[118:119], v225 offset:17568
    v_exp_f32 v211, v179
    v_mfma_f32_16x16x32_bf16 v[164:167], a[60:63], v[124:127], v[164:167]
    v_add_f32 v217, v210, v211
    v_cvt_pk_bf16_f32 v193, v210, v211
    v_mfma_f32_16x16x32_bf16 v[48:51], a[64:67], v[188:191], v[48:51]
    ds_read_b64_tr_b16 a[120:121], v225 offset:17088
    v_exp_f32 v212, v180
    v_mfma_f32_16x16x32_bf16 v[52:55], a[68:71], v[188:191], v[52:55]
    v_exp_f32 v213, v181
    v_mfma_f32_16x16x32_bf16 v[56:59], a[72:75], v[188:191], v[56:59]
    ds_read_b64_tr_b16 a[122:123], v225 offset:17600
    v_add_f32 v234, v234, v217
    v_add_f32 v218, v212, v213
    v_mfma_f32_16x16x32_bf16 v[60:63], a[76:79], v[188:191], v[60:63]
    v_cvt_pk_bf16_f32 v194, v212, v213
    v_exp_f32 v214, v182
    v_mfma_f32_16x16x32_bf16 v[64:67], a[80:83], v[188:191], v[64:67]
    s_add_u32 m0, s28, 59136
    ds_read_b64_tr_b16 a[124:125], v225 offset:17120
    v_exp_f32 v215, v183
    v_mfma_f32_16x16x32_bf16 v[68:71], a[84:87], v[188:191], v[68:71]
    s_waitcnt vmcnt(3)
    buffer_load_dwordx4 v229, s[8:11], s27 offen nt lds
    v_mfma_f32_16x16x32_bf16 v[72:75], a[88:91], v[188:191], v[72:75]
    ds_read_b64_tr_b16 a[126:127], v225 offset:17632
    v_add_f32 v234, v234, v218
    v_add_f32 v219, v214, v215
    v_mfma_f32_16x16x32_bf16 v[76:79], a[92:95], v[188:191], v[76:79]
    v_cvt_pk_bf16_f32 v195, v214, v215
    v_add_f32 v234, v234, v219
    v_cmp_nge_f32 vcc, s32, v234
    v_mfma_f32_16x16x32_bf16 v[168:171], a[32:35], v[128:131], v[200:203]
    v_exp_f32 v208, v160
    v_mfma_f32_16x16x32_bf16 v[172:175], a[48:51], v[128:131], v[200:203]
    s_cbranch_vccnz L_stub_23
L_back_24:
    v_add_u32 v224, 0, v226
    v_add_f32 v222, v222, v234
    v_mfma_f32_16x16x32_bf16 v[168:171], a[36:39], v[132:135], v[168:171]
    v_add_u32 v225, 0, v227
    v_exp_f32 v209, v161
    v_mfma_f32_16x16x32_bf16 v[172:175], a[52:55], v[132:135], v[172:175]
    s_waitcnt lgkmcnt(0)
    s_barrier
    v_mfma_f32_16x16x32_bf16 v[168:171], a[40:43], v[136:139], v[168:171]
    ds_read_b128 a[0:3], v224 offset:0
    v_add_f32 v232, v208, v209
    v_mfma_f32_16x16x32_bf16 v[172:175], a[56:59], v[136:139], v[172:175]
    v_exp_f32 v210, v162
    v_mfma_f32_16x16x32_bf16 v[168:171], a[44:47], v[140:143], v[168:171]
    ds_read_b128 a[16:19], v224 offset:512
    v_exp_f32 v211, v163
    v_mfma_f32_16x16x32_bf16 v[172:175], a[60:63], v[140:143], v[172:175]
    v_cvt_pk_bf16_f32 v184, v208, v209
    v_add_f32 v217, v210, v211
    v_mfma_f32_16x16x32_bf16 v[80:83], a[64:67], v[192:195], v[80:83]
    s_add_u32 m0, s28, 59936
    ds_read_b128 a[4:7], v224 offset:64
    v_exp_f32 v212, v164
    v_mfma_f32_16x16x32_bf16 v[84:87], a[68:71], v[192:195], v[84:87]
    s_waitcnt vmcnt(3)
    buffer_load_dwordx4 v229, s[8:11], s27 offen offset:256 nt lds
    v_mfma_f32_16x16x32_bf16 v[88:91], a[72:75], v[192:195], v[88:91]
    ds_read_b128 a[20:23], v224 offset:576
    v_exp_f32 v213, v165
    v_mfma_f32_16x16x32_bf16 v[92:95], a[76:79], v[192:195], v[92:95]
    v_cvt_pk_bf16_f32 v185, v210, v211
    v_add_f32 v232, v232, v217
    v_add_f32 v218, v212, v213
    v_mfma_f32_16x16x32_bf16 v[96:99], a[80:83], v[192:195], v[96:99]
    ds_read_b128 a[8:11], v224 offset:128
    v_exp_f32 v214, v166
    v_mfma_f32_16x16x32_bf16 v[100:103], a[84:87], v[192:195], v[100:103]
    v_cvt_pk_bf16_f32 v186, v212, v213
    v_exp_f32 v215, v167
    v_mfma_f32_16x16x32_bf16 v[104:107], a[88:91], v[192:195], v[104:107]
    ds_read_b128 a[24:27], v224 offset:640
    v_add_f32 v232, v232, v218
    v_add_f32 v219, v214, v215
    v_mfma_f32_16x16x32_bf16 v[108:111], a[92:95], v[192:195], v[108:111]
    v_cvt_pk_bf16_f32 v187, v214, v215
    v_add_f32 v232, v232, v219
    v_cmp_nge_f32 vcc, s32, v232
    v_mfma_f32_16x16x32_bf16 v[176:179], a[32:35], v[144:147], v[204:207]
    ds_read_b128 a[12:15], v224 offset:192
    v_exp_f32 v208, v168
    v_mfma_f32_16x16x32_bf16 v[180:183], a[48:51], v[144:147], v[204:207]
    s_cbranch_vccnz L_stub_25
L_back_26:
    v_add_f32 v220, v220, v232
    v_mfma_f32_16x16x32_bf16 v[176:179], a[36:39], v[148:151], v[176:179]
    ds_read_b128 a[28:31], v224 offset:704
    v_exp_f32 v209, v169
    v_mfma_f32_16x16x32_bf16 v[180:183], a[52:55], v[148:151], v[180:183]
    s_mov_b32 s27, 81920
    v_exp_f32 v210, v170
    v_mfma_f32_16x16x32_bf16 v[176:179], a[40:43], v[152:155], v[176:179]
    s_add_u32 m0, s28, 67584
    ds_read_b64_tr_b16 a[64:65], v225 offset:0
    v_add_f32 v233, v208, v209
    v_mfma_f32_16x16x32_bf16 v[180:183], a[56:59], v[152:155], v[180:183]
    s_waitcnt vmcnt(3)
    buffer_load_dwordx4 v228, s[4:7], s27 offen nt lds
    v_mfma_f32_16x16x32_bf16 v[176:179], a[44:47], v[156:159], v[176:179]
    ds_read_b64_tr_b16 a[66:67], v225 offset:512
    v_cvt_pk_bf16_f32 v188, v208, v209
    v_mfma_f32_16x16x32_bf16 v[180:183], a[60:63], v[156:159], v[180:183]
    v_exp_f32 v211, v171
    v_mfma_f32_16x16x32_bf16 v[16:19], a[96:99], v[184:187], v[16:19]
    ds_read_b64_tr_b16 a[68:69], v225 offset:32
    v_add_f32 v217, v210, v211
    v_mfma_f32_16x16x32_bf16 v[20:23], a[100:103], v[184:187], v[20:23]
    v_cvt_pk_bf16_f32 v189, v210, v211
    v_add_f32 v233, v233, v217
    v_mfma_f32_16x16x32_bf16 v[24:27], a[104:107], v[184:187], v[24:27]
    ds_read_b64_tr_b16 a[70:71], v225 offset:544
    v_exp_f32 v212, v172
    v_mfma_f32_16x16x32_bf16 v[28:31], a[108:111], v[184:187], v[28:31]
    v_exp_f32 v213, v173
    v_mfma_f32_16x16x32_bf16 v[32:35], a[112:115], v[184:187], v[32:35]
    ds_read_b64_tr_b16 a[72:73], v225 offset:64
    v_exp_f32 v214, v174
    v_mfma_f32_16x16x32_bf16 v[36:39], a[116:119], v[184:187], v[36:39]
    v_add_f32 v218, v212, v213
    v_exp_f32 v215, v175
    v_mfma_f32_16x16x32_bf16 v[40:43], a[120:123], v[184:187], v[40:43]
    v_cvt_pk_bf16_f32 v190, v212, v213
    v_add_f32 v233, v233, v218
    v_add_f32 v219, v214, v215
    v_mfma_f32_16x16x32_bf16 v[44:47], a[124:127], v[184:187], v[44:47]
    s_waitcnt lgkmcnt(5)
    v_cvt_pk_bf16_f32 v191, v214, v215
    v_add_f32 v233, v233, v219
    v_cmp_nge_f32 vcc, s32, v233
    v_mfma_f32_16x16x32_bf16 v[160:163], a[0:3], v[112:115], v[196:199]
    s_add_u32 m0, s28, 68384
    ds_read_b64_tr_b16 a[74:75], v225 offset:576
    v_exp_f32 v208, v176
    v_mfma_f32_16x16x32_bf16 v[164:167], a[16:19], v[112:115], v[196:199]
    s_waitcnt vmcnt(3)
    s_cbranch_vccnz L_stub_27
L_back_28:
    buffer_load_dwordx4 v228, s[4:7], s27 offen offset:256 nt lds
    v_mfma_f32_16x16x32_bf16 v[160:163], a[4:7], v[116:119], v[160:163]
    ds_read_b64_tr_b16 a[76:77], v225 offset:96
    v_exp_f32 v209, v177
    v_mfma_f32_16x16x32_bf16 v[164:167], a[20:23], v[116:119], v[164:167]
    v_add_f32 v221, v221, v233
    v_add_f32 v234, v208, v209
    v_mfma_f32_16x16x32_bf16 v[160:163], a[8:11], v[120:123], v[160:163]
    ds_read_b64_tr_b16 a[78:79], v225 offset:608
    v_cvt_pk_bf16_f32 v192, v208, v209
    v_mfma_f32_16x16x32_bf16 v[164:167], a[24:27], v[120:123], v[164:167]
    v_exp_f32 v210, v178
    v_mfma_f32_16x16x32_bf16 v[160:163], a[12:15], v[124:127], v[160:163]
    ds_read_b64_tr_b16 a[80:81], v225 offset:128
    v_exp_f32 v211, v179
    v_mfma_f32_16x16x32_bf16 v[164:167], a[28:31], v[124:127], v[164:167]
    v_add_f32 v217, v210, v211
    v_cvt_pk_bf16_f32 v193, v210, v211
    v_mfma_f32_16x16x32_bf16 v[48:51], a[96:99], v[188:191], v[48:51]
    ds_read_b64_tr_b16 a[82:83], v225 offset:640
    v_exp_f32 v212, v180
    v_mfma_f32_16x16x32_bf16 v[52:55], a[100:103], v[188:191], v[52:55]
    v_exp_f32 v213, v181
    v_mfma_f32_16x16x32_bf16 v[56:59], a[104:107], v[188:191], v[56:59]
    ds_read_b64_tr_b16 a[84:85], v225 offset:160
    v_add_f32 v234, v234, v217
    v_add_f32 v218, v212, v213
    v_mfma_f32_16x16x32_bf16 v[60:63], a[108:111], v[188:191], v[60:63]
    v_cvt_pk_bf16_f32 v194, v212, v213
    v_exp_f32 v214, v182
    v_mfma_f32_16x16x32_bf16 v[64:67], a[112:115], v[188:191], v[64:67]
    s_add_u32 m0, s28, 76032
    ds_read_b64_tr_b16 a[86:87], v225 offset:672
    v_exp_f32 v215, v183
    v_mfma_f32_16x16x32_bf16 v[68:71], a[116:119], v[188:191], v[68:71]
    s_waitcnt vmcnt(3)
    buffer_load_dwordx4 v228, s[8:11], s27 offen nt lds
    v_mfma_f32_16x16x32_bf16 v[72:75], a[120:123], v[188:191], v[72:75]
    ds_read_b64_tr_b16 a[88:89], v225 offset:192
    v_add_f32 v234, v234, v218
    v_add_f32 v219, v214, v215
    v_mfma_f32_16x16x32_bf16 v[76:79], a[124:127], v[188:191], v[76:79]
    v_cvt_pk_bf16_f32 v195, v214, v215
    v_add_f32 v234, v234, v219
    v_cmp_nge_f32 vcc, s32, v234
    v_mfma_f32_16x16x32_bf16 v[168:171], a[0:3], v[128:131], v[200:203]
    ds_read_b64_tr_b16 a[90:91], v225 offset:704
    v_exp_f32 v208, v160
    v_mfma_f32_16x16x32_bf16 v[172:175], a[16:19], v[128:131], v[200:203]
    s_cbranch_vccnz L_stub_29
L_back_30:
    v_add_f32 v222, v222, v234
    v_mfma_f32_16x16x32_bf16 v[168:171], a[4:7], v[132:135], v[168:171]
    ds_read_b64_tr_b16 a[92:93], v225 offset:224
    v_exp_f32 v209, v161
    v_mfma_f32_16x16x32_bf16 v[172:175], a[20:23], v[132:135], v[172:175]
    v_add_f32 v232, v208, v209
    v_cvt_pk_bf16_f32 v184, v208, v209
    v_mfma_f32_16x16x32_bf16 v[168:171], a[8:11], v[136:139], v[168:171]
    ds_read_b64_tr_b16 a[94:95], v225 offset:736
    v_exp_f32 v210, v162
    v_mfma_f32_16x16x32_bf16 v[172:175], a[24:27], v[136:139], v[172:175]
    v_exp_f32 v211, v163
    v_mfma_f32_16x16x32_bf16 v[168:171], a[12:15], v[140:143], v[168:171]
    ds_read_b128 a[32:35], v224 offset:16896
    v_add_f32 v217, v210, v211
    v_mfma_f32_16x16x32_bf16 v[172:175], a[28:31], v[140:143], v[172:175]
    v_exp_f32 v212, v164
    v_mfma_f32_16x16x32_bf16 v[80:83], a[96:99], v[192:195], v[80:83]
    s_add_u32 m0, s28, 76832
    ds_read_b128 a[48:51], v224 offset:17408
    v_cvt_pk_bf16_f32 v185, v210, v211
    v_mfma_f32_16x16x32_bf16 v[84:87], a[100:103], v[192:195], v[84:87]
    s_waitcnt vmcnt(3)
    buffer_load_dwordx4 v228, s[8:11], s27 offen offset:256 nt lds
    v_mfma_f32_16x16x32_bf16 v[88:91], a[104:107], v[192:195], v[88:91]
    ds_read_b128 a[36:39], v224 offset:16960
    v_exp_f32 v213, v165
    v_mfma_f32_16x16x32_bf16 v[92:95], a[108:111], v[192:195], v[92:95]
    v_add_f32 v232, v232, v217
    v_add_f32 v218, v212, v213
    v_mfma_f32_16x16x32_bf16 v[96:99], a[112:115], v[192:195], v[96:99]
    ds_read_b128 a[52:55], v224 offset:17472
    v_exp_f32 v214, v166
    v_mfma_f32_16x16x32_bf16 v[100:103], a[116:119], v[192:195], v[100:103]
    v_cvt_pk_bf16_f32 v186, v212, v213
    v_exp_f32 v215, v167
    v_mfma_f32_16x16x32_bf16 v[104:107], a[120:123], v[192:195], v[104:107]
    ds_read_b128 a[40:43], v224 offset:17024
    v_add_f32 v232, v232, v218
    v_add_f32 v219, v214, v215
    v_mfma_f32_16x16x32_bf16 v[108:111], a[124:127], v[192:195], v[108:111]
    v_cvt_pk_bf16_f32 v187, v214, v215
    v_add_f32 v232, v232, v219
    v_cmp_nge_f32 vcc, s32, v232
    v_mfma_f32_16x16x32_bf16 v[176:179], a[0:3], v[144:147], v[204:207]
    ds_read_b128 a[56:59], v224 offset:17536
    v_exp_f32 v208, v168
    v_mfma_f32_16x16x32_bf16 v[180:183], a[16:19], v[144:147], v[204:207]
    s_cbranch_vccnz L_stub_31
L_back_32:
    v_exp_f32 v209, v169
    v_mfma_f32_16x16x32_bf16 v[176:179], a[4:7], v[148:151], v[176:179]
    ds_read_b128 a[44:47], v224 offset:17088
    v_add_f32 v220, v220, v232
    v_add_f32 v233, v208, v209
    v_mfma_f32_16x16x32_bf16 v[180:183], a[20:23], v[148:151], v[180:183]
    v_exp_f32 v210, v170
    v_mfma_f32_16x16x32_bf16 v[176:179], a[8:11], v[152:155], v[176:179]
    s_add_u32 m0, s28, 84480
    ds_read_b128 a[60:63], v224 offset:17600
    v_cvt_pk_bf16_f32 v188, v208, v209
    v_mfma_f32_16x16x32_bf16 v[180:183], a[24:27], v[152:155], v[180:183]
    s_waitcnt vmcnt(3)
    buffer_load_dwordx4 v229, s[4:7], s27 offen nt lds
    v_mfma_f32_16x16x32_bf16 v[176:179], a[12:15], v[156:159], v[176:179]
    ds_read_b64_tr_b16 a[96:97], v225 offset:16896
    v_exp_f32 v211, v171
    v_mfma_f32_16x16x32_bf16 v[180:183], a[28:31], v[156:159], v[180:183]
    s_waitcnt lgkmcnt(9)
    ds_read_b64_tr_b16 a[98:99], v225 offset:17408
    v_add_f32 v217, v210, v211
    v_mfma_f32_16x16x32_bf16 v[16:19], a[64:67], v[184:187], v[16:19]
    ds_read_b64_tr_b16 a[100:101], v225 offset:16928
    v_cvt_pk_bf16_f32 v189, v210, v211
    v_mfma_f32_16x16x32_bf16 v[20:23], a[68:71], v[184:187], v[20:23]
    v_exp_f32 v212, v172
    v_mfma_f32_16x16x32_bf16 v[24:27], a[72:75], v[184:187], v[24:27]
    ds_read_b64_tr_b16 a[102:103], v225 offset:17440
    v_exp_f32 v213, v173
    v_mfma_f32_16x16x32_bf16 v[28:31], a[76:79], v[184:187], v[28:31]
    ds_read_b64_tr_b16 a[104:105], v225 offset:16960
    v_add_f32 v233, v233, v217
    v_add_f32 v218, v212, v213
    v_mfma_f32_16x16x32_bf16 v[32:35], a[80:83], v[184:187], v[32:35]
    ds_read_b64_tr_b16 a[106:107], v225 offset:17472
    v_exp_f32 v214, v174
    v_mfma_f32_16x16x32_bf16 v[36:39], a[84:87], v[184:187], v[36:39]
    v_cvt_pk_bf16_f32 v190, v212, v213
    v_exp_f32 v215, v175
    v_mfma_f32_16x16x32_bf16 v[40:43], a[88:91], v[184:187], v[40:43]
    ds_read_b64_tr_b16 a[108:109], v225 offset:16992
    v_add_f32 v233, v233, v218
    v_add_f32 v219, v214, v215
    v_mfma_f32_16x16x32_bf16 v[44:47], a[92:95], v[184:187], v[44:47]
    s_waitcnt lgkmcnt(7)
    v_cvt_pk_bf16_f32 v191, v214, v215
    v_add_f32 v233, v233, v219
    v_cmp_nge_f32 vcc, s32, v233
    v_mfma_f32_16x16x32_bf16 v[160:163], a[32:35], v[112:115], v[196:199]
    s_add_u32 m0, s28, 85280
    ds_read_b64_tr_b16 a[110:111], v225 offset:17504
    v_exp_f32 v208, v176
    v_mfma_f32_16x16x32_bf16 v[164:167], a[48:51], v[112:115], v[196:199]
    s_waitcnt vmcnt(3)
    s_cbranch_vccnz L_stub_33
L_back_34:
    buffer_load_dwordx4 v229, s[4:7], s27 offen offset:256 nt lds
    v_mfma_f32_16x16x32_bf16 v[160:163], a[36:39], v[116:119], v[160:163]
    ds_read_b64_tr_b16 a[112:113], v225 offset:17024
    v_exp_f32 v209, v177
    v_mfma_f32_16x16x32_bf16 v[164:167], a[52:55], v[116:119], v[164:167]
    v_add_f32 v221, v221, v233
    v_add_f32 v234, v208, v209
    v_mfma_f32_16x16x32_bf16 v[160:163], a[40:43], v[120:123], v[160:163]
    ds_read_b64_tr_b16 a[114:115], v225 offset:17536
    v_cvt_pk_bf16_f32 v192, v208, v209
    v_mfma_f32_16x16x32_bf16 v[164:167], a[56:59], v[120:123], v[164:167]
    ds_read_b64_tr_b16 a[116:117], v225 offset:17056
    v_exp_f32 v210, v178
    v_mfma_f32_16x16x32_bf16 v[160:163], a[44:47], v[124:127], v[160:163]
    ds_read_b64_tr_b16 a[118:119], v225 offset:17568
    v_exp_f32 v211, v179
    v_mfma_f32_16x16x32_bf16 v[164:167], a[60:63], v[124:127], v[164:167]
    v_add_f32 v217, v210, v211
    v_cvt_pk_bf16_f32 v193, v210, v211
    v_mfma_f32_16x16x32_bf16 v[48:51], a[64:67], v[188:191], v[48:51]
    ds_read_b64_tr_b16 a[120:121], v225 offset:17088
    v_exp_f32 v212, v180
    v_mfma_f32_16x16x32_bf16 v[52:55], a[68:71], v[188:191], v[52:55]
    v_exp_f32 v213, v181
    v_mfma_f32_16x16x32_bf16 v[56:59], a[72:75], v[188:191], v[56:59]
    ds_read_b64_tr_b16 a[122:123], v225 offset:17600
    v_add_f32 v234, v234, v217
    v_add_f32 v218, v212, v213
    v_mfma_f32_16x16x32_bf16 v[60:63], a[76:79], v[188:191], v[60:63]
    v_cvt_pk_bf16_f32 v194, v212, v213
    v_exp_f32 v214, v182
    v_mfma_f32_16x16x32_bf16 v[64:67], a[80:83], v[188:191], v[64:67]
    s_add_u32 m0, s28, 92928
    ds_read_b64_tr_b16 a[124:125], v225 offset:17120
    v_exp_f32 v215, v183
    v_mfma_f32_16x16x32_bf16 v[68:71], a[84:87], v[188:191], v[68:71]
    s_waitcnt vmcnt(3)
    buffer_load_dwordx4 v229, s[8:11], s27 offen nt lds
    v_mfma_f32_16x16x32_bf16 v[72:75], a[88:91], v[188:191], v[72:75]
    ds_read_b64_tr_b16 a[126:127], v225 offset:17632
    v_add_f32 v234, v234, v218
    v_add_f32 v219, v214, v215
    v_mfma_f32_16x16x32_bf16 v[76:79], a[92:95], v[188:191], v[76:79]
    v_cvt_pk_bf16_f32 v195, v214, v215
    v_add_f32 v234, v234, v219
    v_cmp_nge_f32 vcc, s32, v234
    v_mfma_f32_16x16x32_bf16 v[168:171], a[32:35], v[128:131], v[200:203]
    v_exp_f32 v208, v160
    v_mfma_f32_16x16x32_bf16 v[172:175], a[48:51], v[128:131], v[200:203]
    s_cbranch_vccnz L_stub_35
L_back_36:
    v_add_u32 v224, 33792, v226
    v_add_f32 v222, v222, v234
    v_mfma_f32_16x16x32_bf16 v[168:171], a[36:39], v[132:135], v[168:171]
    v_add_u32 v225, 33792, v227
    v_exp_f32 v209, v161
    v_mfma_f32_16x16x32_bf16 v[172:175], a[52:55], v[132:135], v[172:175]
    s_waitcnt lgkmcnt(0)
    s_barrier
    v_mfma_f32_16x16x32_bf16 v[168:171], a[40:43], v[136:139], v[168:171]
    ds_read_b128 a[0:3], v224 offset:0
    v_add_f32 v232, v208, v209
    v_mfma_f32_16x16x32_bf16 v[172:175], a[56:59], v[136:139], v[172:175]
    v_exp_f32 v210, v162
    v_mfma_f32_16x16x32_bf16 v[168:171], a[44:47], v[140:143], v[168:171]
    ds_read_b128 a[16:19], v224 offset:512
    v_exp_f32 v211, v163
    v_mfma_f32_16x16x32_bf16 v[172:175], a[60:63], v[140:143], v[172:175]
    v_cvt_pk_bf16_f32 v184, v208, v209
    v_add_f32 v217, v210, v211
    v_mfma_f32_16x16x32_bf16 v[80:83], a[64:67], v[192:195], v[80:83]
    s_add_u32 m0, s28, 93728
    ds_read_b128 a[4:7], v224 offset:64
    v_exp_f32 v212, v164
    v_mfma_f32_16x16x32_bf16 v[84:87], a[68:71], v[192:195], v[84:87]
    s_waitcnt vmcnt(3)
    buffer_load_dwordx4 v229, s[8:11], s27 offen offset:256 nt lds
    v_mfma_f32_16x16x32_bf16 v[88:91], a[72:75], v[192:195], v[88:91]
    ds_read_b128 a[20:23], v224 offset:576
    v_exp_f32 v213, v165
    v_mfma_f32_16x16x32_bf16 v[92:95], a[76:79], v[192:195], v[92:95]
    v_cvt_pk_bf16_f32 v185, v210, v211
    v_add_f32 v232, v232, v217
    v_add_f32 v218, v212, v213
    v_mfma_f32_16x16x32_bf16 v[96:99], a[80:83], v[192:195], v[96:99]
    ds_read_b128 a[8:11], v224 offset:128
    v_exp_f32 v214, v166
    v_mfma_f32_16x16x32_bf16 v[100:103], a[84:87], v[192:195], v[100:103]
    v_cvt_pk_bf16_f32 v186, v212, v213
    v_exp_f32 v215, v167
    v_mfma_f32_16x16x32_bf16 v[104:107], a[88:91], v[192:195], v[104:107]
    ds_read_b128 a[24:27], v224 offset:640
    v_add_f32 v232, v232, v218
    v_add_f32 v219, v214, v215
    v_mfma_f32_16x16x32_bf16 v[108:111], a[92:95], v[192:195], v[108:111]
    v_cvt_pk_bf16_f32 v187, v214, v215
    v_add_f32 v232, v232, v219
    v_cmp_nge_f32 vcc, s32, v232
    v_mfma_f32_16x16x32_bf16 v[176:179], a[32:35], v[144:147], v[204:207]
    ds_read_b128 a[12:15], v224 offset:192
    v_exp_f32 v208, v168
    v_mfma_f32_16x16x32_bf16 v[180:183], a[48:51], v[144:147], v[204:207]
    s_cbranch_vccnz L_stub_37
L_back_38:
    v_add_f32 v220, v220, v232
    v_mfma_f32_16x16x32_bf16 v[176:179], a[36:39], v[148:151], v[176:179]
    ds_read_b128 a[28:31], v224 offset:704
    v_exp_f32 v209, v169
    v_mfma_f32_16x16x32_bf16 v[180:183], a[52:55], v[148:151], v[180:183]
    s_mov_b32 s27, 98304
    v_exp_f32 v210, v170
    v_mfma_f32_16x16x32_bf16 v[176:179], a[40:43], v[152:155], v[176:179]
    s_add_u32 m0, s28, 0
    ds_read_b64_tr_b16 a[64:65], v225 offset:0
    v_add_f32 v233, v208, v209
    v_mfma_f32_16x16x32_bf16 v[180:183], a[56:59], v[152:155], v[180:183]
    s_waitcnt vmcnt(3)
    buffer_load_dwordx4 v228, s[4:7], s27 offen nt lds
    v_mfma_f32_16x16x32_bf16 v[176:179], a[44:47], v[156:159], v[176:179]
    ds_read_b64_tr_b16 a[66:67], v225 offset:512
    v_cvt_pk_bf16_f32 v188, v208, v209
    v_mfma_f32_16x16x32_bf16 v[180:183], a[60:63], v[156:159], v[180:183]
    v_exp_f32 v211, v171
    v_mfma_f32_16x16x32_bf16 v[16:19], a[96:99], v[184:187], v[16:19]
    ds_read_b64_tr_b16 a[68:69], v225 offset:32
    v_add_f32 v217, v210, v211
    v_mfma_f32_16x16x32_bf16 v[20:23], a[100:103], v[184:187], v[20:23]
    v_cvt_pk_bf16_f32 v189, v210, v211
    v_add_f32 v233, v233, v217
    v_mfma_f32_16x16x32_bf16 v[24:27], a[104:107], v[184:187], v[24:27]
    ds_read_b64_tr_b16 a[70:71], v225 offset:544
    v_exp_f32 v212, v172
    v_mfma_f32_16x16x32_bf16 v[28:31], a[108:111], v[184:187], v[28:31]
    v_exp_f32 v213, v173
    v_mfma_f32_16x16x32_bf16 v[32:35], a[112:115], v[184:187], v[32:35]
    ds_read_b64_tr_b16 a[72:73], v225 offset:64
    v_exp_f32 v214, v174
    v_mfma_f32_16x16x32_bf16 v[36:39], a[116:119], v[184:187], v[36:39]
    v_add_f32 v218, v212, v213
    v_exp_f32 v215, v175
    v_mfma_f32_16x16x32_bf16 v[40:43], a[120:123], v[184:187], v[40:43]
    v_cvt_pk_bf16_f32 v190, v212, v213
    v_add_f32 v233, v233, v218
    v_add_f32 v219, v214, v215
    v_mfma_f32_16x16x32_bf16 v[44:47], a[124:127], v[184:187], v[44:47]
    s_waitcnt lgkmcnt(5)
    v_cvt_pk_bf16_f32 v191, v214, v215
    v_add_f32 v233, v233, v219
    v_cmp_nge_f32 vcc, s32, v233
    v_mfma_f32_16x16x32_bf16 v[160:163], a[0:3], v[112:115], v[196:199]
    s_add_u32 m0, s28, 800
    ds_read_b64_tr_b16 a[74:75], v225 offset:576
    v_exp_f32 v208, v176
    v_mfma_f32_16x16x32_bf16 v[164:167], a[16:19], v[112:115], v[196:199]
    s_waitcnt vmcnt(3)
    s_cbranch_vccnz L_stub_39
L_back_40:
    buffer_load_dwordx4 v228, s[4:7], s27 offen offset:256 nt lds
    v_mfma_f32_16x16x32_bf16 v[160:163], a[4:7], v[116:119], v[160:163]
    ds_read_b64_tr_b16 a[76:77], v225 offset:96
    v_exp_f32 v209, v177
    v_mfma_f32_16x16x32_bf16 v[164:167], a[20:23], v[116:119], v[164:167]
    v_add_f32 v221, v221, v233
    v_add_f32 v234, v208, v209
    v_mfma_f32_16x16x32_bf16 v[160:163], a[8:11], v[120:123], v[160:163]
    ds_read_b64_tr_b16 a[78:79], v225 offset:608
    v_cvt_pk_bf16_f32 v192, v208, v209
    v_mfma_f32_16x16x32_bf16 v[164:167], a[24:27], v[120:123], v[164:167]
    v_exp_f32 v210, v178
    v_mfma_f32_16x16x32_bf16 v[160:163], a[12:15], v[124:127], v[160:163]
    ds_read_b64_tr_b16 a[80:81], v225 offset:128
    v_exp_f32 v211, v179
    v_mfma_f32_16x16x32_bf16 v[164:167], a[28:31], v[124:127], v[164:167]
    v_add_f32 v217, v210, v211
    v_cvt_pk_bf16_f32 v193, v210, v211
    v_mfma_f32_16x16x32_bf16 v[48:51], a[96:99], v[188:191], v[48:51]
    ds_read_b64_tr_b16 a[82:83], v225 offset:640
    v_exp_f32 v212, v180
    v_mfma_f32_16x16x32_bf16 v[52:55], a[100:103], v[188:191], v[52:55]
    v_exp_f32 v213, v181
    v_mfma_f32_16x16x32_bf16 v[56:59], a[104:107], v[188:191], v[56:59]
    ds_read_b64_tr_b16 a[84:85], v225 offset:160
    v_add_f32 v234, v234, v217
    v_add_f32 v218, v212, v213
    v_mfma_f32_16x16x32_bf16 v[60:63], a[108:111], v[188:191], v[60:63]
    v_cvt_pk_bf16_f32 v194, v212, v213
    v_exp_f32 v214, v182
    v_mfma_f32_16x16x32_bf16 v[64:67], a[112:115], v[188:191], v[64:67]
    s_add_u32 m0, s28, 8448
    ds_read_b64_tr_b16 a[86:87], v225 offset:672
    v_exp_f32 v215, v183
    v_mfma_f32_16x16x32_bf16 v[68:71], a[116:119], v[188:191], v[68:71]
    s_waitcnt vmcnt(3)
    buffer_load_dwordx4 v228, s[8:11], s27 offen nt lds
    v_mfma_f32_16x16x32_bf16 v[72:75], a[120:123], v[188:191], v[72:75]
    ds_read_b64_tr_b16 a[88:89], v225 offset:192
    v_add_f32 v234, v234, v218
    v_add_f32 v219, v214, v215
    v_mfma_f32_16x16x32_bf16 v[76:79], a[124:127], v[188:191], v[76:79]
    v_cvt_pk_bf16_f32 v195, v214, v215
    v_add_f32 v234, v234, v219
    v_cmp_nge_f32 vcc, s32, v234
    v_mfma_f32_16x16x32_bf16 v[168:171], a[0:3], v[128:131], v[200:203]
    ds_read_b64_tr_b16 a[90:91], v225 offset:704
    v_exp_f32 v208, v160
    v_mfma_f32_16x16x32_bf16 v[172:175], a[16:19], v[128:131], v[200:203]
    s_cbranch_vccnz L_stub_41
L_back_42:
    v_add_f32 v222, v222, v234
    v_mfma_f32_16x16x32_bf16 v[168:171], a[4:7], v[132:135], v[168:171]
    ds_read_b64_tr_b16 a[92:93], v225 offset:224
    v_exp_f32 v209, v161
    v_mfma_f32_16x16x32_bf16 v[172:175], a[20:23], v[132:135], v[172:175]
    v_add_f32 v232, v208, v209
    v_cvt_pk_bf16_f32 v184, v208, v209
    v_mfma_f32_16x16x32_bf16 v[168:171], a[8:11], v[136:139], v[168:171]
    ds_read_b64_tr_b16 a[94:95], v225 offset:736
    v_exp_f32 v210, v162
    v_mfma_f32_16x16x32_bf16 v[172:175], a[24:27], v[136:139], v[172:175]
    v_exp_f32 v211, v163
    v_mfma_f32_16x16x32_bf16 v[168:171], a[12:15], v[140:143], v[168:171]
    ds_read_b128 a[32:35], v224 offset:16896
    v_add_f32 v217, v210, v211
    v_mfma_f32_16x16x32_bf16 v[172:175], a[28:31], v[140:143], v[172:175]
    v_exp_f32 v212, v164
    v_mfma_f32_16x16x32_bf16 v[80:83], a[96:99], v[192:195], v[80:83]
    s_add_u32 m0, s28, 9248
    ds_read_b128 a[48:51], v224 offset:17408
    v_cvt_pk_bf16_f32 v185, v210, v211
    v_mfma_f32_16x16x32_bf16 v[84:87], a[100:103], v[192:195], v[84:87]
    s_waitcnt vmcnt(3)
    buffer_load_dwordx4 v228, s[8:11], s27 offen offset:256 nt lds
    v_mfma_f32_16x16x32_bf16 v[88:91], a[104:107], v[192:195], v[88:91]
    ds_read_b128 a[36:39], v224 offset:16960
    v_exp_f32 v213, v165
    v_mfma_f32_16x16x32_bf16 v[92:95], a[108:111], v[192:195], v[92:95]
    v_add_f32 v232, v232, v217
    v_add_f32 v218, v212, v213
    v_mfma_f32_16x16x32_bf16 v[96:99], a[112:115], v[192:195], v[96:99]
    ds_read_b128 a[52:55], v224 offset:17472
    v_exp_f32 v214, v166
    v_mfma_f32_16x16x32_bf16 v[100:103], a[116:119], v[192:195], v[100:103]
    v_cvt_pk_bf16_f32 v186, v212, v213
    v_exp_f32 v215, v167
    v_mfma_f32_16x16x32_bf16 v[104:107], a[120:123], v[192:195], v[104:107]
    ds_read_b128 a[40:43], v224 offset:17024
    v_add_f32 v232, v232, v218
    v_add_f32 v219, v214, v215
    v_mfma_f32_16x16x32_bf16 v[108:111], a[124:127], v[192:195], v[108:111]
    v_cvt_pk_bf16_f32 v187, v214, v215
    v_add_f32 v232, v232, v219
    v_cmp_nge_f32 vcc, s32, v232
    v_mfma_f32_16x16x32_bf16 v[176:179], a[0:3], v[144:147], v[204:207]
    ds_read_b128 a[56:59], v224 offset:17536
    v_exp_f32 v208, v168
    v_mfma_f32_16x16x32_bf16 v[180:183], a[16:19], v[144:147], v[204:207]
    s_cbranch_vccnz L_stub_43
L_back_44:
    v_exp_f32 v209, v169
    v_mfma_f32_16x16x32_bf16 v[176:179], a[4:7], v[148:151], v[176:179]
    ds_read_b128 a[44:47], v224 offset:17088
    v_add_f32 v220, v220, v232
    v_add_f32 v233, v208, v209
    v_mfma_f32_16x16x32_bf16 v[180:183], a[20:23], v[148:151], v[180:183]
    v_exp_f32 v210, v170
    v_mfma_f32_16x16x32_bf16 v[176:179], a[8:11], v[152:155], v[176:179]
    s_add_u32 m0, s28, 16896
    ds_read_b128 a[60:63], v224 offset:17600
    v_cvt_pk_bf16_f32 v188, v208, v209
    v_mfma_f32_16x16x32_bf16 v[180:183], a[24:27], v[152:155], v[180:183]
    s_waitcnt vmcnt(3)
    buffer_load_dwordx4 v229, s[4:7], s27 offen nt lds
    v_mfma_f32_16x16x32_bf16 v[176:179], a[12:15], v[156:159], v[176:179]
    ds_read_b64_tr_b16 a[96:97], v225 offset:16896
    v_exp_f32 v211, v171
    v_mfma_f32_16x16x32_bf16 v[180:183], a[28:31], v[156:159], v[180:183]
    s_waitcnt lgkmcnt(9)
    ds_read_b64_tr_b16 a[98:99], v225 offset:17408
    v_add_f32 v217, v210, v211
    v_mfma_f32_16x16x32_bf16 v[16:19], a[64:67], v[184:187], v[16:19]
    ds_read_b64_tr_b16 a[100:101], v225 offset:16928
    v_cvt_pk_bf16_f32 v189, v210, v211
    v_mfma_f32_16x16x32_bf16 v[20:23], a[68:71], v[184:187], v[20:23]
    v_exp_f32 v212, v172
    v_mfma_f32_16x16x32_bf16 v[24:27], a[72:75], v[184:187], v[24:27]
    ds_read_b64_tr_b16 a[102:103], v225 offset:17440
    v_exp_f32 v213, v173
    v_mfma_f32_16x16x32_bf16 v[28:31], a[76:79], v[184:187], v[28:31]
    ds_read_b64_tr_b16 a[104:105], v225 offset:16960
    v_add_f32 v233, v233, v217
    v_add_f32 v218, v212, v213
    v_mfma_f32_16x16x32_bf16 v[32:35], a[80:83], v[184:187], v[32:35]
    ds_read_b64_tr_b16 a[106:107], v225 offset:17472
    v_exp_f32 v214, v174
    v_mfma_f32_16x16x32_bf16 v[36:39], a[84:87], v[184:187], v[36:39]
    v_cvt_pk_bf16_f32 v190, v212, v213
    v_exp_f32 v215, v175
    v_mfma_f32_16x16x32_bf16 v[40:43], a[88:91], v[184:187], v[40:43]
    ds_read_b64_tr_b16 a[108:109], v225 offset:16992
    v_add_f32 v233, v233, v218
    v_add_f32 v219, v214, v215
    v_mfma_f32_16x16x32_bf16 v[44:47], a[92:95], v[184:187], v[44:47]
    s_waitcnt lgkmcnt(7)
    v_cvt_pk_bf16_f32 v191, v214, v215
    v_add_f32 v233, v233, v219
    v_cmp_nge_f32 vcc, s32, v233
    v_mfma_f32_16x16x32_bf16 v[160:163], a[32:35], v[112:115], v[196:199]
    s_add_u32 m0, s28, 17696
    ds_read_b64_tr_b16 a[110:111], v225 offset:17504
    v_exp_f32 v208, v176
    v_mfma_f32_16x16x32_bf16 v[164:167], a[48:51], v[112:115], v[196:199]
    s_waitcnt vmcnt(3)
    s_cbranch_vccnz L_stub_45
L_back_46:
    buffer_load_dwordx4 v229, s[4:7], s27 offen offset:256 nt lds
    v_mfma_f32_16x16x32_bf16 v[160:163], a[36:39], v[116:119], v[160:163]
    ds_read_b64_tr_b16 a[112:113], v225 offset:17024
    v_exp_f32 v209, v177
    v_mfma_f32_16x16x32_bf16 v[164:167], a[52:55], v[116:119], v[164:167]
    v_add_f32 v221, v221, v233
    v_add_f32 v234, v208, v209
    v_mfma_f32_16x16x32_bf16 v[160:163], a[40:43], v[120:123], v[160:163]
    ds_read_b64_tr_b16 a[114:115], v225 offset:17536
    v_cvt_pk_bf16_f32 v192, v208, v209
    v_mfma_f32_16x16x32_bf16 v[164:167], a[56:59], v[120:123], v[164:167]
    ds_read_b64_tr_b16 a[116:117], v225 offset:17056
    v_exp_f32 v210, v178
    v_mfma_f32_16x16x32_bf16 v[160:163], a[44:47], v[124:127], v[160:163]
    ds_read_b64_tr_b16 a[118:119], v225 offset:17568
    v_exp_f32 v211, v179
    v_mfma_f32_16x16x32_bf16 v[164:167], a[60:63], v[124:127], v[164:167]
    v_add_f32 v217, v210, v211
    v_cvt_pk_bf16_f32 v193, v210, v211
    v_mfma_f32_16x16x32_bf16 v[48:51], a[64:67], v[188:191], v[48:51]
    ds_read_b64_tr_b16 a[120:121], v225 offset:17088
    v_exp_f32 v212, v180
    v_mfma_f32_16x16x32_bf16 v[52:55], a[68:71], v[188:191], v[52:55]
    v_exp_f32 v213, v181
    v_mfma_f32_16x16x32_bf16 v[56:59], a[72:75], v[188:191], v[56:59]
    ds_read_b64_tr_b16 a[122:123], v225 offset:17600
    v_add_f32 v234, v234, v217
    v_add_f32 v218, v212, v213
    v_mfma_f32_16x16x32_bf16 v[60:63], a[76:79], v[188:191], v[60:63]
    v_cvt_pk_bf16_f32 v194, v212, v213
    v_exp_f32 v214, v182
    v_mfma_f32_16x16x32_bf16 v[64:67], a[80:83], v[188:191], v[64:67]
    s_add_u32 m0, s28, 25344
    ds_read_b64_tr_b16 a[124:125], v225 offset:17120
    v_exp_f32 v215, v183
    v_mfma_f32_16x16x32_bf16 v[68:71], a[84:87], v[188:191], v[68:71]
    s_waitcnt vmcnt(3)
    buffer_load_dwordx4 v229, s[8:11], s27 offen nt lds
    v_mfma_f32_16x16x32_bf16 v[72:75], a[88:91], v[188:191], v[72:75]
    ds_read_b64_tr_b16 a[126:127], v225 offset:17632
    v_add_f32 v234, v234, v218
    v_add_f32 v219, v214, v215
    v_mfma_f32_16x16x32_bf16 v[76:79], a[92:95], v[188:191], v[76:79]
    v_cvt_pk_bf16_f32 v195, v214, v215
    v_add_f32 v234, v234, v219
    v_cmp_nge_f32 vcc, s32, v234
    v_mfma_f32_16x16x32_bf16 v[168:171], a[32:35], v[128:131], v[200:203]
    v_exp_f32 v208, v160
    v_mfma_f32_16x16x32_bf16 v[172:175], a[48:51], v[128:131], v[200:203]
    s_cbranch_vccnz L_stub_47
L_back_48:
    v_add_u32 v224, 67584, v226
    v_add_f32 v222, v222, v234
    v_mfma_f32_16x16x32_bf16 v[168:171], a[36:39], v[132:135], v[168:171]
    v_add_u32 v225, 67584, v227
    v_exp_f32 v209, v161
    v_mfma_f32_16x16x32_bf16 v[172:175], a[52:55], v[132:135], v[172:175]
    s_waitcnt lgkmcnt(0)
    s_barrier
    v_mfma_f32_16x16x32_bf16 v[168:171], a[40:43], v[136:139], v[168:171]
    ds_read_b128 a[0:3], v224 offset:0
    v_add_f32 v232, v208, v209
    v_mfma_f32_16x16x32_bf16 v[172:175], a[56:59], v[136:139], v[172:175]
    v_exp_f32 v210, v162
    v_mfma_f32_16x16x32_bf16 v[168:171], a[44:47], v[140:143], v[168:171]
    ds_read_b128 a[16:19], v224 offset:512
    v_exp_f32 v211, v163
    v_mfma_f32_16x16x32_bf16 v[172:175], a[60:63], v[140:143], v[172:175]
    v_cvt_pk_bf16_f32 v184, v208, v209
    v_add_f32 v217, v210, v211
    v_mfma_f32_16x16x32_bf16 v[80:83], a[64:67], v[192:195], v[80:83]
    s_add_u32 m0, s28, 26144
    ds_read_b128 a[4:7], v224 offset:64
    v_exp_f32 v212, v164
    v_mfma_f32_16x16x32_bf16 v[84:87], a[68:71], v[192:195], v[84:87]
    s_waitcnt vmcnt(3)
    buffer_load_dwordx4 v229, s[8:11], s27 offen offset:256 nt lds
    v_mfma_f32_16x16x32_bf16 v[88:91], a[72:75], v[192:195], v[88:91]
    ds_read_b128 a[20:23], v224 offset:576
    v_exp_f32 v213, v165
    v_mfma_f32_16x16x32_bf16 v[92:95], a[76:79], v[192:195], v[92:95]
    v_cvt_pk_bf16_f32 v185, v210, v211
    v_add_f32 v232, v232, v217
    v_add_f32 v218, v212, v213
    v_mfma_f32_16x16x32_bf16 v[96:99], a[80:83], v[192:195], v[96:99]
    ds_read_b128 a[8:11], v224 offset:128
    v_exp_f32 v214, v166
    v_mfma_f32_16x16x32_bf16 v[100:103], a[84:87], v[192:195], v[100:103]
    v_cvt_pk_bf16_f32 v186, v212, v213
    v_exp_f32 v215, v167
    v_mfma_f32_16x16x32_bf16 v[104:107], a[88:91], v[192:195], v[104:107]
    ds_read_b128 a[24:27], v224 offset:640
    v_add_f32 v232, v232, v218
    v_add_f32 v219, v214, v215
    v_mfma_f32_16x16x32_bf16 v[108:111], a[92:95], v[192:195], v[108:111]
    v_cvt_pk_bf16_f32 v187, v214, v215
    v_add_f32 v232, v232, v219
    v_cmp_nge_f32 vcc, s32, v232
    v_mfma_f32_16x16x32_bf16 v[176:179], a[32:35], v[144:147], v[204:207]
    ds_read_b128 a[12:15], v224 offset:192
    v_exp_f32 v208, v168
    v_mfma_f32_16x16x32_bf16 v[180:183], a[48:51], v[144:147], v[204:207]
    s_cbranch_vccnz L_stub_49
L_back_50:
    v_add_f32 v220, v220, v232
    v_mfma_f32_16x16x32_bf16 v[176:179], a[36:39], v[148:151], v[176:179]
    ds_read_b128 a[28:31], v224 offset:704
    v_exp_f32 v209, v169
    v_mfma_f32_16x16x32_bf16 v[180:183], a[52:55], v[148:151], v[180:183]
    s_mov_b32 s27, 114688
    v_exp_f32 v210, v170
    v_mfma_f32_16x16x32_bf16 v[176:179], a[40:43], v[152:155], v[176:179]
    s_add_u32 m0, s28, 33792
    ds_read_b64_tr_b16 a[64:65], v225 offset:0
    v_add_f32 v233, v208, v209
    v_mfma_f32_16x16x32_bf16 v[180:183], a[56:59], v[152:155], v[180:183]
    s_waitcnt vmcnt(3)
    buffer_load_dwordx4 v228, s[4:7], s27 offen nt lds
    v_mfma_f32_16x16x32_bf16 v[176:179], a[44:47], v[156:159], v[176:179]
    ds_read_b64_tr_b16 a[66:67], v225 offset:512
    v_cvt_pk_bf16_f32 v188, v208, v209
    v_mfma_f32_16x16x32_bf16 v[180:183], a[60:63], v[156:159], v[180:183]
    v_exp_f32 v211, v171
    v_mfma_f32_16x16x32_bf16 v[16:19], a[96:99], v[184:187], v[16:19]
    ds_read_b64_tr_b16 a[68:69], v225 offset:32
    v_add_f32 v217, v210, v211
    v_mfma_f32_16x16x32_bf16 v[20:23], a[100:103], v[184:187], v[20:23]
    v_cvt_pk_bf16_f32 v189, v210, v211
    v_add_f32 v233, v233, v217
    v_mfma_f32_16x16x32_bf16 v[24:27], a[104:107], v[184:187], v[24:27]
    ds_read_b64_tr_b16 a[70:71], v225 offset:544
    v_exp_f32 v212, v172
    v_mfma_f32_16x16x32_bf16 v[28:31], a[108:111], v[184:187], v[28:31]
    v_exp_f32 v213, v173
    v_mfma_f32_16x16x32_bf16 v[32:35], a[112:115], v[184:187], v[32:35]
    ds_read_b64_tr_b16 a[72:73], v225 offset:64
    v_exp_f32 v214, v174
    v_mfma_f32_16x16x32_bf16 v[36:39], a[116:119], v[184:187], v[36:39]
    v_add_f32 v218, v212, v213
    v_exp_f32 v215, v175
    v_mfma_f32_16x16x32_bf16 v[40:43], a[120:123], v[184:187], v[40:43]
    v_cvt_pk_bf16_f32 v190, v212, v213
    v_add_f32 v233, v233, v218
    v_add_f32 v219, v214, v215
    v_mfma_f32_16x16x32_bf16 v[44:47], a[124:127], v[184:187], v[44:47]
    s_waitcnt lgkmcnt(5)
    v_cvt_pk_bf16_f32 v191, v214, v215
    v_add_f32 v233, v233, v219
    v_cmp_nge_f32 vcc, s32, v233
    v_mfma_f32_16x16x32_bf16 v[160:163], a[0:3], v[112:115], v[196:199]
    s_add_u32 m0, s28, 34592
    ds_read_b64_tr_b16 a[74:75], v225 offset:576
    v_exp_f32 v208, v176
    v_mfma_f32_16x16x32_bf16 v[164:167], a[16:19], v[112:115], v[196:199]
    s_waitcnt vmcnt(3)
    s_cbranch_vccnz L_stub_51
L_back_52:
    buffer_load_dwordx4 v228, s[4:7], s27 offen offset:256 nt lds
    v_mfma_f32_16x16x32_bf16 v[160:163], a[4:7], v[116:119], v[160:163]
    ds_read_b64_tr_b16 a[76:77], v225 offset:96
    v_exp_f32 v209, v177
    v_mfma_f32_16x16x32_bf16 v[164:167], a[20:23], v[116:119], v[164:167]
    v_add_f32 v221, v221, v233
    v_add_f32 v234, v208, v209
    v_mfma_f32_16x16x32_bf16 v[160:163], a[8:11], v[120:123], v[160:163]
    ds_read_b64_tr_b16 a[78:79], v225 offset:608
    v_cvt_pk_bf16_f32 v192, v208, v209
    v_mfma_f32_16x16x32_bf16 v[164:167], a[24:27], v[120:123], v[164:167]
    v_exp_f32 v210, v178
    v_mfma_f32_16x16x32_bf16 v[160:163], a[12:15], v[124:127], v[160:163]
    ds_read_b64_tr_b16 a[80:81], v225 offset:128
    v_exp_f32 v211, v179
    v_mfma_f32_16x16x32_bf16 v[164:167], a[28:31], v[124:127], v[164:167]
    v_add_f32 v217, v210, v211
    v_cvt_pk_bf16_f32 v193, v210, v211
    v_mfma_f32_16x16x32_bf16 v[48:51], a[96:99], v[188:191], v[48:51]
    ds_read_b64_tr_b16 a[82:83], v225 offset:640
    v_exp_f32 v212, v180
    v_mfma_f32_16x16x32_bf16 v[52:55], a[100:103], v[188:191], v[52:55]
    v_exp_f32 v213, v181
    v_mfma_f32_16x16x32_bf16 v[56:59], a[104:107], v[188:191], v[56:59]
    ds_read_b64_tr_b16 a[84:85], v225 offset:160
    v_add_f32 v234, v234, v217
    v_add_f32 v218, v212, v213
    v_mfma_f32_16x16x32_bf16 v[60:63], a[108:111], v[188:191], v[60:63]
    v_cvt_pk_bf16_f32 v194, v212, v213
    v_exp_f32 v214, v182
    v_mfma_f32_16x16x32_bf16 v[64:67], a[112:115], v[188:191], v[64:67]
    s_add_u32 m0, s28, 42240
    ds_read_b64_tr_b16 a[86:87], v225 offset:672
    v_exp_f32 v215, v183
    v_mfma_f32_16x16x32_bf16 v[68:71], a[116:119], v[188:191], v[68:71]
    s_waitcnt vmcnt(3)
    buffer_load_dwordx4 v228, s[8:11], s27 offen nt lds
    v_mfma_f32_16x16x32_bf16 v[72:75], a[120:123], v[188:191], v[72:75]
    ds_read_b64_tr_b16 a[88:89], v225 offset:192
    v_add_f32 v234, v234, v218
    v_add_f32 v219, v214, v215
    v_mfma_f32_16x16x32_bf16 v[76:79], a[124:127], v[188:191], v[76:79]
    v_cvt_pk_bf16_f32 v195, v214, v215
    v_add_f32 v234, v234, v219
    v_cmp_nge_f32 vcc, s32, v234
    v_mfma_f32_16x16x32_bf16 v[168:171], a[0:3], v[128:131], v[200:203]
    ds_read_b64_tr_b16 a[90:91], v225 offset:704
    v_exp_f32 v208, v160
    v_mfma_f32_16x16x32_bf16 v[172:175], a[16:19], v[128:131], v[200:203]
    s_cbranch_vccnz L_stub_53
L_back_54:
    v_add_f32 v222, v222, v234
    v_mfma_f32_16x16x32_bf16 v[168:171], a[4:7], v[132:135], v[168:171]
    ds_read_b64_tr_b16 a[92:93], v225 offset:224
    v_exp_f32 v209, v161
    v_mfma_f32_16x16x32_bf16 v[172:175], a[20:23], v[132:135], v[172:175]
    v_add_f32 v232, v208, v209
    v_cvt_pk_bf16_f32 v184, v208, v209
    v_mfma_f32_16x16x32_bf16 v[168:171], a[8:11], v[136:139], v[168:171]
    ds_read_b64_tr_b16 a[94:95], v225 offset:736
    v_exp_f32 v210, v162
    v_mfma_f32_16x16x32_bf16 v[172:175], a[24:27], v[136:139], v[172:175]
    v_exp_f32 v211, v163
    v_mfma_f32_16x16x32_bf16 v[168:171], a[12:15], v[140:143], v[168:171]
    ds_read_b128 a[32:35], v224 offset:16896
    v_add_f32 v217, v210, v211
    v_mfma_f32_16x16x32_bf16 v[172:175], a[28:31], v[140:143], v[172:175]
    v_exp_f32 v212, v164
    v_mfma_f32_16x16x32_bf16 v[80:83], a[96:99], v[192:195], v[80:83]
    s_add_u32 m0, s28, 43040
    ds_read_b128 a[48:51], v224 offset:17408
    v_cvt_pk_bf16_f32 v185, v210, v211
    v_mfma_f32_16x16x32_bf16 v[84:87], a[100:103], v[192:195], v[84:87]
    s_waitcnt vmcnt(3)
    buffer_load_dwordx4 v228, s[8:11], s27 offen offset:256 nt lds
    v_mfma_f32_16x16x32_bf16 v[88:91], a[104:107], v[192:195], v[88:91]
    ds_read_b128 a[36:39], v224 offset:16960
    v_exp_f32 v213, v165
    v_mfma_f32_16x16x32_bf16 v[92:95], a[108:111], v[192:195], v[92:95]
    v_add_f32 v232, v232, v217
    v_add_f32 v218, v212, v213
    v_mfma_f32_16x16x32_bf16 v[96:99], a[112:115], v[192:195], v[96:99]
    ds_read_b128 a[52:55], v224 offset:17472
    v_exp_f32 v214, v166
    v_mfma_f32_16x16x32_bf16 v[100:103], a[116:119], v[192:195], v[100:103]
    v_cvt_pk_bf16_f32 v186, v212, v213
    v_exp_f32 v215, v167
    v_mfma_f32_16x16x32_bf16 v[104:107], a[120:123], v[192:195], v[104:107]
    ds_read_b128 a[40:43], v224 offset:17024
    v_add_f32 v232, v232, v218
    v_add_f32 v219, v214, v215
    v_mfma_f32_16x16x32_bf16 v[108:111], a[124:127], v[192:195], v[108:111]
    v_cvt_pk_bf16_f32 v187, v214, v215
    v_add_f32 v232, v232, v219
    v_cmp_nge_f32 vcc, s32, v232
    v_mfma_f32_16x16x32_bf16 v[176:179], a[0:3], v[144:147], v[204:207]
    ds_read_b128 a[56:59], v224 offset:17536
    v_exp_f32 v208, v168
    v_mfma_f32_16x16x32_bf16 v[180:183], a[16:19], v[144:147], v[204:207]
    s_cbranch_vccnz L_stub_55
L_back_56:
    v_exp_f32 v209, v169
    v_mfma_f32_16x16x32_bf16 v[176:179], a[4:7], v[148:151], v[176:179]
    ds_read_b128 a[44:47], v224 offset:17088
    v_add_f32 v220, v220, v232
    v_add_f32 v233, v208, v209
    v_mfma_f32_16x16x32_bf16 v[180:183], a[20:23], v[148:151], v[180:183]
    v_exp_f32 v210, v170
    v_mfma_f32_16x16x32_bf16 v[176:179], a[8:11], v[152:155], v[176:179]
    s_add_u32 m0, s28, 50688
    ds_read_b128 a[60:63], v224 offset:17600
    v_cvt_pk_bf16_f32 v188, v208, v209
    v_mfma_f32_16x16x32_bf16 v[180:183], a[24:27], v[152:155], v[180:183]
    s_waitcnt vmcnt(3)
    buffer_load_dwordx4 v229, s[4:7], s27 offen nt lds
    v_mfma_f32_16x16x32_bf16 v[176:179], a[12:15], v[156:159], v[176:179]
    ds_read_b64_tr_b16 a[96:97], v225 offset:16896
    v_exp_f32 v211, v171
    v_mfma_f32_16x16x32_bf16 v[180:183], a[28:31], v[156:159], v[180:183]
    s_waitcnt lgkmcnt(9)
    ds_read_b64_tr_b16 a[98:99], v225 offset:17408
    v_add_f32 v217, v210, v211
    v_mfma_f32_16x16x32_bf16 v[16:19], a[64:67], v[184:187], v[16:19]
    ds_read_b64_tr_b16 a[100:101], v225 offset:16928
    v_cvt_pk_bf16_f32 v189, v210, v211
    v_mfma_f32_16x16x32_bf16 v[20:23], a[68:71], v[184:187], v[20:23]
    v_exp_f32 v212, v172
    v_mfma_f32_16x16x32_bf16 v[24:27], a[72:75], v[184:187], v[24:27]
    ds_read_b64_tr_b16 a[102:103], v225 offset:17440
    v_exp_f32 v213, v173
    v_mfma_f32_16x16x32_bf16 v[28:31], a[76:79], v[184:187], v[28:31]
    ds_read_b64_tr_b16 a[104:105], v225 offset:16960
    v_add_f32 v233, v233, v217
    v_add_f32 v218, v212, v213
    v_mfma_f32_16x16x32_bf16 v[32:35], a[80:83], v[184:187], v[32:35]
    ds_read_b64_tr_b16 a[106:107], v225 offset:17472
    v_exp_f32 v214, v174
    v_mfma_f32_16x16x32_bf16 v[36:39], a[84:87], v[184:187], v[36:39]
    v_cvt_pk_bf16_f32 v190, v212, v213
    v_exp_f32 v215, v175
    v_mfma_f32_16x16x32_bf16 v[40:43], a[88:91], v[184:187], v[40:43]
    ds_read_b64_tr_b16 a[108:109], v225 offset:16992
    v_add_f32 v233, v233, v218
    v_add_f32 v219, v214, v215
    v_mfma_f32_16x16x32_bf16 v[44:47], a[92:95], v[184:187], v[44:47]
    s_waitcnt lgkmcnt(7)
    v_cvt_pk_bf16_f32 v191, v214, v215
    v_add_f32 v233, v233, v219
    v_cmp_nge_f32 vcc, s32, v233
    v_mfma_f32_16x16x32_bf16 v[160:163], a[32:35], v[112:115], v[196:199]
    s_add_u32 m0, s28, 51488
    ds_read_b64_tr_b16 a[110:111], v225 offset:17504
    v_exp_f32 v208, v176
    v_mfma_f32_16x16x32_bf16 v[164:167], a[48:51], v[112:115], v[196:199]
    s_waitcnt vmcnt(3)
    s_cbranch_vccnz L_stub_57
L_back_58:
    buffer_load_dwordx4 v229, s[4:7], s27 offen offset:256 nt lds
    v_mfma_f32_16x16x32_bf16 v[160:163], a[36:39], v[116:119], v[160:163]
    ds_read_b64_tr_b16 a[112:113], v225 offset:17024
    v_exp_f32 v209, v177
    v_mfma_f32_16x16x32_bf16 v[164:167], a[52:55], v[116:119], v[164:167]
    v_add_f32 v221, v221, v233
    v_add_f32 v234, v208, v209
    v_mfma_f32_16x16x32_bf16 v[160:163], a[40:43], v[120:123], v[160:163]
    ds_read_b64_tr_b16 a[114:115], v225 offset:17536
    v_cvt_pk_bf16_f32 v192, v208, v209
    v_mfma_f32_16x16x32_bf16 v[164:167], a[56:59], v[120:123], v[164:167]
    ds_read_b64_tr_b16 a[116:117], v225 offset:17056
    v_exp_f32 v210, v178
    v_mfma_f32_16x16x32_bf16 v[160:163], a[44:47], v[124:127], v[160:163]
    ds_read_b64_tr_b16 a[118:119], v225 offset:17568
    v_exp_f32 v211, v179
    v_mfma_f32_16x16x32_bf16 v[164:167], a[60:63], v[124:127], v[164:167]
    v_add_f32 v217, v210, v211
    v_cvt_pk_bf16_f32 v193, v210, v211
    v_mfma_f32_16x16x32_bf16 v[48:51], a[64:67], v[188:191], v[48:51]
    ds_read_b64_tr_b16 a[120:121], v225 offset:17088
    v_exp_f32 v212, v180
    v_mfma_f32_16x16x32_bf16 v[52:55], a[68:71], v[188:191], v[52:55]
    v_exp_f32 v213, v181
    v_mfma_f32_16x16x32_bf16 v[56:59], a[72:75], v[188:191], v[56:59]
    ds_read_b64_tr_b16 a[122:123], v225 offset:17600
    v_add_f32 v234, v234, v217
    v_add_f32 v218, v212, v213
    v_mfma_f32_16x16x32_bf16 v[60:63], a[76:79], v[188:191], v[60:63]
    v_cvt_pk_bf16_f32 v194, v212, v213
    v_exp_f32 v214, v182
    v_mfma_f32_16x16x32_bf16 v[64:67], a[80:83], v[188:191], v[64:67]
    s_add_u32 m0, s28, 59136
    ds_read_b64_tr_b16 a[124:125], v225 offset:17120
    v_exp_f32 v215, v183
    v_mfma_f32_16x16x32_bf16 v[68:71], a[84:87], v[188:191], v[68:71]
    s_waitcnt vmcnt(3)
    buffer_load_dwordx4 v229, s[8:11], s27 offen nt lds
    v_mfma_f32_16x16x32_bf16 v[72:75], a[88:91], v[188:191], v[72:75]
    ds_read_b64_tr_b16 a[126:127], v225 offset:17632
    v_add_f32 v234, v234, v218
    v_add_f32 v219, v214, v215
    v_mfma_f32_16x16x32_bf16 v[76:79], a[92:95], v[188:191], v[76:79]
    v_cvt_pk_bf16_f32 v195, v214, v215
    v_add_f32 v234, v234, v219
    v_cmp_nge_f32 vcc, s32, v234
    v_mfma_f32_16x16x32_bf16 v[168:171], a[32:35], v[128:131], v[200:203]
    v_exp_f32 v208, v160
    v_mfma_f32_16x16x32_bf16 v[172:175], a[48:51], v[128:131], v[200:203]
    s_cbranch_vccnz L_stub_59
L_back_60:
    v_add_u32 v224, 0, v226
    v_add_f32 v222, v222, v234
    v_mfma_f32_16x16x32_bf16 v[168:171], a[36:39], v[132:135], v[168:171]
    v_add_u32 v225, 0, v227
    v_exp_f32 v209, v161
    v_mfma_f32_16x16x32_bf16 v[172:175], a[52:55], v[132:135], v[172:175]
    s_waitcnt lgkmcnt(0)
    s_barrier
    v_mfma_f32_16x16x32_bf16 v[168:171], a[40:43], v[136:139], v[168:171]
    ds_read_b128 a[0:3], v224 offset:0
    v_add_f32 v232, v208, v209
    v_mfma_f32_16x16x32_bf16 v[172:175], a[56:59], v[136:139], v[172:175]
    v_exp_f32 v210, v162
    v_mfma_f32_16x16x32_bf16 v[168:171], a[44:47], v[140:143], v[168:171]
    ds_read_b128 a[16:19], v224 offset:512
    v_exp_f32 v211, v163
    v_mfma_f32_16x16x32_bf16 v[172:175], a[60:63], v[140:143], v[172:175]
    v_cvt_pk_bf16_f32 v184, v208, v209
    v_add_f32 v217, v210, v211
    v_mfma_f32_16x16x32_bf16 v[80:83], a[64:67], v[192:195], v[80:83]
    s_add_u32 m0, s28, 59936
    ds_read_b128 a[4:7], v224 offset:64
    v_exp_f32 v212, v164
    v_mfma_f32_16x16x32_bf16 v[84:87], a[68:71], v[192:195], v[84:87]
    s_waitcnt vmcnt(3)
    buffer_load_dwordx4 v229, s[8:11], s27 offen offset:256 nt lds
    v_mfma_f32_16x16x32_bf16 v[88:91], a[72:75], v[192:195], v[88:91]
    ds_read_b128 a[20:23], v224 offset:576
    v_exp_f32 v213, v165
    v_mfma_f32_16x16x32_bf16 v[92:95], a[76:79], v[192:195], v[92:95]
    v_cvt_pk_bf16_f32 v185, v210, v211
    v_add_f32 v232, v232, v217
    v_add_f32 v218, v212, v213
    v_mfma_f32_16x16x32_bf16 v[96:99], a[80:83], v[192:195], v[96:99]
    ds_read_b128 a[8:11], v224 offset:128
    v_exp_f32 v214, v166
    v_mfma_f32_16x16x32_bf16 v[100:103], a[84:87], v[192:195], v[100:103]
    v_cvt_pk_bf16_f32 v186, v212, v213
    v_exp_f32 v215, v167
    v_mfma_f32_16x16x32_bf16 v[104:107], a[88:91], v[192:195], v[104:107]
    ds_read_b128 a[24:27], v224 offset:640
    v_add_f32 v232, v232, v218
    v_add_f32 v219, v214, v215
    v_mfma_f32_16x16x32_bf16 v[108:111], a[92:95], v[192:195], v[108:111]
    v_cvt_pk_bf16_f32 v187, v214, v215
    v_add_f32 v232, v232, v219
    v_cmp_nge_f32 vcc, s32, v232
    v_mfma_f32_16x16x32_bf16 v[176:179], a[32:35], v[144:147], v[204:207]
    ds_read_b128 a[12:15], v224 offset:192
    v_exp_f32 v208, v168
    v_mfma_f32_16x16x32_bf16 v[180:183], a[48:51], v[144:147], v[204:207]
    s_cbranch_vccnz L_stub_61
L_back_62:
    v_add_f32 v220, v220, v232
    v_mfma_f32_16x16x32_bf16 v[176:179], a[36:39], v[148:151], v[176:179]
    ds_read_b128 a[28:31], v224 offset:704
    v_exp_f32 v209, v169
    v_mfma_f32_16x16x32_bf16 v[180:183], a[52:55], v[148:151], v[180:183]
    s_mov_b32 s27, 131072
    v_exp_f32 v210, v170
    v_mfma_f32_16x16x32_bf16 v[176:179], a[40:43], v[152:155], v[176:179]
    s_add_u32 m0, s28, 67584
    ds_read_b64_tr_b16 a[64:65], v225 offset:0
    v_add_f32 v233, v208, v209
    v_mfma_f32_16x16x32_bf16 v[180:183], a[56:59], v[152:155], v[180:183]
    s_waitcnt vmcnt(3)
    buffer_load_dwordx4 v228, s[4:7], s27 offen nt lds
    v_mfma_f32_16x16x32_bf16 v[176:179], a[44:47], v[156:159], v[176:179]
    ds_read_b64_tr_b16 a[66:67], v225 offset:512
    v_cvt_pk_bf16_f32 v188, v208, v209
    v_mfma_f32_16x16x32_bf16 v[180:183], a[60:63], v[156:159], v[180:183]
    v_exp_f32 v211, v171
    v_mfma_f32_16x16x32_bf16 v[16:19], a[96:99], v[184:187], v[16:19]
    ds_read_b64_tr_b16 a[68:69], v225 offset:32
    v_add_f32 v217, v210, v211
    v_mfma_f32_16x16x32_bf16 v[20:23], a[100:103], v[184:187], v[20:23]
    v_cvt_pk_bf16_f32 v189, v210, v211
    v_add_f32 v233, v233, v217
    v_mfma_f32_16x16x32_bf16 v[24:27], a[104:107], v[184:187], v[24:27]
    ds_read_b64_tr_b16 a[70:71], v225 offset:544
    v_exp_f32 v212, v172
    v_mfma_f32_16x16x32_bf16 v[28:31], a[108:111], v[184:187], v[28:31]
    v_exp_f32 v213, v173
    v_mfma_f32_16x16x32_bf16 v[32:35], a[112:115], v[184:187], v[32:35]
    ds_read_b64_tr_b16 a[72:73], v225 offset:64
    v_exp_f32 v214, v174
    v_mfma_f32_16x16x32_bf16 v[36:39], a[116:119], v[184:187], v[36:39]
    v_add_f32 v218, v212, v213
    v_exp_f32 v215, v175
    v_mfma_f32_16x16x32_bf16 v[40:43], a[120:123], v[184:187], v[40:43]
    v_cvt_pk_bf16_f32 v190, v212, v213
    v_add_f32 v233, v233, v218
    v_add_f32 v219, v214, v215
    v_mfma_f32_16x16x32_bf16 v[44:47], a[124:127], v[184:187], v[44:47]
    s_waitcnt lgkmcnt(5)
    v_cvt_pk_bf16_f32 v191, v214, v215
    v_add_f32 v233, v233, v219
    v_cmp_nge_f32 vcc, s32, v233
    v_mfma_f32_16x16x32_bf16 v[160:163], a[0:3], v[112:115], v[196:199]
    s_add_u32 m0, s28, 68384
    ds_read_b64_tr_b16 a[74:75], v225 offset:576
    v_exp_f32 v208, v176
    v_mfma_f32_16x16x32_bf16 v[164:167], a[16:19], v[112:115], v[196:199]
    s_waitcnt vmcnt(3)
    s_cbranch_vccnz L_stub_63
L_back_64:
    buffer_load_dwordx4 v228, s[4:7], s27 offen offset:256 nt lds
    v_mfma_f32_16x16x32_bf16 v[160:163], a[4:7], v[116:119], v[160:163]
    ds_read_b64_tr_b16 a[76:77], v225 offset:96
    v_exp_f32 v209, v177
    v_mfma_f32_16x16x32_bf16 v[164:167], a[20:23], v[116:119], v[164:167]
    v_add_f32 v221, v221, v233
    v_add_f32 v234, v208, v209
    v_mfma_f32_16x16x32_bf16 v[160:163], a[8:11], v[120:123], v[160:163]
    ds_read_b64_tr_b16 a[78:79], v225 offset:608
    v_cvt_pk_bf16_f32 v192, v208, v209
    v_mfma_f32_16x16x32_bf16 v[164:167], a[24:27], v[120:123], v[164:167]
    v_exp_f32 v210, v178
    v_mfma_f32_16x16x32_bf16 v[160:163], a[12:15], v[124:127], v[160:163]
    ds_read_b64_tr_b16 a[80:81], v225 offset:128
    v_exp_f32 v211, v179
    v_mfma_f32_16x16x32_bf16 v[164:167], a[28:31], v[124:127], v[164:167]
    v_add_f32 v217, v210, v211
    v_cvt_pk_bf16_f32 v193, v210, v211
    v_mfma_f32_16x16x32_bf16 v[48:51], a[96:99], v[188:191], v[48:51]
    ds_read_b64_tr_b16 a[82:83], v225 offset:640
    v_exp_f32 v212, v180
    v_mfma_f32_16x16x32_bf16 v[52:55], a[100:103], v[188:191], v[52:55]
    v_exp_f32 v213, v181
    v_mfma_f32_16x16x32_bf16 v[56:59], a[104:107], v[188:191], v[56:59]
    ds_read_b64_tr_b16 a[84:85], v225 offset:160
    v_add_f32 v234, v234, v217
    v_add_f32 v218, v212, v213
    v_mfma_f32_16x16x32_bf16 v[60:63], a[108:111], v[188:191], v[60:63]
    v_cvt_pk_bf16_f32 v194, v212, v213
    v_exp_f32 v214, v182
    v_mfma_f32_16x16x32_bf16 v[64:67], a[112:115], v[188:191], v[64:67]
    s_add_u32 m0, s28, 76032
    ds_read_b64_tr_b16 a[86:87], v225 offset:672
    v_exp_f32 v215, v183
    v_mfma_f32_16x16x32_bf16 v[68:71], a[116:119], v[188:191], v[68:71]
    s_waitcnt vmcnt(3)
    buffer_load_dwordx4 v228, s[8:11], s27 offen nt lds
    v_mfma_f32_16x16x32_bf16 v[72:75], a[120:123], v[188:191], v[72:75]
    ds_read_b64_tr_b16 a[88:89], v225 offset:192
    v_add_f32 v234, v234, v218
    v_add_f32 v219, v214, v215
    v_mfma_f32_16x16x32_bf16 v[76:79], a[124:127], v[188:191], v[76:79]
    v_cvt_pk_bf16_f32 v195, v214, v215
    v_add_f32 v234, v234, v219
    v_cmp_nge_f32 vcc, s32, v234
    v_mfma_f32_16x16x32_bf16 v[168:171], a[0:3], v[128:131], v[200:203]
    ds_read_b64_tr_b16 a[90:91], v225 offset:704
    v_exp_f32 v208, v160
    v_mfma_f32_16x16x32_bf16 v[172:175], a[16:19], v[128:131], v[200:203]
    s_cbranch_vccnz L_stub_65
L_back_66:
    v_add_f32 v222, v222, v234
    v_mfma_f32_16x16x32_bf16 v[168:171], a[4:7], v[132:135], v[168:171]
    ds_read_b64_tr_b16 a[92:93], v225 offset:224
    v_exp_f32 v209, v161
    v_mfma_f32_16x16x32_bf16 v[172:175], a[20:23], v[132:135], v[172:175]
    v_add_f32 v232, v208, v209
    v_cvt_pk_bf16_f32 v184, v208, v209
    v_mfma_f32_16x16x32_bf16 v[168:171], a[8:11], v[136:139], v[168:171]
    ds_read_b64_tr_b16 a[94:95], v225 offset:736
    v_exp_f32 v210, v162
    v_mfma_f32_16x16x32_bf16 v[172:175], a[24:27], v[136:139], v[172:175]
    v_exp_f32 v211, v163
    v_mfma_f32_16x16x32_bf16 v[168:171], a[12:15], v[140:143], v[168:171]
    ds_read_b128 a[32:35], v224 offset:16896
    v_add_f32 v217, v210, v211
    v_mfma_f32_16x16x32_bf16 v[172:175], a[28:31], v[140:143], v[172:175]
    v_exp_f32 v212, v164
    v_mfma_f32_16x16x32_bf16 v[80:83], a[96:99], v[192:195], v[80:83]
    s_add_u32 m0, s28, 76832
    ds_read_b128 a[48:51], v224 offset:17408
    v_cvt_pk_bf16_f32 v185, v210, v211
    v_mfma_f32_16x16x32_bf16 v[84:87], a[100:103], v[192:195], v[84:87]
    s_waitcnt vmcnt(3)
    buffer_load_dwordx4 v228, s[8:11], s27 offen offset:256 nt lds
    v_mfma_f32_16x16x32_bf16 v[88:91], a[104:107], v[192:195], v[88:91]
    ds_read_b128 a[36:39], v224 offset:16960
    v_exp_f32 v213, v165
    v_mfma_f32_16x16x32_bf16 v[92:95], a[108:111], v[192:195], v[92:95]
    v_add_f32 v232, v232, v217
    v_add_f32 v218, v212, v213
    v_mfma_f32_16x16x32_bf16 v[96:99], a[112:115], v[192:195], v[96:99]
    ds_read_b128 a[52:55], v224 offset:17472
    v_exp_f32 v214, v166
    v_mfma_f32_16x16x32_bf16 v[100:103], a[116:119], v[192:195], v[100:103]
    v_cvt_pk_bf16_f32 v186, v212, v213
    v_exp_f32 v215, v167
    v_mfma_f32_16x16x32_bf16 v[104:107], a[120:123], v[192:195], v[104:107]
    ds_read_b128 a[40:43], v224 offset:17024
    v_add_f32 v232, v232, v218
    v_add_f32 v219, v214, v215
    v_mfma_f32_16x16x32_bf16 v[108:111], a[124:127], v[192:195], v[108:111]
    v_cvt_pk_bf16_f32 v187, v214, v215
    v_add_f32 v232, v232, v219
    v_cmp_nge_f32 vcc, s32, v232
    v_mfma_f32_16x16x32_bf16 v[176:179], a[0:3], v[144:147], v[204:207]
    ds_read_b128 a[56:59], v224 offset:17536
    v_exp_f32 v208, v168
    v_mfma_f32_16x16x32_bf16 v[180:183], a[16:19], v[144:147], v[204:207]
    s_cbranch_vccnz L_stub_67
L_back_68:
    v_exp_f32 v209, v169
    v_mfma_f32_16x16x32_bf16 v[176:179], a[4:7], v[148:151], v[176:179]
    ds_read_b128 a[44:47], v224 offset:17088
    v_add_f32 v220, v220, v232
    v_add_f32 v233, v208, v209
    v_mfma_f32_16x16x32_bf16 v[180:183], a[20:23], v[148:151], v[180:183]
    v_exp_f32 v210, v170
    v_mfma_f32_16x16x32_bf16 v[176:179], a[8:11], v[152:155], v[176:179]
    s_add_u32 m0, s28, 84480
    ds_read_b128 a[60:63], v224 offset:17600
    v_cvt_pk_bf16_f32 v188, v208, v209
    v_mfma_f32_16x16x32_bf16 v[180:183], a[24:27], v[152:155], v[180:183]
    s_waitcnt vmcnt(3)
    buffer_load_dwordx4 v229, s[4:7], s27 offen nt lds
    v_mfma_f32_16x16x32_bf16 v[176:179], a[12:15], v[156:159], v[176:179]
    ds_read_b64_tr_b16 a[96:97], v225 offset:16896
    v_exp_f32 v211, v171
    v_mfma_f32_16x16x32_bf16 v[180:183], a[28:31], v[156:159], v[180:183]
    s_waitcnt lgkmcnt(9)
    ds_read_b64_tr_b16 a[98:99], v225 offset:17408
    v_add_f32 v217, v210, v211
    v_mfma_f32_16x16x32_bf16 v[16:19], a[64:67], v[184:187], v[16:19]
    ds_read_b64_tr_b16 a[100:101], v225 offset:16928
    v_cvt_pk_bf16_f32 v189, v210, v211
    v_mfma_f32_16x16x32_bf16 v[20:23], a[68:71], v[184:187], v[20:23]
    v_exp_f32 v212, v172
    v_mfma_f32_16x16x32_bf16 v[24:27], a[72:75], v[184:187], v[24:27]
    ds_read_b64_tr_b16 a[102:103], v225 offset:17440
    v_exp_f32 v213, v173
    v_mfma_f32_16x16x32_bf16 v[28:31], a[76:79], v[184:187], v[28:31]
    ds_read_b64_tr_b16 a[104:105], v225 offset:16960
    v_add_f32 v233, v233, v217
    v_add_f32 v218, v212, v213
    v_mfma_f32_16x16x32_bf16 v[32:35], a[80:83], v[184:187], v[32:35]
    ds_read_b64_tr_b16 a[106:107], v225 offset:17472
    v_exp_f32 v214, v174
    v_mfma_f32_16x16x32_bf16 v[36:39], a[84:87], v[184:187], v[36:39]
    v_cvt_pk_bf16_f32 v190, v212, v213
    v_exp_f32 v215, v175
    v_mfma_f32_16x16x32_bf16 v[40:43], a[88:91], v[184:187], v[40:43]
    ds_read_b64_tr_b16 a[108:109], v225 offset:16992
    v_add_f32 v233, v233, v218
    v_add_f32 v219, v214, v215
    v_mfma_f32_16x16x32_bf16 v[44:47], a[92:95], v[184:187], v[44:47]
    s_waitcnt lgkmcnt(7)
    v_cvt_pk_bf16_f32 v191, v214, v215
    v_add_f32 v233, v233, v219
    v_cmp_nge_f32 vcc, s32, v233
    v_mfma_f32_16x16x32_bf16 v[160:163], a[32:35], v[112:115], v[196:199]
    s_add_u32 m0, s28, 85280
    ds_read_b64_tr_b16 a[110:111], v225 offset:17504
    v_exp_f32 v208, v176
    v_mfma_f32_16x16x32_bf16 v[164:167], a[48:51], v[112:115], v[196:199]
    s_waitcnt vmcnt(3)
    s_cbranch_vccnz L_stub_69
L_back_70:
    buffer_load_dwordx4 v229, s[4:7], s27 offen offset:256 nt lds
    v_mfma_f32_16x16x32_bf16 v[160:163], a[36:39], v[116:119], v[160:163]
    ds_read_b64_tr_b16 a[112:113], v225 offset:17024
    v_exp_f32 v209, v177
    v_mfma_f32_16x16x32_bf16 v[164:167], a[52:55], v[116:119], v[164:167]
    v_add_f32 v221, v221, v233
    v_add_f32 v234, v208, v209
    v_mfma_f32_16x16x32_bf16 v[160:163], a[40:43], v[120:123], v[160:163]
    ds_read_b64_tr_b16 a[114:115], v225 offset:17536
    v_cvt_pk_bf16_f32 v192, v208, v209
    v_mfma_f32_16x16x32_bf16 v[164:167], a[56:59], v[120:123], v[164:167]
    ds_read_b64_tr_b16 a[116:117], v225 offset:17056
    v_exp_f32 v210, v178
    v_mfma_f32_16x16x32_bf16 v[160:163], a[44:47], v[124:127], v[160:163]
    ds_read_b64_tr_b16 a[118:119], v225 offset:17568
    v_exp_f32 v211, v179
    v_mfma_f32_16x16x32_bf16 v[164:167], a[60:63], v[124:127], v[164:167]
    v_add_f32 v217, v210, v211
    v_cvt_pk_bf16_f32 v193, v210, v211
    v_mfma_f32_16x16x32_bf16 v[48:51], a[64:67], v[188:191], v[48:51]
    ds_read_b64_tr_b16 a[120:121], v225 offset:17088
    v_exp_f32 v212, v180
    v_mfma_f32_16x16x32_bf16 v[52:55], a[68:71], v[188:191], v[52:55]
    v_exp_f32 v213, v181
    v_mfma_f32_16x16x32_bf16 v[56:59], a[72:75], v[188:191], v[56:59]
    ds_read_b64_tr_b16 a[122:123], v225 offset:17600
    v_add_f32 v234, v234, v217
    v_add_f32 v218, v212, v213
    v_mfma_f32_16x16x32_bf16 v[60:63], a[76:79], v[188:191], v[60:63]
    v_cvt_pk_bf16_f32 v194, v212, v213
    v_exp_f32 v214, v182
    v_mfma_f32_16x16x32_bf16 v[64:67], a[80:83], v[188:191], v[64:67]
    s_add_u32 m0, s28, 92928
    ds_read_b64_tr_b16 a[124:125], v225 offset:17120
    v_exp_f32 v215, v183
    v_mfma_f32_16x16x32_bf16 v[68:71], a[84:87], v[188:191], v[68:71]
    s_waitcnt vmcnt(3)
    buffer_load_dwordx4 v229, s[8:11], s27 offen nt lds
    v_mfma_f32_16x16x32_bf16 v[72:75], a[88:91], v[188:191], v[72:75]
    ds_read_b64_tr_b16 a[126:127], v225 offset:17632
    v_add_f32 v234, v234, v218
    v_add_f32 v219, v214, v215
    v_mfma_f32_16x16x32_bf16 v[76:79], a[92:95], v[188:191], v[76:79]
    v_cvt_pk_bf16_f32 v195, v214, v215
    v_add_f32 v234, v234, v219
    v_cmp_nge_f32 vcc, s32, v234
    v_mfma_f32_16x16x32_bf16 v[168:171], a[32:35], v[128:131], v[200:203]
    v_exp_f32 v208, v160
    v_mfma_f32_16x16x32_bf16 v[172:175], a[48:51], v[128:131], v[200:203]
    s_cbranch_vccnz L_stub_71
L_back_72:
    v_add_u32 v224, 33792, v226
    v_add_f32 v222, v222, v234
    v_mfma_f32_16x16x32_bf16 v[168:171], a[36:39], v[132:135], v[168:171]
    v_add_u32 v225, 33792, v227
    v_exp_f32 v209, v161
    v_mfma_f32_16x16x32_bf16 v[172:175], a[52:55], v[132:135], v[172:175]
    s_waitcnt lgkmcnt(0)
    s_barrier
    v_mfma_f32_16x16x32_bf16 v[168:171], a[40:43], v[136:139], v[168:171]
    ds_read_b128 a[0:3], v224 offset:0
    v_add_f32 v232, v208, v209
    v_mfma_f32_16x16x32_bf16 v[172:175], a[56:59], v[136:139], v[172:175]
    v_exp_f32 v210, v162
    v_mfma_f32_16x16x32_bf16 v[168:171], a[44:47], v[140:143], v[168:171]
    ds_read_b128 a[16:19], v224 offset:512
    v_exp_f32 v211, v163
    v_mfma_f32_16x16x32_bf16 v[172:175], a[60:63], v[140:143], v[172:175]
    v_cvt_pk_bf16_f32 v184, v208, v209
    v_add_f32 v217, v210, v211
    v_mfma_f32_16x16x32_bf16 v[80:83], a[64:67], v[192:195], v[80:83]
    s_add_u32 m0, s28, 93728
    ds_read_b128 a[4:7], v224 offset:64
    v_exp_f32 v212, v164
    v_mfma_f32_16x16x32_bf16 v[84:87], a[68:71], v[192:195], v[84:87]
    s_waitcnt vmcnt(3)
    buffer_load_dwordx4 v229, s[8:11], s27 offen offset:256 nt lds
    v_mfma_f32_16x16x32_bf16 v[88:91], a[72:75], v[192:195], v[88:91]
    ds_read_b128 a[20:23], v224 offset:576
    v_exp_f32 v213, v165
    v_mfma_f32_16x16x32_bf16 v[92:95], a[76:79], v[192:195], v[92:95]
    v_cvt_pk_bf16_f32 v185, v210, v211
    v_add_f32 v232, v232, v217
    v_add_f32 v218, v212, v213
    v_mfma_f32_16x16x32_bf16 v[96:99], a[80:83], v[192:195], v[96:99]
    ds_read_b128 a[8:11], v224 offset:128
    v_exp_f32 v214, v166
    v_mfma_f32_16x16x32_bf16 v[100:103], a[84:87], v[192:195], v[100:103]
    v_cvt_pk_bf16_f32 v186, v212, v213
    v_exp_f32 v215, v167
    v_mfma_f32_16x16x32_bf16 v[104:107], a[88:91], v[192:195], v[104:107]
    ds_read_b128 a[24:27], v224 offset:640
    v_add_f32 v232, v232, v218
    v_add_f32 v219, v214, v215
    v_mfma_f32_16x16x32_bf16 v[108:111], a[92:95], v[192:195], v[108:111]
    v_cvt_pk_bf16_f32 v187, v214, v215
    v_add_f32 v232, v232, v219
    v_cmp_nge_f32 vcc, s32, v232
    v_mfma_f32_16x16x32_bf16 v[176:179], a[32:35], v[144:147], v[204:207]
    ds_read_b128 a[12:15], v224 offset:192
    v_exp_f32 v208, v168
    v_mfma_f32_16x16x32_bf16 v[180:183], a[48:51], v[144:147], v[204:207]
    s_cbranch_vccnz L_stub_73
L_back_74:
    v_add_f32 v220, v220, v232
    v_mfma_f32_16x16x32_bf16 v[176:179], a[36:39], v[148:151], v[176:179]
    ds_read_b128 a[28:31], v224 offset:704
    v_exp_f32 v209, v169
    v_mfma_f32_16x16x32_bf16 v[180:183], a[52:55], v[148:151], v[180:183]
    s_mov_b32 s27, 147456
    v_exp_f32 v210, v170
    v_mfma_f32_16x16x32_bf16 v[176:179], a[40:43], v[152:155], v[176:179]
    s_add_u32 m0, s28, 0
    ds_read_b64_tr_b16 a[64:65], v225 offset:0
    v_add_f32 v233, v208, v209
    v_mfma_f32_16x16x32_bf16 v[180:183], a[56:59], v[152:155], v[180:183]
    s_waitcnt vmcnt(3)
    buffer_load_dwordx4 v228, s[4:7], s27 offen nt lds
    v_mfma_f32_16x16x32_bf16 v[176:179], a[44:47], v[156:159], v[176:179]
    ds_read_b64_tr_b16 a[66:67], v225 offset:512
    v_cvt_pk_bf16_f32 v188, v208, v209
    v_mfma_f32_16x16x32_bf16 v[180:183], a[60:63], v[156:159], v[180:183]
    v_exp_f32 v211, v171
    v_mfma_f32_16x16x32_bf16 v[16:19], a[96:99], v[184:187], v[16:19]
    ds_read_b64_tr_b16 a[68:69], v225 offset:32
    v_add_f32 v217, v210, v211
    v_mfma_f32_16x16x32_bf16 v[20:23], a[100:103], v[184:187], v[20:23]
    v_cvt_pk_bf16_f32 v189, v210, v211
    v_add_f32 v233, v233, v217
    v_mfma_f32_16x16x32_bf16 v[24:27], a[104:107], v[184:187], v[24:27]
    ds_read_b64_tr_b16 a[70:71], v225 offset:544
    v_exp_f32 v212, v172
    v_mfma_f32_16x16x32_bf16 v[28:31], a[108:111], v[184:187], v[28:31]
    v_exp_f32 v213, v173
    v_mfma_f32_16x16x32_bf16 v[32:35], a[112:115], v[184:187], v[32:35]
    ds_read_b64_tr_b16 a[72:73], v225 offset:64
    v_exp_f32 v214, v174
    v_mfma_f32_16x16x32_bf16 v[36:39], a[116:119], v[184:187], v[36:39]
    v_add_f32 v218, v212, v213
    v_exp_f32 v215, v175
    v_mfma_f32_16x16x32_bf16 v[40:43], a[120:123], v[184:187], v[40:43]
    v_cvt_pk_bf16_f32 v190, v212, v213
    v_add_f32 v233, v233, v218
    v_add_f32 v219, v214, v215
    v_mfma_f32_16x16x32_bf16 v[44:47], a[124:127], v[184:187], v[44:47]
    s_waitcnt lgkmcnt(5)
    v_cvt_pk_bf16_f32 v191, v214, v215
    v_add_f32 v233, v233, v219
    v_cmp_nge_f32 vcc, s32, v233
    v_mfma_f32_16x16x32_bf16 v[160:163], a[0:3], v[112:115], v[196:199]
    s_add_u32 m0, s28, 800
    ds_read_b64_tr_b16 a[74:75], v225 offset:576
    v_exp_f32 v208, v176
    v_mfma_f32_16x16x32_bf16 v[164:167], a[16:19], v[112:115], v[196:199]
    s_waitcnt vmcnt(3)
    s_cbranch_vccnz L_stub_75
L_back_76:
    buffer_load_dwordx4 v228, s[4:7], s27 offen offset:256 nt lds
    v_mfma_f32_16x16x32_bf16 v[160:163], a[4:7], v[116:119], v[160:163]
    ds_read_b64_tr_b16 a[76:77], v225 offset:96
    v_exp_f32 v209, v177
    v_mfma_f32_16x16x32_bf16 v[164:167], a[20:23], v[116:119], v[164:167]
    v_add_f32 v221, v221, v233
    v_add_f32 v234, v208, v209
    v_mfma_f32_16x16x32_bf16 v[160:163], a[8:11], v[120:123], v[160:163]
    ds_read_b64_tr_b16 a[78:79], v225 offset:608
    v_cvt_pk_bf16_f32 v192, v208, v209
    v_mfma_f32_16x16x32_bf16 v[164:167], a[24:27], v[120:123], v[164:167]
    v_exp_f32 v210, v178
    v_mfma_f32_16x16x32_bf16 v[160:163], a[12:15], v[124:127], v[160:163]
    ds_read_b64_tr_b16 a[80:81], v225 offset:128
    v_exp_f32 v211, v179
    v_mfma_f32_16x16x32_bf16 v[164:167], a[28:31], v[124:127], v[164:167]
    v_add_f32 v217, v210, v211
    v_cvt_pk_bf16_f32 v193, v210, v211
    v_mfma_f32_16x16x32_bf16 v[48:51], a[96:99], v[188:191], v[48:51]
    ds_read_b64_tr_b16 a[82:83], v225 offset:640
    v_exp_f32 v212, v180
    v_mfma_f32_16x16x32_bf16 v[52:55], a[100:103], v[188:191], v[52:55]
    v_exp_f32 v213, v181
    v_mfma_f32_16x16x32_bf16 v[56:59], a[104:107], v[188:191], v[56:59]
    ds_read_b64_tr_b16 a[84:85], v225 offset:160
    v_add_f32 v234, v234, v217
    v_add_f32 v218, v212, v213
    v_mfma_f32_16x16x32_bf16 v[60:63], a[108:111], v[188:191], v[60:63]
    v_cvt_pk_bf16_f32 v194, v212, v213
    v_exp_f32 v214, v182
    v_mfma_f32_16x16x32_bf16 v[64:67], a[112:115], v[188:191], v[64:67]
    s_add_u32 m0, s28, 8448
    ds_read_b64_tr_b16 a[86:87], v225 offset:672
    v_exp_f32 v215, v183
    v_mfma_f32_16x16x32_bf16 v[68:71], a[116:119], v[188:191], v[68:71]
    s_waitcnt vmcnt(3)
    buffer_load_dwordx4 v228, s[8:11], s27 offen nt lds
    v_mfma_f32_16x16x32_bf16 v[72:75], a[120:123], v[188:191], v[72:75]
    ds_read_b64_tr_b16 a[88:89], v225 offset:192
    v_add_f32 v234, v234, v218
    v_add_f32 v219, v214, v215
    v_mfma_f32_16x16x32_bf16 v[76:79], a[124:127], v[188:191], v[76:79]
    v_cvt_pk_bf16_f32 v195, v214, v215
    v_add_f32 v234, v234, v219
    v_cmp_nge_f32 vcc, s32, v234
    v_mfma_f32_16x16x32_bf16 v[168:171], a[0:3], v[128:131], v[200:203]
    ds_read_b64_tr_b16 a[90:91], v225 offset:704
    v_exp_f32 v208, v160
    v_mfma_f32_16x16x32_bf16 v[172:175], a[16:19], v[128:131], v[200:203]
    s_cbranch_vccnz L_stub_77
L_back_78:
    v_add_f32 v222, v222, v234
    v_mfma_f32_16x16x32_bf16 v[168:171], a[4:7], v[132:135], v[168:171]
    ds_read_b64_tr_b16 a[92:93], v225 offset:224
    v_exp_f32 v209, v161
    v_mfma_f32_16x16x32_bf16 v[172:175], a[20:23], v[132:135], v[172:175]
    v_add_f32 v232, v208, v209
    v_cvt_pk_bf16_f32 v184, v208, v209
    v_mfma_f32_16x16x32_bf16 v[168:171], a[8:11], v[136:139], v[168:171]
    ds_read_b64_tr_b16 a[94:95], v225 offset:736
    v_exp_f32 v210, v162
    v_mfma_f32_16x16x32_bf16 v[172:175], a[24:27], v[136:139], v[172:175]
    v_exp_f32 v211, v163
    v_mfma_f32_16x16x32_bf16 v[168:171], a[12:15], v[140:143], v[168:171]
    ds_read_b128 a[32:35], v224 offset:16896
    v_add_f32 v217, v210, v211
    v_mfma_f32_16x16x32_bf16 v[172:175], a[28:31], v[140:143], v[172:175]
    v_exp_f32 v212, v164
    v_mfma_f32_16x16x32_bf16 v[80:83], a[96:99], v[192:195], v[80:83]
    s_add_u32 m0, s28, 9248
    ds_read_b128 a[48:51], v224 offset:17408
    v_cvt_pk_bf16_f32 v185, v210, v211
    v_mfma_f32_16x16x32_bf16 v[84:87], a[100:103], v[192:195], v[84:87]
    s_waitcnt vmcnt(3)
    buffer_load_dwordx4 v228, s[8:11], s27 offen offset:256 nt lds
    v_mfma_f32_16x16x32_bf16 v[88:91], a[104:107], v[192:195], v[88:91]
    ds_read_b128 a[36:39], v224 offset:16960
    v_exp_f32 v213, v165
    v_mfma_f32_16x16x32_bf16 v[92:95], a[108:111], v[192:195], v[92:95]
    v_add_f32 v232, v232, v217
    v_add_f32 v218, v212, v213
    v_mfma_f32_16x16x32_bf16 v[96:99], a[112:115], v[192:195], v[96:99]
    ds_read_b128 a[52:55], v224 offset:17472
    v_exp_f32 v214, v166
    v_mfma_f32_16x16x32_bf16 v[100:103], a[116:119], v[192:195], v[100:103]
    v_cvt_pk_bf16_f32 v186, v212, v213
    v_exp_f32 v215, v167
    v_mfma_f32_16x16x32_bf16 v[104:107], a[120:123], v[192:195], v[104:107]
    ds_read_b128 a[40:43], v224 offset:17024
    v_add_f32 v232, v232, v218
    v_add_f32 v219, v214, v215
    v_mfma_f32_16x16x32_bf16 v[108:111], a[124:127], v[192:195], v[108:111]
    v_cvt_pk_bf16_f32 v187, v214, v215
    v_add_f32 v232, v232, v219
    v_cmp_nge_f32 vcc, s32, v232
    v_mfma_f32_16x16x32_bf16 v[176:179], a[0:3], v[144:147], v[204:207]
    ds_read_b128 a[56:59], v224 offset:17536
    v_exp_f32 v208, v168
    v_mfma_f32_16x16x32_bf16 v[180:183], a[16:19], v[144:147], v[204:207]
    s_cbranch_vccnz L_stub_79
L_back_80:
    v_exp_f32 v209, v169
    v_mfma_f32_16x16x32_bf16 v[176:179], a[4:7], v[148:151], v[176:179]
    ds_read_b128 a[44:47], v224 offset:17088
    v_add_f32 v220, v220, v232
    v_add_f32 v233, v208, v209
    v_mfma_f32_16x16x32_bf16 v[180:183], a[20:23], v[148:151], v[180:183]
    v_exp_f32 v210, v170
    v_mfma_f32_16x16x32_bf16 v[176:179], a[8:11], v[152:155], v[176:179]
    s_add_u32 m0, s28, 16896
    ds_read_b128 a[60:63], v224 offset:17600
    v_cvt_pk_bf16_f32 v188, v208, v209
    v_mfma_f32_16x16x32_bf16 v[180:183], a[24:27], v[152:155], v[180:183]
    s_waitcnt vmcnt(3)
    buffer_load_dwordx4 v229, s[4:7], s27 offen nt lds
    v_mfma_f32_16x16x32_bf16 v[176:179], a[12:15], v[156:159], v[176:179]
    ds_read_b64_tr_b16 a[96:97], v225 offset:16896
    v_exp_f32 v211, v171
    v_mfma_f32_16x16x32_bf16 v[180:183], a[28:31], v[156:159], v[180:183]
    s_waitcnt lgkmcnt(9)
    ds_read_b64_tr_b16 a[98:99], v225 offset:17408
    v_add_f32 v217, v210, v211
    v_mfma_f32_16x16x32_bf16 v[16:19], a[64:67], v[184:187], v[16:19]
    ds_read_b64_tr_b16 a[100:101], v225 offset:16928
    v_cvt_pk_bf16_f32 v189, v210, v211
    v_mfma_f32_16x16x32_bf16 v[20:23], a[68:71], v[184:187], v[20:23]
    v_exp_f32 v212, v172
    v_mfma_f32_16x16x32_bf16 v[24:27], a[72:75], v[184:187], v[24:27]
    ds_read_b64_tr_b16 a[102:103], v225 offset:17440
    v_exp_f32 v213, v173
    v_mfma_f32_16x16x32_bf16 v[28:31], a[76:79], v[184:187], v[28:31]
    ds_read_b64_tr_b16 a[104:105], v225 offset:16960
    v_add_f32 v233, v233, v217
    v_add_f32 v218, v212, v213
    v_mfma_f32_16x16x32_bf16 v[32:35], a[80:83], v[184:187], v[32:35]
    ds_read_b64_tr_b16 a[106:107], v225 offset:17472
    v_exp_f32 v214, v174
    v_mfma_f32_16x16x32_bf16 v[36:39], a[84:87], v[184:187], v[36:39]
    v_cvt_pk_bf16_f32 v190, v212, v213
    v_exp_f32 v215, v175
    v_mfma_f32_16x16x32_bf16 v[40:43], a[88:91], v[184:187], v[40:43]
    ds_read_b64_tr_b16 a[108:109], v225 offset:16992
    v_add_f32 v233, v233, v218
    v_add_f32 v219, v214, v215
    v_mfma_f32_16x16x32_bf16 v[44:47], a[92:95], v[184:187], v[44:47]
    s_waitcnt lgkmcnt(7)
    v_cvt_pk_bf16_f32 v191, v214, v215
    v_add_f32 v233, v233, v219
    v_cmp_nge_f32 vcc, s32, v233
    v_mfma_f32_16x16x32_bf16 v[160:163], a[32:35], v[112:115], v[196:199]
    s_add_u32 m0, s28, 17696
    ds_read_b64_tr_b16 a[110:111], v225 offset:17504
    v_exp_f32 v208, v176
    v_mfma_f32_16x16x32_bf16 v[164:167], a[48:51], v[112:115], v[196:199]
    s_waitcnt vmcnt(3)
    s_cbranch_vccnz L_stub_81
L_back_82:
    buffer_load_dwordx4 v229, s[4:7], s27 offen offset:256 nt lds
    v_mfma_f32_16x16x32_bf16 v[160:163], a[36:39], v[116:119], v[160:163]
    ds_read_b64_tr_b16 a[112:113], v225 offset:17024
    v_exp_f32 v209, v177
    v_mfma_f32_16x16x32_bf16 v[164:167], a[52:55], v[116:119], v[164:167]
    v_add_f32 v221, v221, v233
    v_add_f32 v234, v208, v209
    v_mfma_f32_16x16x32_bf16 v[160:163], a[40:43], v[120:123], v[160:163]
    ds_read_b64_tr_b16 a[114:115], v225 offset:17536
    v_cvt_pk_bf16_f32 v192, v208, v209
    v_mfma_f32_16x16x32_bf16 v[164:167], a[56:59], v[120:123], v[164:167]
    ds_read_b64_tr_b16 a[116:117], v225 offset:17056
    v_exp_f32 v210, v178
    v_mfma_f32_16x16x32_bf16 v[160:163], a[44:47], v[124:127], v[160:163]
    ds_read_b64_tr_b16 a[118:119], v225 offset:17568
    v_exp_f32 v211, v179
    v_mfma_f32_16x16x32_bf16 v[164:167], a[60:63], v[124:127], v[164:167]
    v_add_f32 v217, v210, v211
    v_cvt_pk_bf16_f32 v193, v210, v211
    v_mfma_f32_16x16x32_bf16 v[48:51], a[64:67], v[188:191], v[48:51]
    ds_read_b64_tr_b16 a[120:121], v225 offset:17088
    v_exp_f32 v212, v180
    v_mfma_f32_16x16x32_bf16 v[52:55], a[68:71], v[188:191], v[52:55]
    v_exp_f32 v213, v181
    v_mfma_f32_16x16x32_bf16 v[56:59], a[72:75], v[188:191], v[56:59]
    ds_read_b64_tr_b16 a[122:123], v225 offset:17600
    v_add_f32 v234, v234, v217
    v_add_f32 v218, v212, v213
    v_mfma_f32_16x16x32_bf16 v[60:63], a[76:79], v[188:191], v[60:63]
    v_cvt_pk_bf16_f32 v194, v212, v213
    v_exp_f32 v214, v182
    v_mfma_f32_16x16x32_bf16 v[64:67], a[80:83], v[188:191], v[64:67]
    s_add_u32 m0, s28, 25344
    ds_read_b64_tr_b16 a[124:125], v225 offset:17120
    v_exp_f32 v215, v183
    v_mfma_f32_16x16x32_bf16 v[68:71], a[84:87], v[188:191], v[68:71]
    s_waitcnt vmcnt(3)
    buffer_load_dwordx4 v229, s[8:11], s27 offen nt lds
    v_mfma_f32_16x16x32_bf16 v[72:75], a[88:91], v[188:191], v[72:75]
    ds_read_b64_tr_b16 a[126:127], v225 offset:17632
    v_add_f32 v234, v234, v218
    v_add_f32 v219, v214, v215
    v_mfma_f32_16x16x32_bf16 v[76:79], a[92:95], v[188:191], v[76:79]
    v_cvt_pk_bf16_f32 v195, v214, v215
    v_add_f32 v234, v234, v219
    v_cmp_nge_f32 vcc, s32, v234
    v_mfma_f32_16x16x32_bf16 v[168:171], a[32:35], v[128:131], v[200:203]
    v_exp_f32 v208, v160
    v_mfma_f32_16x16x32_bf16 v[172:175], a[48:51], v[128:131], v[200:203]
    s_cbranch_vccnz L_stub_83
L_back_84:
    v_add_u32 v224, 67584, v226
    v_add_f32 v222, v222, v234
    v_mfma_f32_16x16x32_bf16 v[168:171], a[36:39], v[132:135], v[168:171]
    v_add_u32 v225, 67584, v227
    v_exp_f32 v209, v161
    v_mfma_f32_16x16x32_bf16 v[172:175], a[52:55], v[132:135], v[172:175]
    s_waitcnt lgkmcnt(0)
    s_barrier
    v_mfma_f32_16x16x32_bf16 v[168:171], a[40:43], v[136:139], v[168:171]
    ds_read_b128 a[0:3], v224 offset:0
    v_add_f32 v232, v208, v209
    v_mfma_f32_16x16x32_bf16 v[172:175], a[56:59], v[136:139], v[172:175]
    v_exp_f32 v210, v162
    v_mfma_f32_16x16x32_bf16 v[168:171], a[44:47], v[140:143], v[168:171]
    ds_read_b128 a[16:19], v224 offset:512
    v_exp_f32 v211, v163
    v_mfma_f32_16x16x32_bf16 v[172:175], a[60:63], v[140:143], v[172:175]
    v_cvt_pk_bf16_f32 v184, v208, v209
    v_add_f32 v217, v210, v211
    v_mfma_f32_16x16x32_bf16 v[80:83], a[64:67], v[192:195], v[80:83]
    s_add_u32 m0, s28, 26144
    ds_read_b128 a[4:7], v224 offset:64
    v_exp_f32 v212, v164
    v_mfma_f32_16x16x32_bf16 v[84:87], a[68:71], v[192:195], v[84:87]
    s_waitcnt vmcnt(3)
    buffer_load_dwordx4 v229, s[8:11], s27 offen offset:256 nt lds
    v_mfma_f32_16x16x32_bf16 v[88:91], a[72:75], v[192:195], v[88:91]
    ds_read_b128 a[20:23], v224 offset:576
    v_exp_f32 v213, v165
    v_mfma_f32_16x16x32_bf16 v[92:95], a[76:79], v[192:195], v[92:95]
    v_cvt_pk_bf16_f32 v185, v210, v211
    v_add_f32 v232, v232, v217
    v_add_f32 v218, v212, v213
    v_mfma_f32_16x16x32_bf16 v[96:99], a[80:83], v[192:195], v[96:99]
    ds_read_b128 a[8:11], v224 offset:128
    v_exp_f32 v214, v166
    v_mfma_f32_16x16x32_bf16 v[100:103], a[84:87], v[192:195], v[100:103]
    v_cvt_pk_bf16_f32 v186, v212, v213
    v_exp_f32 v215, v167
    v_mfma_f32_16x16x32_bf16 v[104:107], a[88:91], v[192:195], v[104:107]
    ds_read_b128 a[24:27], v224 offset:640
    v_add_f32 v232, v232, v218
    v_add_f32 v219, v214, v215
    v_mfma_f32_16x16x32_bf16 v[108:111], a[92:95], v[192:195], v[108:111]
    v_cvt_pk_bf16_f32 v187, v214, v215
    v_add_f32 v232, v232, v219
    v_cmp_nge_f32 vcc, s32, v232
    v_mfma_f32_16x16x32_bf16 v[176:179], a[32:35], v[144:147], v[204:207]
    ds_read_b128 a[12:15], v224 offset:192
    v_exp_f32 v208, v168
    v_mfma_f32_16x16x32_bf16 v[180:183], a[48:51], v[144:147], v[204:207]
    s_cbranch_vccnz L_stub_85
L_back_86:
    v_add_f32 v220, v220, v232
    v_mfma_f32_16x16x32_bf16 v[176:179], a[36:39], v[148:151], v[176:179]
    ds_read_b128 a[28:31], v224 offset:704
    v_exp_f32 v209, v169
    v_mfma_f32_16x16x32_bf16 v[180:183], a[52:55], v[148:151], v[180:183]
    s_mov_b32 s27, 163840
    v_exp_f32 v210, v170
    v_mfma_f32_16x16x32_bf16 v[176:179], a[40:43], v[152:155], v[176:179]
    s_add_u32 m0, s28, 33792
    ds_read_b64_tr_b16 a[64:65], v225 offset:0
    v_add_f32 v233, v208, v209
    v_mfma_f32_16x16x32_bf16 v[180:183], a[56:59], v[152:155], v[180:183]
    s_waitcnt vmcnt(3)
    buffer_load_dwordx4 v228, s[4:7], s27 offen nt lds
    v_mfma_f32_16x16x32_bf16 v[176:179], a[44:47], v[156:159], v[176:179]
    ds_read_b64_tr_b16 a[66:67], v225 offset:512
    v_cvt_pk_bf16_f32 v188, v208, v209
    v_mfma_f32_16x16x32_bf16 v[180:183], a[60:63], v[156:159], v[180:183]
    v_exp_f32 v211, v171
    v_mfma_f32_16x16x32_bf16 v[16:19], a[96:99], v[184:187], v[16:19]
    ds_read_b64_tr_b16 a[68:69], v225 offset:32
    v_add_f32 v217, v210, v211
    v_mfma_f32_16x16x32_bf16 v[20:23], a[100:103], v[184:187], v[20:23]
    v_cvt_pk_bf16_f32 v189, v210, v211
    v_add_f32 v233, v233, v217
    v_mfma_f32_16x16x32_bf16 v[24:27], a[104:107], v[184:187], v[24:27]
    ds_read_b64_tr_b16 a[70:71], v225 offset:544
    v_exp_f32 v212, v172
    v_mfma_f32_16x16x32_bf16 v[28:31], a[108:111], v[184:187], v[28:31]
    v_exp_f32 v213, v173
    v_mfma_f32_16x16x32_bf16 v[32:35], a[112:115], v[184:187], v[32:35]
    ds_read_b64_tr_b16 a[72:73], v225 offset:64
    v_exp_f32 v214, v174
    v_mfma_f32_16x16x32_bf16 v[36:39], a[116:119], v[184:187], v[36:39]
    v_add_f32 v218, v212, v213
    v_exp_f32 v215, v175
    v_mfma_f32_16x16x32_bf16 v[40:43], a[120:123], v[184:187], v[40:43]
    v_cvt_pk_bf16_f32 v190, v212, v213
    v_add_f32 v233, v233, v218
    v_add_f32 v219, v214, v215
    v_mfma_f32_16x16x32_bf16 v[44:47], a[124:127], v[184:187], v[44:47]
    s_waitcnt lgkmcnt(5)
    v_cvt_pk_bf16_f32 v191, v214, v215
    v_add_f32 v233, v233, v219
    v_cmp_nge_f32 vcc, s32, v233
    v_mfma_f32_16x16x32_bf16 v[160:163], a[0:3], v[112:115], v[196:199]
    s_add_u32 m0, s28, 34592
    ds_read_b64_tr_b16 a[74:75], v225 offset:576
    v_exp_f32 v208, v176
    v_mfma_f32_16x16x32_bf16 v[164:167], a[16:19], v[112:115], v[196:199]
    s_waitcnt vmcnt(3)
    s_cbranch_vccnz L_stub_87
L_back_88:
    buffer_load_dwordx4 v228, s[4:7], s27 offen offset:256 nt lds
    v_mfma_f32_16x16x32_bf16 v[160:163], a[4:7], v[116:119], v[160:163]
    ds_read_b64_tr_b16 a[76:77], v225 offset:96
    v_exp_f32 v209, v177
    v_mfma_f32_16x16x32_bf16 v[164:167], a[20:23], v[116:119], v[164:167]
    v_add_f32 v221, v221, v233
    v_add_f32 v234, v208, v209
    v_mfma_f32_16x16x32_bf16 v[160:163], a[8:11], v[120:123], v[160:163]
    ds_read_b64_tr_b16 a[78:79], v225 offset:608
    v_cvt_pk_bf16_f32 v192, v208, v209
    v_mfma_f32_16x16x32_bf16 v[164:167], a[24:27], v[120:123], v[164:167]
    v_exp_f32 v210, v178
    v_mfma_f32_16x16x32_bf16 v[160:163], a[12:15], v[124:127], v[160:163]
    ds_read_b64_tr_b16 a[80:81], v225 offset:128
    v_exp_f32 v211, v179
    v_mfma_f32_16x16x32_bf16 v[164:167], a[28:31], v[124:127], v[164:167]
    v_add_f32 v217, v210, v211
    v_cvt_pk_bf16_f32 v193, v210, v211
    v_mfma_f32_16x16x32_bf16 v[48:51], a[96:99], v[188:191], v[48:51]
    ds_read_b64_tr_b16 a[82:83], v225 offset:640
    v_exp_f32 v212, v180
    v_mfma_f32_16x16x32_bf16 v[52:55], a[100:103], v[188:191], v[52:55]
    v_exp_f32 v213, v181
    v_mfma_f32_16x16x32_bf16 v[56:59], a[104:107], v[188:191], v[56:59]
    ds_read_b64_tr_b16 a[84:85], v225 offset:160
    v_add_f32 v234, v234, v217
    v_add_f32 v218, v212, v213
    v_mfma_f32_16x16x32_bf16 v[60:63], a[108:111], v[188:191], v[60:63]
    v_cvt_pk_bf16_f32 v194, v212, v213
    v_exp_f32 v214, v182
    v_mfma_f32_16x16x32_bf16 v[64:67], a[112:115], v[188:191], v[64:67]
    s_add_u32 m0, s28, 42240
    ds_read_b64_tr_b16 a[86:87], v225 offset:672
    v_exp_f32 v215, v183
    v_mfma_f32_16x16x32_bf16 v[68:71], a[116:119], v[188:191], v[68:71]
    s_waitcnt vmcnt(3)
    buffer_load_dwordx4 v228, s[8:11], s27 offen nt lds
    v_mfma_f32_16x16x32_bf16 v[72:75], a[120:123], v[188:191], v[72:75]
    ds_read_b64_tr_b16 a[88:89], v225 offset:192
    v_add_f32 v234, v234, v218
    v_add_f32 v219, v214, v215
    v_mfma_f32_16x16x32_bf16 v[76:79], a[124:127], v[188:191], v[76:79]
    v_cvt_pk_bf16_f32 v195, v214, v215
    v_add_f32 v234, v234, v219
    v_cmp_nge_f32 vcc, s32, v234
    v_mfma_f32_16x16x32_bf16 v[168:171], a[0:3], v[128:131], v[200:203]
    ds_read_b64_tr_b16 a[90:91], v225 offset:704
    v_exp_f32 v208, v160
    v_mfma_f32_16x16x32_bf16 v[172:175], a[16:19], v[128:131], v[200:203]
    s_cbranch_vccnz L_stub_89
L_back_90:
    v_add_f32 v222, v222, v234
    v_mfma_f32_16x16x32_bf16 v[168:171], a[4:7], v[132:135], v[168:171]
    ds_read_b64_tr_b16 a[92:93], v225 offset:224
    v_exp_f32 v209, v161
    v_mfma_f32_16x16x32_bf16 v[172:175], a[20:23], v[132:135], v[172:175]
    v_add_f32 v232, v208, v209
    v_cvt_pk_bf16_f32 v184, v208, v209
    v_mfma_f32_16x16x32_bf16 v[168:171], a[8:11], v[136:139], v[168:171]
    ds_read_b64_tr_b16 a[94:95], v225 offset:736
    v_exp_f32 v210, v162
    v_mfma_f32_16x16x32_bf16 v[172:175], a[24:27], v[136:139], v[172:175]
    v_exp_f32 v211, v163
    v_mfma_f32_16x16x32_bf16 v[168:171], a[12:15], v[140:143], v[168:171]
    ds_read_b128 a[32:35], v224 offset:16896
    v_add_f32 v217, v210, v211
    v_mfma_f32_16x16x32_bf16 v[172:175], a[28:31], v[140:143], v[172:175]
    v_exp_f32 v212, v164
    v_mfma_f32_16x16x32_bf16 v[80:83], a[96:99], v[192:195], v[80:83]
    s_add_u32 m0, s28, 43040
    ds_read_b128 a[48:51], v224 offset:17408
    v_cvt_pk_bf16_f32 v185, v210, v211
    v_mfma_f32_16x16x32_bf16 v[84:87], a[100:103], v[192:195], v[84:87]
    s_waitcnt vmcnt(3)
    buffer_load_dwordx4 v228, s[8:11], s27 offen offset:256 nt lds
    v_mfma_f32_16x16x32_bf16 v[88:91], a[104:107], v[192:195], v[88:91]
    ds_read_b128 a[36:39], v224 offset:16960
    v_exp_f32 v213, v165
    v_mfma_f32_16x16x32_bf16 v[92:95], a[108:111], v[192:195], v[92:95]
    v_add_f32 v232, v232, v217
    v_add_f32 v218, v212, v213
    v_mfma_f32_16x16x32_bf16 v[96:99], a[112:115], v[192:195], v[96:99]
    ds_read_b128 a[52:55], v224 offset:17472
    v_exp_f32 v214, v166
    v_mfma_f32_16x16x32_bf16 v[100:103], a[116:119], v[192:195], v[100:103]
    v_cvt_pk_bf16_f32 v186, v212, v213
    v_exp_f32 v215, v167
    v_mfma_f32_16x16x32_bf16 v[104:107], a[120:123], v[192:195], v[104:107]
    ds_read_b128 a[40:43], v224 offset:17024
    v_add_f32 v232, v232, v218
    v_add_f32 v219, v214, v215
    v_mfma_f32_16x16x32_bf16 v[108:111], a[124:127], v[192:195], v[108:111]
    v_cvt_pk_bf16_f32 v187, v214, v215
    v_add_f32 v232, v232, v219
    v_cmp_nge_f32 vcc, s32, v232
    v_mfma_f32_16x16x32_bf16 v[176:179], a[0:3], v[144:147], v[204:207]
    ds_read_b128 a[56:59], v224 offset:17536
    v_exp_f32 v208, v168
    v_mfma_f32_16x16x32_bf16 v[180:183], a[16:19], v[144:147], v[204:207]
    s_cbranch_vccnz L_stub_91
L_back_92:
    v_exp_f32 v209, v169
    v_mfma_f32_16x16x32_bf16 v[176:179], a[4:7], v[148:151], v[176:179]
    ds_read_b128 a[44:47], v224 offset:17088
    v_add_f32 v220, v220, v232
    v_add_f32 v233, v208, v209
    v_mfma_f32_16x16x32_bf16 v[180:183], a[20:23], v[148:151], v[180:183]
    v_exp_f32 v210, v170
    v_mfma_f32_16x16x32_bf16 v[176:179], a[8:11], v[152:155], v[176:179]
    s_add_u32 m0, s28, 50688
    ds_read_b128 a[60:63], v224 offset:17600
    v_cvt_pk_bf16_f32 v188, v208, v209
    v_mfma_f32_16x16x32_bf16 v[180:183], a[24:27], v[152:155], v[180:183]
    s_waitcnt vmcnt(3)
    buffer_load_dwordx4 v229, s[4:7], s27 offen nt lds
    v_mfma_f32_16x16x32_bf16 v[176:179], a[12:15], v[156:159], v[176:179]
    ds_read_b64_tr_b16 a[96:97], v225 offset:16896
    v_exp_f32 v211, v171
    v_mfma_f32_16x16x32_bf16 v[180:183], a[28:31], v[156:159], v[180:183]
    s_waitcnt lgkmcnt(9)
    ds_read_b64_tr_b16 a[98:99], v225 offset:17408
    v_add_f32 v217, v210, v211
    v_mfma_f32_16x16x32_bf16 v[16:19], a[64:67], v[184:187], v[16:19]
    ds_read_b64_tr_b16 a[100:101], v225 offset:16928
    v_cvt_pk_bf16_f32 v189, v210, v211
    v_mfma_f32_16x16x32_bf16 v[20:23], a[68:71], v[184:187], v[20:23]
    v_exp_f32 v212, v172
    v_mfma_f32_16x16x32_bf16 v[24:27], a[72:75], v[184:187], v[24:27]
    ds_read_b64_tr_b16 a[102:103], v225 offset:17440
    v_exp_f32 v213, v173
    v_mfma_f32_16x16x32_bf16 v[28:31], a[76:79], v[184:187], v[28:31]
    ds_read_b64_tr_b16 a[104:105], v225 offset:16960
    v_add_f32 v233, v233, v217
    v_add_f32 v218, v212, v213
    v_mfma_f32_16x16x32_bf16 v[32:35], a[80:83], v[184:187], v[32:35]
    ds_read_b64_tr_b16 a[106:107], v225 offset:17472
    v_exp_f32 v214, v174
    v_mfma_f32_16x16x32_bf16 v[36:39], a[84:87], v[184:187], v[36:39]
    v_cvt_pk_bf16_f32 v190, v212, v213
    v_exp_f32 v215, v175
    v_mfma_f32_16x16x32_bf16 v[40:43], a[88:91], v[184:187], v[40:43]
    ds_read_b64_tr_b16 a[108:109], v225 offset:16992
    v_add_f32 v233, v233, v218
    v_add_f32 v219, v214, v215
    v_mfma_f32_16x16x32_bf16 v[44:47], a[92:95], v[184:187], v[44:47]
    s_waitcnt lgkmcnt(7)
    v_cvt_pk_bf16_f32 v191, v214, v215
    v_add_f32 v233, v233, v219
    v_cmp_nge_f32 vcc, s32, v233
    v_mfma_f32_16x16x32_bf16 v[160:163], a[32:35], v[112:115], v[196:199]
    s_add_u32 m0, s28, 51488
    ds_read_b64_tr_b16 a[110:111], v225 offset:17504
    v_exp_f32 v208, v176
    v_mfma_f32_16x16x32_bf16 v[164:167], a[48:51], v[112:115], v[196:199]
    s_waitcnt vmcnt(3)
    s_cbranch_vccnz L_stub_93
L_back_94:
    buffer_load_dwordx4 v229, s[4:7], s27 offen offset:256 nt lds
    v_mfma_f32_16x16x32_bf16 v[160:163], a[36:39], v[116:119], v[160:163]
    ds_read_b64_tr_b16 a[112:113], v225 offset:17024
    v_exp_f32 v209, v177
    v_mfma_f32_16x16x32_bf16 v[164:167], a[52:55], v[116:119], v[164:167]
    v_add_f32 v221, v221, v233
    v_add_f32 v234, v208, v209
    v_mfma_f32_16x16x32_bf16 v[160:163], a[40:43], v[120:123], v[160:163]
    ds_read_b64_tr_b16 a[114:115], v225 offset:17536
    v_cvt_pk_bf16_f32 v192, v208, v209
    v_mfma_f32_16x16x32_bf16 v[164:167], a[56:59], v[120:123], v[164:167]
    ds_read_b64_tr_b16 a[116:117], v225 offset:17056
    v_exp_f32 v210, v178
    v_mfma_f32_16x16x32_bf16 v[160:163], a[44:47], v[124:127], v[160:163]
    ds_read_b64_tr_b16 a[118:119], v225 offset:17568
    v_exp_f32 v211, v179
    v_mfma_f32_16x16x32_bf16 v[164:167], a[60:63], v[124:127], v[164:167]
    v_add_f32 v217, v210, v211
    v_cvt_pk_bf16_f32 v193, v210, v211
    v_mfma_f32_16x16x32_bf16 v[48:51], a[64:67], v[188:191], v[48:51]
    ds_read_b64_tr_b16 a[120:121], v225 offset:17088
    v_exp_f32 v212, v180
    v_mfma_f32_16x16x32_bf16 v[52:55], a[68:71], v[188:191], v[52:55]
    v_exp_f32 v213, v181
    v_mfma_f32_16x16x32_bf16 v[56:59], a[72:75], v[188:191], v[56:59]
    ds_read_b64_tr_b16 a[122:123], v225 offset:17600
    v_add_f32 v234, v234, v217
    v_add_f32 v218, v212, v213
    v_mfma_f32_16x16x32_bf16 v[60:63], a[76:79], v[188:191], v[60:63]
    v_cvt_pk_bf16_f32 v194, v212, v213
    v_exp_f32 v214, v182
    v_mfma_f32_16x16x32_bf16 v[64:67], a[80:83], v[188:191], v[64:67]
    s_add_u32 m0, s28, 59136
    ds_read_b64_tr_b16 a[124:125], v225 offset:17120
    v_exp_f32 v215, v183
    v_mfma_f32_16x16x32_bf16 v[68:71], a[84:87], v[188:191], v[68:71]
    s_waitcnt vmcnt(3)
    buffer_load_dwordx4 v229, s[8:11], s27 offen nt lds
    v_mfma_f32_16x16x32_bf16 v[72:75], a[88:91], v[188:191], v[72:75]
    ds_read_b64_tr_b16 a[126:127], v225 offset:17632
    v_add_f32 v234, v234, v218
    v_add_f32 v219, v214, v215
    v_mfma_f32_16x16x32_bf16 v[76:79], a[92:95], v[188:191], v[76:79]
    v_cvt_pk_bf16_f32 v195, v214, v215
    v_add_f32 v234, v234, v219
    v_cmp_nge_f32 vcc, s32, v234
    v_mfma_f32_16x16x32_bf16 v[168:171], a[32:35], v[128:131], v[200:203]
    v_exp_f32 v208, v160
    v_mfma_f32_16x16x32_bf16 v[172:175], a[48:51], v[128:131], v[200:203]
    s_cbranch_vccnz L_stub_95
L_back_96:
    v_add_u32 v224, 0, v226
    v_add_f32 v222, v222, v234
    v_mfma_f32_16x16x32_bf16 v[168:171], a[36:39], v[132:135], v[168:171]
    v_add_u32 v225, 0, v227
    v_exp_f32 v209, v161
    v_mfma_f32_16x16x32_bf16 v[172:175], a[52:55], v[132:135], v[172:175]
    s_waitcnt lgkmcnt(0)
    s_barrier
    v_mfma_f32_16x16x32_bf16 v[168:171], a[40:43], v[136:139], v[168:171]
    ds_read_b128 a[0:3], v224 offset:0
    v_add_f32 v232, v208, v209
    v_mfma_f32_16x16x32_bf16 v[172:175], a[56:59], v[136:139], v[172:175]
    v_exp_f32 v210, v162
    v_mfma_f32_16x16x32_bf16 v[168:171], a[44:47], v[140:143], v[168:171]
    ds_read_b128 a[16:19], v224 offset:512
    v_exp_f32 v211, v163
    v_mfma_f32_16x16x32_bf16 v[172:175], a[60:63], v[140:143], v[172:175]
    v_cvt_pk_bf16_f32 v184, v208, v209
    v_add_f32 v217, v210, v211
    v_mfma_f32_16x16x32_bf16 v[80:83], a[64:67], v[192:195], v[80:83]
    s_add_u32 m0, s28, 59936
    ds_read_b128 a[4:7], v224 offset:64
    v_exp_f32 v212, v164
    v_mfma_f32_16x16x32_bf16 v[84:87], a[68:71], v[192:195], v[84:87]
    s_waitcnt vmcnt(3)
    buffer_load_dwordx4 v229, s[8:11], s27 offen offset:256 nt lds
    v_mfma_f32_16x16x32_bf16 v[88:91], a[72:75], v[192:195], v[88:91]
    ds_read_b128 a[20:23], v224 offset:576
    v_exp_f32 v213, v165
    v_mfma_f32_16x16x32_bf16 v[92:95], a[76:79], v[192:195], v[92:95]
    v_cvt_pk_bf16_f32 v185, v210, v211
    v_add_f32 v232, v232, v217
    v_add_f32 v218, v212, v213
    v_mfma_f32_16x16x32_bf16 v[96:99], a[80:83], v[192:195], v[96:99]
    ds_read_b128 a[8:11], v224 offset:128
    v_exp_f32 v214, v166
    v_mfma_f32_16x16x32_bf16 v[100:103], a[84:87], v[192:195], v[100:103]
    v_cvt_pk_bf16_f32 v186, v212, v213
    v_exp_f32 v215, v167
    v_mfma_f32_16x16x32_bf16 v[104:107], a[88:91], v[192:195], v[104:107]
    ds_read_b128 a[24:27], v224 offset:640
    v_add_f32 v232, v232, v218
    v_add_f32 v219, v214, v215
    v_mfma_f32_16x16x32_bf16 v[108:111], a[92:95], v[192:195], v[108:111]
    v_cvt_pk_bf16_f32 v187, v214, v215
    v_add_f32 v232, v232, v219
    v_cmp_nge_f32 vcc, s32, v232
    v_mfma_f32_16x16x32_bf16 v[176:179], a[32:35], v[144:147], v[204:207]
    ds_read_b128 a[12:15], v224 offset:192
    v_exp_f32 v208, v168
    v_mfma_f32_16x16x32_bf16 v[180:183], a[48:51], v[144:147], v[204:207]
    s_cbranch_vccnz L_stub_97
L_back_98:
    v_add_f32 v220, v220, v232
    v_mfma_f32_16x16x32_bf16 v[176:179], a[36:39], v[148:151], v[176:179]
    ds_read_b128 a[28:31], v224 offset:704
    v_exp_f32 v209, v169
    v_mfma_f32_16x16x32_bf16 v[180:183], a[52:55], v[148:151], v[180:183]
    s_mov_b32 s27, 180224
    v_exp_f32 v210, v170
    v_mfma_f32_16x16x32_bf16 v[176:179], a[40:43], v[152:155], v[176:179]
    s_add_u32 m0, s28, 67584
    ds_read_b64_tr_b16 a[64:65], v225 offset:0
    v_add_f32 v233, v208, v209
    v_mfma_f32_16x16x32_bf16 v[180:183], a[56:59], v[152:155], v[180:183]
    s_waitcnt vmcnt(3)
    buffer_load_dwordx4 v228, s[4:7], s27 offen nt lds
    v_mfma_f32_16x16x32_bf16 v[176:179], a[44:47], v[156:159], v[176:179]
    ds_read_b64_tr_b16 a[66:67], v225 offset:512
    v_cvt_pk_bf16_f32 v188, v208, v209
    v_mfma_f32_16x16x32_bf16 v[180:183], a[60:63], v[156:159], v[180:183]
    v_exp_f32 v211, v171
    v_mfma_f32_16x16x32_bf16 v[16:19], a[96:99], v[184:187], v[16:19]
    ds_read_b64_tr_b16 a[68:69], v225 offset:32
    v_add_f32 v217, v210, v211
    v_mfma_f32_16x16x32_bf16 v[20:23], a[100:103], v[184:187], v[20:23]
    v_cvt_pk_bf16_f32 v189, v210, v211
    v_add_f32 v233, v233, v217
    v_mfma_f32_16x16x32_bf16 v[24:27], a[104:107], v[184:187], v[24:27]
    ds_read_b64_tr_b16 a[70:71], v225 offset:544
    v_exp_f32 v212, v172
    v_mfma_f32_16x16x32_bf16 v[28:31], a[108:111], v[184:187], v[28:31]
    v_exp_f32 v213, v173
    v_mfma_f32_16x16x32_bf16 v[32:35], a[112:115], v[184:187], v[32:35]
    ds_read_b64_tr_b16 a[72:73], v225 offset:64
    v_exp_f32 v214, v174
    v_mfma_f32_16x16x32_bf16 v[36:39], a[116:119], v[184:187], v[36:39]
    v_add_f32 v218, v212, v213
    v_exp_f32 v215, v175
    v_mfma_f32_16x16x32_bf16 v[40:43], a[120:123], v[184:187], v[40:43]
    v_cvt_pk_bf16_f32 v190, v212, v213
    v_add_f32 v233, v233, v218
    v_add_f32 v219, v214, v215
    v_mfma_f32_16x16x32_bf16 v[44:47], a[124:127], v[184:187], v[44:47]
    s_waitcnt lgkmcnt(5)
    v_cvt_pk_bf16_f32 v191, v214, v215
    v_add_f32 v233, v233, v219
    v_cmp_nge_f32 vcc, s32, v233
    v_mfma_f32_16x16x32_bf16 v[160:163], a[0:3], v[112:115], v[196:199]
    s_add_u32 m0, s28, 68384
    ds_read_b64_tr_b16 a[74:75], v225 offset:576
    v_exp_f32 v208, v176
    v_mfma_f32_16x16x32_bf16 v[164:167], a[16:19], v[112:115], v[196:199]
    s_waitcnt vmcnt(3)
    s_cbranch_vccnz L_stub_99
L_back_100:
    buffer_load_dwordx4 v228, s[4:7], s27 offen offset:256 nt lds
    v_mfma_f32_16x16x32_bf16 v[160:163], a[4:7], v[116:119], v[160:163]
    ds_read_b64_tr_b16 a[76:77], v225 offset:96
    v_exp_f32 v209, v177
    v_mfma_f32_16x16x32_bf16 v[164:167], a[20:23], v[116:119], v[164:167]
    v_add_f32 v221, v221, v233
    v_add_f32 v234, v208, v209
    v_mfma_f32_16x16x32_bf16 v[160:163], a[8:11], v[120:123], v[160:163]
    ds_read_b64_tr_b16 a[78:79], v225 offset:608
    v_cvt_pk_bf16_f32 v192, v208, v209
    v_mfma_f32_16x16x32_bf16 v[164:167], a[24:27], v[120:123], v[164:167]
    v_exp_f32 v210, v178
    v_mfma_f32_16x16x32_bf16 v[160:163], a[12:15], v[124:127], v[160:163]
    ds_read_b64_tr_b16 a[80:81], v225 offset:128
    v_exp_f32 v211, v179
    v_mfma_f32_16x16x32_bf16 v[164:167], a[28:31], v[124:127], v[164:167]
    v_add_f32 v217, v210, v211
    v_cvt_pk_bf16_f32 v193, v210, v211
    v_mfma_f32_16x16x32_bf16 v[48:51], a[96:99], v[188:191], v[48:51]
    ds_read_b64_tr_b16 a[82:83], v225 offset:640
    v_exp_f32 v212, v180
    v_mfma_f32_16x16x32_bf16 v[52:55], a[100:103], v[188:191], v[52:55]
    v_exp_f32 v213, v181
    v_mfma_f32_16x16x32_bf16 v[56:59], a[104:107], v[188:191], v[56:59]
    ds_read_b64_tr_b16 a[84:85], v225 offset:160
    v_add_f32 v234, v234, v217
    v_add_f32 v218, v212, v213
    v_mfma_f32_16x16x32_bf16 v[60:63], a[108:111], v[188:191], v[60:63]
    v_cvt_pk_bf16_f32 v194, v212, v213
    v_exp_f32 v214, v182
    v_mfma_f32_16x16x32_bf16 v[64:67], a[112:115], v[188:191], v[64:67]
    s_add_u32 m0, s28, 76032
    ds_read_b64_tr_b16 a[86:87], v225 offset:672
    v_exp_f32 v215, v183
    v_mfma_f32_16x16x32_bf16 v[68:71], a[116:119], v[188:191], v[68:71]
    s_waitcnt vmcnt(3)
    buffer_load_dwordx4 v228, s[8:11], s27 offen nt lds
    v_mfma_f32_16x16x32_bf16 v[72:75], a[120:123], v[188:191], v[72:75]
    ds_read_b64_tr_b16 a[88:89], v225 offset:192
    v_add_f32 v234, v234, v218
    v_add_f32 v219, v214, v215
    v_mfma_f32_16x16x32_bf16 v[76:79], a[124:127], v[188:191], v[76:79]
    v_cvt_pk_bf16_f32 v195, v214, v215
    v_add_f32 v234, v234, v219
    v_cmp_nge_f32 vcc, s32, v234
    v_mfma_f32_16x16x32_bf16 v[168:171], a[0:3], v[128:131], v[200:203]
    ds_read_b64_tr_b16 a[90:91], v225 offset:704
    v_exp_f32 v208, v160
    v_mfma_f32_16x16x32_bf16 v[172:175], a[16:19], v[128:131], v[200:203]
    s_cbranch_vccnz L_stub_101
L_back_102:
    v_add_f32 v222, v222, v234
    v_mfma_f32_16x16x32_bf16 v[168:171], a[4:7], v[132:135], v[168:171]
    ds_read_b64_tr_b16 a[92:93], v225 offset:224
    v_exp_f32 v209, v161
    v_mfma_f32_16x16x32_bf16 v[172:175], a[20:23], v[132:135], v[172:175]
    v_add_f32 v232, v208, v209
    v_cvt_pk_bf16_f32 v184, v208, v209
    v_mfma_f32_16x16x32_bf16 v[168:171], a[8:11], v[136:139], v[168:171]
    ds_read_b64_tr_b16 a[94:95], v225 offset:736
    v_exp_f32 v210, v162
    v_mfma_f32_16x16x32_bf16 v[172:175], a[24:27], v[136:139], v[172:175]
    v_exp_f32 v211, v163
    v_mfma_f32_16x16x32_bf16 v[168:171], a[12:15], v[140:143], v[168:171]
    ds_read_b128 a[32:35], v224 offset:16896
    v_add_f32 v217, v210, v211
    v_mfma_f32_16x16x32_bf16 v[172:175], a[28:31], v[140:143], v[172:175]
    v_exp_f32 v212, v164
    v_mfma_f32_16x16x32_bf16 v[80:83], a[96:99], v[192:195], v[80:83]
    s_add_u32 m0, s28, 76832
    ds_read_b128 a[48:51], v224 offset:17408
    v_cvt_pk_bf16_f32 v185, v210, v211
    v_mfma_f32_16x16x32_bf16 v[84:87], a[100:103], v[192:195], v[84:87]
    s_waitcnt vmcnt(3)
    buffer_load_dwordx4 v228, s[8:11], s27 offen offset:256 nt lds
    v_mfma_f32_16x16x32_bf16 v[88:91], a[104:107], v[192:195], v[88:91]
    ds_read_b128 a[36:39], v224 offset:16960
    v_exp_f32 v213, v165
    v_mfma_f32_16x16x32_bf16 v[92:95], a[108:111], v[192:195], v[92:95]
    v_add_f32 v232, v232, v217
    v_add_f32 v218, v212, v213
    v_mfma_f32_16x16x32_bf16 v[96:99], a[112:115], v[192:195], v[96:99]
    ds_read_b128 a[52:55], v224 offset:17472
    v_exp_f32 v214, v166
    v_mfma_f32_16x16x32_bf16 v[100:103], a[116:119], v[192:195], v[100:103]
    v_cvt_pk_bf16_f32 v186, v212, v213
    v_exp_f32 v215, v167
    v_mfma_f32_16x16x32_bf16 v[104:107], a[120:123], v[192:195], v[104:107]
    ds_read_b128 a[40:43], v224 offset:17024
    v_add_f32 v232, v232, v218
    v_add_f32 v219, v214, v215
    v_mfma_f32_16x16x32_bf16 v[108:111], a[124:127], v[192:195], v[108:111]
    v_cvt_pk_bf16_f32 v187, v214, v215
    v_add_f32 v232, v232, v219
    v_cmp_nge_f32 vcc, s32, v232
    v_mfma_f32_16x16x32_bf16 v[176:179], a[0:3], v[144:147], v[204:207]
    ds_read_b128 a[56:59], v224 offset:17536
    v_exp_f32 v208, v168
    v_mfma_f32_16x16x32_bf16 v[180:183], a[16:19], v[144:147], v[204:207]
    s_cbranch_vccnz L_stub_103
L_back_104:
    v_exp_f32 v209, v169
    v_mfma_f32_16x16x32_bf16 v[176:179], a[4:7], v[148:151], v[176:179]
    ds_read_b128 a[44:47], v224 offset:17088
    v_add_f32 v220, v220, v232
    v_add_f32 v233, v208, v209
    v_mfma_f32_16x16x32_bf16 v[180:183], a[20:23], v[148:151], v[180:183]
    v_exp_f32 v210, v170
    v_mfma_f32_16x16x32_bf16 v[176:179], a[8:11], v[152:155], v[176:179]
    s_add_u32 m0, s28, 84480
    ds_read_b128 a[60:63], v224 offset:17600
    v_cvt_pk_bf16_f32 v188, v208, v209
    v_mfma_f32_16x16x32_bf16 v[180:183], a[24:27], v[152:155], v[180:183]
    s_waitcnt vmcnt(3)
    buffer_load_dwordx4 v229, s[4:7], s27 offen nt lds
    v_mfma_f32_16x16x32_bf16 v[176:179], a[12:15], v[156:159], v[176:179]
    ds_read_b64_tr_b16 a[96:97], v225 offset:16896
    v_exp_f32 v211, v171
    v_mfma_f32_16x16x32_bf16 v[180:183], a[28:31], v[156:159], v[180:183]
    s_waitcnt lgkmcnt(9)
    ds_read_b64_tr_b16 a[98:99], v225 offset:17408
    v_add_f32 v217, v210, v211
    v_mfma_f32_16x16x32_bf16 v[16:19], a[64:67], v[184:187], v[16:19]
    ds_read_b64_tr_b16 a[100:101], v225 offset:16928
    v_cvt_pk_bf16_f32 v189, v210, v211
    v_mfma_f32_16x16x32_bf16 v[20:23], a[68:71], v[184:187], v[20:23]
    v_exp_f32 v212, v172
    v_mfma_f32_16x16x32_bf16 v[24:27], a[72:75], v[184:187], v[24:27]
    ds_read_b64_tr_b16 a[102:103], v225 offset:17440
    v_exp_f32 v213, v173
    v_mfma_f32_16x16x32_bf16 v[28:31], a[76:79], v[184:187], v[28:31]
    ds_read_b64_tr_b16 a[104:105], v225 offset:16960
    v_add_f32 v233, v233, v217
    v_add_f32 v218, v212, v213
    v_mfma_f32_16x16x32_bf16 v[32:35], a[80:83], v[184:187], v[32:35]
    ds_read_b64_tr_b16 a[106:107], v225 offset:17472
    v_exp_f32 v214, v174
    v_mfma_f32_16x16x32_bf16 v[36:39], a[84:87], v[184:187], v[36:39]
    v_cvt_pk_bf16_f32 v190, v212, v213
    v_exp_f32 v215, v175
    v_mfma_f32_16x16x32_bf16 v[40:43], a[88:91], v[184:187], v[40:43]
    ds_read_b64_tr_b16 a[108:109], v225 offset:16992
    v_add_f32 v233, v233, v218
    v_add_f32 v219, v214, v215
    v_mfma_f32_16x16x32_bf16 v[44:47], a[92:95], v[184:187], v[44:47]
    s_waitcnt lgkmcnt(7)
    v_cvt_pk_bf16_f32 v191, v214, v215
    v_add_f32 v233, v233, v219
    v_cmp_nge_f32 vcc, s32, v233
    v_mfma_f32_16x16x32_bf16 v[160:163], a[32:35], v[112:115], v[196:199]
    s_add_u32 m0, s28, 85280
    ds_read_b64_tr_b16 a[110:111], v225 offset:17504
    v_exp_f32 v208, v176
    v_mfma_f32_16x16x32_bf16 v[164:167], a[48:51], v[112:115], v[196:199]
    s_waitcnt vmcnt(3)
    s_cbranch_vccnz L_stub_105
L_back_106:
    buffer_load_dwordx4 v229, s[4:7], s27 offen offset:256 nt lds
    v_mfma_f32_16x16x32_bf16 v[160:163], a[36:39], v[116:119], v[160:163]
    ds_read_b64_tr_b16 a[112:113], v225 offset:17024
    v_exp_f32 v209, v177
    v_mfma_f32_16x16x32_bf16 v[164:167], a[52:55], v[116:119], v[164:167]
    v_add_f32 v221, v221, v233
    v_add_f32 v234, v208, v209
    v_mfma_f32_16x16x32_bf16 v[160:163], a[40:43], v[120:123], v[160:163]
    ds_read_b64_tr_b16 a[114:115], v225 offset:17536
    v_cvt_pk_bf16_f32 v192, v208, v209
    v_mfma_f32_16x16x32_bf16 v[164:167], a[56:59], v[120:123], v[164:167]
    ds_read_b64_tr_b16 a[116:117], v225 offset:17056
    v_exp_f32 v210, v178
    v_mfma_f32_16x16x32_bf16 v[160:163], a[44:47], v[124:127], v[160:163]
    ds_read_b64_tr_b16 a[118:119], v225 offset:17568
    v_exp_f32 v211, v179
    v_mfma_f32_16x16x32_bf16 v[164:167], a[60:63], v[124:127], v[164:167]
    v_add_f32 v217, v210, v211
    v_cvt_pk_bf16_f32 v193, v210, v211
    v_mfma_f32_16x16x32_bf16 v[48:51], a[64:67], v[188:191], v[48:51]
    ds_read_b64_tr_b16 a[120:121], v225 offset:17088
    v_exp_f32 v212, v180
    v_mfma_f32_16x16x32_bf16 v[52:55], a[68:71], v[188:191], v[52:55]
    v_exp_f32 v213, v181
    v_mfma_f32_16x16x32_bf16 v[56:59], a[72:75], v[188:191], v[56:59]
    ds_read_b64_tr_b16 a[122:123], v225 offset:17600
    v_add_f32 v234, v234, v217
    v_add_f32 v218, v212, v213
    v_mfma_f32_16x16x32_bf16 v[60:63], a[76:79], v[188:191], v[60:63]
    v_cvt_pk_bf16_f32 v194, v212, v213
    v_exp_f32 v214, v182
    v_mfma_f32_16x16x32_bf16 v[64:67], a[80:83], v[188:191], v[64:67]
    s_add_u32 m0, s28, 92928
    ds_read_b64_tr_b16 a[124:125], v225 offset:17120
    v_exp_f32 v215, v183
    v_mfma_f32_16x16x32_bf16 v[68:71], a[84:87], v[188:191], v[68:71]
    s_waitcnt vmcnt(3)
    buffer_load_dwordx4 v229, s[8:11], s27 offen nt lds
    v_mfma_f32_16x16x32_bf16 v[72:75], a[88:91], v[188:191], v[72:75]
    ds_read_b64_tr_b16 a[126:127], v225 offset:17632
    v_add_f32 v234, v234, v218
    v_add_f32 v219, v214, v215
    v_mfma_f32_16x16x32_bf16 v[76:79], a[92:95], v[188:191], v[76:79]
    v_cvt_pk_bf16_f32 v195, v214, v215
    v_add_f32 v234, v234, v219
    v_cmp_nge_f32 vcc, s32, v234
    v_mfma_f32_16x16x32_bf16 v[168:171], a[32:35], v[128:131], v[200:203]
    v_exp_f32 v208, v160
    v_mfma_f32_16x16x32_bf16 v[172:175], a[48:51], v[128:131], v[200:203]
    s_cbranch_vccnz L_stub_107
L_back_108:
    v_add_u32 v224, 33792, v226
    v_add_f32 v222, v222, v234
    v_mfma_f32_16x16x32_bf16 v[168:171], a[36:39], v[132:135], v[168:171]
    v_add_u32 v225, 33792, v227
    v_exp_f32 v209, v161
    v_mfma_f32_16x16x32_bf16 v[172:175], a[52:55], v[132:135], v[172:175]
    s_waitcnt lgkmcnt(0)
    s_barrier
    v_mfma_f32_16x16x32_bf16 v[168:171], a[40:43], v[136:139], v[168:171]
    ds_read_b128 a[0:3], v224 offset:0
    v_add_f32 v232, v208, v209
    v_mfma_f32_16x16x32_bf16 v[172:175], a[56:59], v[136:139], v[172:175]
    v_exp_f32 v210, v162
    v_mfma_f32_16x16x32_bf16 v[168:171], a[44:47], v[140:143], v[168:171]
    ds_read_b128 a[16:19], v224 offset:512
    v_exp_f32 v211, v163
    v_mfma_f32_16x16x32_bf16 v[172:175], a[60:63], v[140:143], v[172:175]
    v_cvt_pk_bf16_f32 v184, v208, v209
    v_add_f32 v217, v210, v211
    v_mfma_f32_16x16x32_bf16 v[80:83], a[64:67], v[192:195], v[80:83]
    s_add_u32 m0, s28, 93728
    ds_read_b128 a[4:7], v224 offset:64
    v_exp_f32 v212, v164
    v_mfma_f32_16x16x32_bf16 v[84:87], a[68:71], v[192:195], v[84:87]
    s_waitcnt vmcnt(3)
    buffer_load_dwordx4 v229, s[8:11], s27 offen offset:256 nt lds
    v_mfma_f32_16x16x32_bf16 v[88:91], a[72:75], v[192:195], v[88:91]
    ds_read_b128 a[20:23], v224 offset:576
    v_exp_f32 v213, v165
    v_mfma_f32_16x16x32_bf16 v[92:95], a[76:79], v[192:195], v[92:95]
    v_cvt_pk_bf16_f32 v185, v210, v211
    v_add_f32 v232, v232, v217
    v_add_f32 v218, v212, v213
    v_mfma_f32_16x16x32_bf16 v[96:99], a[80:83], v[192:195], v[96:99]
    ds_read_b128 a[8:11], v224 offset:128
    v_exp_f32 v214, v166
    v_mfma_f32_16x16x32_bf16 v[100:103], a[84:87], v[192:195], v[100:103]
    v_cvt_pk_bf16_f32 v186, v212, v213
    v_exp_f32 v215, v167
    v_mfma_f32_16x16x32_bf16 v[104:107], a[88:91], v[192:195], v[104:107]
    ds_read_b128 a[24:27], v224 offset:640
    v_add_f32 v232, v232, v218
    v_add_f32 v219, v214, v215
    v_mfma_f32_16x16x32_bf16 v[108:111], a[92:95], v[192:195], v[108:111]
    v_cvt_pk_bf16_f32 v187, v214, v215
    v_add_f32 v232, v232, v219
    v_cmp_nge_f32 vcc, s32, v232
    v_mfma_f32_16x16x32_bf16 v[176:179], a[32:35], v[144:147], v[204:207]
    ds_read_b128 a[12:15], v224 offset:192
    v_exp_f32 v208, v168
    v_mfma_f32_16x16x32_bf16 v[180:183], a[48:51], v[144:147], v[204:207]
    s_cbranch_vccnz L_stub_109
L_back_110:
    v_add_f32 v220, v220, v232
    v_mfma_f32_16x16x32_bf16 v[176:179], a[36:39], v[148:151], v[176:179]
    ds_read_b128 a[28:31], v224 offset:704
    v_exp_f32 v209, v169
    v_mfma_f32_16x16x32_bf16 v[180:183], a[52:55], v[148:151], v[180:183]
    s_mov_b32 s27, 196608
    v_exp_f32 v210, v170
    v_mfma_f32_16x16x32_bf16 v[176:179], a[40:43], v[152:155], v[176:179]
    s_add_u32 m0, s28, 0
    ds_read_b64_tr_b16 a[64:65], v225 offset:0
    v_add_f32 v233, v208, v209
    v_mfma_f32_16x16x32_bf16 v[180:183], a[56:59], v[152:155], v[180:183]
    s_waitcnt vmcnt(3)
    buffer_load_dwordx4 v228, s[4:7], s27 offen nt lds
    v_mfma_f32_16x16x32_bf16 v[176:179], a[44:47], v[156:159], v[176:179]
    ds_read_b64_tr_b16 a[66:67], v225 offset:512
    v_cvt_pk_bf16_f32 v188, v208, v209
    v_mfma_f32_16x16x32_bf16 v[180:183], a[60:63], v[156:159], v[180:183]
    v_exp_f32 v211, v171
    v_mfma_f32_16x16x32_bf16 v[16:19], a[96:99], v[184:187], v[16:19]
    ds_read_b64_tr_b16 a[68:69], v225 offset:32
    v_add_f32 v217, v210, v211
    v_mfma_f32_16x16x32_bf16 v[20:23], a[100:103], v[184:187], v[20:23]
    v_cvt_pk_bf16_f32 v189, v210, v211
    v_add_f32 v233, v233, v217
    v_mfma_f32_16x16x32_bf16 v[24:27], a[104:107], v[184:187], v[24:27]
    ds_read_b64_tr_b16 a[70:71], v225 offset:544
    v_exp_f32 v212, v172
    v_mfma_f32_16x16x32_bf16 v[28:31], a[108:111], v[184:187], v[28:31]
    v_exp_f32 v213, v173
    v_mfma_f32_16x16x32_bf16 v[32:35], a[112:115], v[184:187], v[32:35]
    ds_read_b64_tr_b16 a[72:73], v225 offset:64
    v_exp_f32 v214, v174
    v_mfma_f32_16x16x32_bf16 v[36:39], a[116:119], v[184:187], v[36:39]
    v_add_f32 v218, v212, v213
    v_exp_f32 v215, v175
    v_mfma_f32_16x16x32_bf16 v[40:43], a[120:123], v[184:187], v[40:43]
    v_cvt_pk_bf16_f32 v190, v212, v213
    v_add_f32 v233, v233, v218
    v_add_f32 v219, v214, v215
    v_mfma_f32_16x16x32_bf16 v[44:47], a[124:127], v[184:187], v[44:47]
    s_waitcnt lgkmcnt(5)
    v_cvt_pk_bf16_f32 v191, v214, v215
    v_add_f32 v233, v233, v219
    v_cmp_nge_f32 vcc, s32, v233
    v_mfma_f32_16x16x32_bf16 v[160:163], a[0:3], v[112:115], v[196:199]
    s_add_u32 m0, s28, 800
    ds_read_b64_tr_b16 a[74:75], v225 offset:576
    v_exp_f32 v208, v176
    v_mfma_f32_16x16x32_bf16 v[164:167], a[16:19], v[112:115], v[196:199]
    s_waitcnt vmcnt(3)
    s_cbranch_vccnz L_stub_111
L_back_112:
    buffer_load_dwordx4 v228, s[4:7], s27 offen offset:256 nt lds
    v_mfma_f32_16x16x32_bf16 v[160:163], a[4:7], v[116:119], v[160:163]
    ds_read_b64_tr_b16 a[76:77], v225 offset:96
    v_exp_f32 v209, v177
    v_mfma_f32_16x16x32_bf16 v[164:167], a[20:23], v[116:119], v[164:167]
    v_add_f32 v221, v221, v233
    v_add_f32 v234, v208, v209
    v_mfma_f32_16x16x32_bf16 v[160:163], a[8:11], v[120:123], v[160:163]
    ds_read_b64_tr_b16 a[78:79], v225 offset:608
    v_cvt_pk_bf16_f32 v192, v208, v209
    v_mfma_f32_16x16x32_bf16 v[164:167], a[24:27], v[120:123], v[164:167]
    v_exp_f32 v210, v178
    v_mfma_f32_16x16x32_bf16 v[160:163], a[12:15], v[124:127], v[160:163]
    ds_read_b64_tr_b16 a[80:81], v225 offset:128
    v_exp_f32 v211, v179
    v_mfma_f32_16x16x32_bf16 v[164:167], a[28:31], v[124:127], v[164:167]
    v_add_f32 v217, v210, v211
    v_cvt_pk_bf16_f32 v193, v210, v211
    v_mfma_f32_16x16x32_bf16 v[48:51], a[96:99], v[188:191], v[48:51]
    ds_read_b64_tr_b16 a[82:83], v225 offset:640
    v_exp_f32 v212, v180
    v_mfma_f32_16x16x32_bf16 v[52:55], a[100:103], v[188:191], v[52:55]
    v_exp_f32 v213, v181
    v_mfma_f32_16x16x32_bf16 v[56:59], a[104:107], v[188:191], v[56:59]
    ds_read_b64_tr_b16 a[84:85], v225 offset:160
    v_add_f32 v234, v234, v217
    v_add_f32 v218, v212, v213
    v_mfma_f32_16x16x32_bf16 v[60:63], a[108:111], v[188:191], v[60:63]
    v_cvt_pk_bf16_f32 v194, v212, v213
    v_exp_f32 v214, v182
    v_mfma_f32_16x16x32_bf16 v[64:67], a[112:115], v[188:191], v[64:67]
    s_add_u32 m0, s28, 8448
    ds_read_b64_tr_b16 a[86:87], v225 offset:672
    v_exp_f32 v215, v183
    v_mfma_f32_16x16x32_bf16 v[68:71], a[116:119], v[188:191], v[68:71]
    s_waitcnt vmcnt(3)
    buffer_load_dwordx4 v228, s[8:11], s27 offen nt lds
    v_mfma_f32_16x16x32_bf16 v[72:75], a[120:123], v[188:191], v[72:75]
    ds_read_b64_tr_b16 a[88:89], v225 offset:192
    v_add_f32 v234, v234, v218
    v_add_f32 v219, v214, v215
    v_mfma_f32_16x16x32_bf16 v[76:79], a[124:127], v[188:191], v[76:79]
    v_cvt_pk_bf16_f32 v195, v214, v215
    v_add_f32 v234, v234, v219
    v_cmp_nge_f32 vcc, s32, v234
    v_mfma_f32_16x16x32_bf16 v[168:171], a[0:3], v[128:131], v[200:203]
    ds_read_b64_tr_b16 a[90:91], v225 offset:704
    v_exp_f32 v208, v160
    v_mfma_f32_16x16x32_bf16 v[172:175], a[16:19], v[128:131], v[200:203]
    s_cbranch_vccnz L_stub_113
L_back_114:
    v_add_f32 v222, v222, v234
    v_mfma_f32_16x16x32_bf16 v[168:171], a[4:7], v[132:135], v[168:171]
    ds_read_b64_tr_b16 a[92:93], v225 offset:224
    v_exp_f32 v209, v161
    v_mfma_f32_16x16x32_bf16 v[172:175], a[20:23], v[132:135], v[172:175]
    v_add_f32 v232, v208, v209
    v_cvt_pk_bf16_f32 v184, v208, v209
    v_mfma_f32_16x16x32_bf16 v[168:171], a[8:11], v[136:139], v[168:171]
    ds_read_b64_tr_b16 a[94:95], v225 offset:736
    v_exp_f32 v210, v162
    v_mfma_f32_16x16x32_bf16 v[172:175], a[24:27], v[136:139], v[172:175]
    v_exp_f32 v211, v163
    v_mfma_f32_16x16x32_bf16 v[168:171], a[12:15], v[140:143], v[168:171]
    ds_read_b128 a[32:35], v224 offset:16896
    v_add_f32 v217, v210, v211
    v_mfma_f32_16x16x32_bf16 v[172:175], a[28:31], v[140:143], v[172:175]
    v_exp_f32 v212, v164
    v_mfma_f32_16x16x32_bf16 v[80:83], a[96:99], v[192:195], v[80:83]
    s_add_u32 m0, s28, 9248
    ds_read_b128 a[48:51], v224 offset:17408
    v_cvt_pk_bf16_f32 v185, v210, v211
    v_mfma_f32_16x16x32_bf16 v[84:87], a[100:103], v[192:195], v[84:87]
    s_waitcnt vmcnt(3)
    buffer_load_dwordx4 v228, s[8:11], s27 offen offset:256 nt lds
    v_mfma_f32_16x16x32_bf16 v[88:91], a[104:107], v[192:195], v[88:91]
    ds_read_b128 a[36:39], v224 offset:16960
    v_exp_f32 v213, v165
    v_mfma_f32_16x16x32_bf16 v[92:95], a[108:111], v[192:195], v[92:95]
    v_add_f32 v232, v232, v217
    v_add_f32 v218, v212, v213
    v_mfma_f32_16x16x32_bf16 v[96:99], a[112:115], v[192:195], v[96:99]
    ds_read_b128 a[52:55], v224 offset:17472
    v_exp_f32 v214, v166
    v_mfma_f32_16x16x32_bf16 v[100:103], a[116:119], v[192:195], v[100:103]
    v_cvt_pk_bf16_f32 v186, v212, v213
    v_exp_f32 v215, v167
    v_mfma_f32_16x16x32_bf16 v[104:107], a[120:123], v[192:195], v[104:107]
    ds_read_b128 a[40:43], v224 offset:17024
    v_add_f32 v232, v232, v218
    v_add_f32 v219, v214, v215
    v_mfma_f32_16x16x32_bf16 v[108:111], a[124:127], v[192:195], v[108:111]
    v_cvt_pk_bf16_f32 v187, v214, v215
    v_add_f32 v232, v232, v219
    v_cmp_nge_f32 vcc, s32, v232
    v_mfma_f32_16x16x32_bf16 v[176:179], a[0:3], v[144:147], v[204:207]
    ds_read_b128 a[56:59], v224 offset:17536
    v_exp_f32 v208, v168
    v_mfma_f32_16x16x32_bf16 v[180:183], a[16:19], v[144:147], v[204:207]
    s_cbranch_vccnz L_stub_115
L_back_116:
    v_exp_f32 v209, v169
    v_mfma_f32_16x16x32_bf16 v[176:179], a[4:7], v[148:151], v[176:179]
    ds_read_b128 a[44:47], v224 offset:17088
    v_add_f32 v220, v220, v232
    v_add_f32 v233, v208, v209
    v_mfma_f32_16x16x32_bf16 v[180:183], a[20:23], v[148:151], v[180:183]
    v_exp_f32 v210, v170
    v_mfma_f32_16x16x32_bf16 v[176:179], a[8:11], v[152:155], v[176:179]
    s_add_u32 m0, s28, 16896
    ds_read_b128 a[60:63], v224 offset:17600
    v_cvt_pk_bf16_f32 v188, v208, v209
    v_mfma_f32_16x16x32_bf16 v[180:183], a[24:27], v[152:155], v[180:183]
    s_waitcnt vmcnt(3)
    buffer_load_dwordx4 v229, s[4:7], s27 offen nt lds
    v_mfma_f32_16x16x32_bf16 v[176:179], a[12:15], v[156:159], v[176:179]
    ds_read_b64_tr_b16 a[96:97], v225 offset:16896
    v_exp_f32 v211, v171
    v_mfma_f32_16x16x32_bf16 v[180:183], a[28:31], v[156:159], v[180:183]
    s_waitcnt lgkmcnt(9)
    ds_read_b64_tr_b16 a[98:99], v225 offset:17408
    v_add_f32 v217, v210, v211
    v_mfma_f32_16x16x32_bf16 v[16:19], a[64:67], v[184:187], v[16:19]
    ds_read_b64_tr_b16 a[100:101], v225 offset:16928
    v_cvt_pk_bf16_f32 v189, v210, v211
    v_mfma_f32_16x16x32_bf16 v[20:23], a[68:71], v[184:187], v[20:23]
    v_exp_f32 v212, v172
    v_mfma_f32_16x16x32_bf16 v[24:27], a[72:75], v[184:187], v[24:27]
    ds_read_b64_tr_b16 a[102:103], v225 offset:17440
    v_exp_f32 v213, v173
    v_mfma_f32_16x16x32_bf16 v[28:31], a[76:79], v[184:187], v[28:31]
    ds_read_b64_tr_b16 a[104:105], v225 offset:16960
    v_add_f32 v233, v233, v217
    v_add_f32 v218, v212, v213
    v_mfma_f32_16x16x32_bf16 v[32:35], a[80:83], v[184:187], v[32:35]
    ds_read_b64_tr_b16 a[106:107], v225 offset:17472
    v_exp_f32 v214, v174
    v_mfma_f32_16x16x32_bf16 v[36:39], a[84:87], v[184:187], v[36:39]
    v_cvt_pk_bf16_f32 v190, v212, v213
    v_exp_f32 v215, v175
    v_mfma_f32_16x16x32_bf16 v[40:43], a[88:91], v[184:187], v[40:43]
    ds_read_b64_tr_b16 a[108:109], v225 offset:16992
    v_add_f32 v233, v233, v218
    v_add_f32 v219, v214, v215
    v_mfma_f32_16x16x32_bf16 v[44:47], a[92:95], v[184:187], v[44:47]
    s_waitcnt lgkmcnt(7)
    v_cvt_pk_bf16_f32 v191, v214, v215
    v_add_f32 v233, v233, v219
    v_cmp_nge_f32 vcc, s32, v233
    v_mfma_f32_16x16x32_bf16 v[160:163], a[32:35], v[112:115], v[196:199]
    s_add_u32 m0, s28, 17696
    ds_read_b64_tr_b16 a[110:111], v225 offset:17504
    v_exp_f32 v208, v176
    v_mfma_f32_16x16x32_bf16 v[164:167], a[48:51], v[112:115], v[196:199]
    s_waitcnt vmcnt(3)
    s_cbranch_vccnz L_stub_117
L_back_118:
    buffer_load_dwordx4 v229, s[4:7], s27 offen offset:256 nt lds
    v_mfma_f32_16x16x32_bf16 v[160:163], a[36:39], v[116:119], v[160:163]
    ds_read_b64_tr_b16 a[112:113], v225 offset:17024
    v_exp_f32 v209, v177
    v_mfma_f32_16x16x32_bf16 v[164:167], a[52:55], v[116:119], v[164:167]
    v_add_f32 v221, v221, v233
    v_add_f32 v234, v208, v209
    v_mfma_f32_16x16x32_bf16 v[160:163], a[40:43], v[120:123], v[160:163]
    ds_read_b64_tr_b16 a[114:115], v225 offset:17536
    v_cvt_pk_bf16_f32 v192, v208, v209
    v_mfma_f32_16x16x32_bf16 v[164:167], a[56:59], v[120:123], v[164:167]
    ds_read_b64_tr_b16 a[116:117], v225 offset:17056
    v_exp_f32 v210, v178
    v_mfma_f32_16x16x32_bf16 v[160:163], a[44:47], v[124:127], v[160:163]
    ds_read_b64_tr_b16 a[118:119], v225 offset:17568
    v_exp_f32 v211, v179
    v_mfma_f32_16x16x32_bf16 v[164:167], a[60:63], v[124:127], v[164:167]
    v_add_f32 v217, v210, v211
    v_cvt_pk_bf16_f32 v193, v210, v211
    v_mfma_f32_16x16x32_bf16 v[48:51], a[64:67], v[188:191], v[48:51]
    ds_read_b64_tr_b16 a[120:121], v225 offset:17088
    v_exp_f32 v212, v180
    v_mfma_f32_16x16x32_bf16 v[52:55], a[68:71], v[188:191], v[52:55]
    v_exp_f32 v213, v181
    v_mfma_f32_16x16x32_bf16 v[56:59], a[72:75], v[188:191], v[56:59]
    ds_read_b64_tr_b16 a[122:123], v225 offset:17600
    v_add_f32 v234, v234, v217
    v_add_f32 v218, v212, v213
    v_mfma_f32_16x16x32_bf16 v[60:63], a[76:79], v[188:191], v[60:63]
    v_cvt_pk_bf16_f32 v194, v212, v213
    v_exp_f32 v214, v182
    v_mfma_f32_16x16x32_bf16 v[64:67], a[80:83], v[188:191], v[64:67]
    s_add_u32 m0, s28, 25344
    ds_read_b64_tr_b16 a[124:125], v225 offset:17120
    v_exp_f32 v215, v183
    v_mfma_f32_16x16x32_bf16 v[68:71], a[84:87], v[188:191], v[68:71]
    s_waitcnt vmcnt(3)
    buffer_load_dwordx4 v229, s[8:11], s27 offen nt lds
    v_mfma_f32_16x16x32_bf16 v[72:75], a[88:91], v[188:191], v[72:75]
    ds_read_b64_tr_b16 a[126:127], v225 offset:17632
    v_add_f32 v234, v234, v218
    v_add_f32 v219, v214, v215
    v_mfma_f32_16x16x32_bf16 v[76:79], a[92:95], v[188:191], v[76:79]
    v_cvt_pk_bf16_f32 v195, v214, v215
    v_add_f32 v234, v234, v219
    v_cmp_nge_f32 vcc, s32, v234
    v_mfma_f32_16x16x32_bf16 v[168:171], a[32:35], v[128:131], v[200:203]
    v_exp_f32 v208, v160
    v_mfma_f32_16x16x32_bf16 v[172:175], a[48:51], v[128:131], v[200:203]
    s_cbranch_vccnz L_stub_119
L_back_120:
    v_add_u32 v224, 67584, v226
    v_add_f32 v222, v222, v234
    v_mfma_f32_16x16x32_bf16 v[168:171], a[36:39], v[132:135], v[168:171]
    v_add_u32 v225, 67584, v227
    v_exp_f32 v209, v161
    v_mfma_f32_16x16x32_bf16 v[172:175], a[52:55], v[132:135], v[172:175]
    s_waitcnt lgkmcnt(0)
    s_barrier
    v_mfma_f32_16x16x32_bf16 v[168:171], a[40:43], v[136:139], v[168:171]
    ds_read_b128 a[0:3], v224 offset:0
    v_add_f32 v232, v208, v209
    v_mfma_f32_16x16x32_bf16 v[172:175], a[56:59], v[136:139], v[172:175]
    v_exp_f32 v210, v162
    v_mfma_f32_16x16x32_bf16 v[168:171], a[44:47], v[140:143], v[168:171]
    ds_read_b128 a[16:19], v224 offset:512
    v_exp_f32 v211, v163
    v_mfma_f32_16x16x32_bf16 v[172:175], a[60:63], v[140:143], v[172:175]
    v_cvt_pk_bf16_f32 v184, v208, v209
    v_add_f32 v217, v210, v211
    v_mfma_f32_16x16x32_bf16 v[80:83], a[64:67], v[192:195], v[80:83]
    s_add_u32 m0, s28, 26144
    ds_read_b128 a[4:7], v224 offset:64
    v_exp_f32 v212, v164
    v_mfma_f32_16x16x32_bf16 v[84:87], a[68:71], v[192:195], v[84:87]
    s_waitcnt vmcnt(3)
    buffer_load_dwordx4 v229, s[8:11], s27 offen offset:256 nt lds
    v_mfma_f32_16x16x32_bf16 v[88:91], a[72:75], v[192:195], v[88:91]
    ds_read_b128 a[20:23], v224 offset:576
    v_exp_f32 v213, v165
    v_mfma_f32_16x16x32_bf16 v[92:95], a[76:79], v[192:195], v[92:95]
    v_cvt_pk_bf16_f32 v185, v210, v211
    v_add_f32 v232, v232, v217
    v_add_f32 v218, v212, v213
    v_mfma_f32_16x16x32_bf16 v[96:99], a[80:83], v[192:195], v[96:99]
    ds_read_b128 a[8:11], v224 offset:128
    v_exp_f32 v214, v166
    v_mfma_f32_16x16x32_bf16 v[100:103], a[84:87], v[192:195], v[100:103]
    v_cvt_pk_bf16_f32 v186, v212, v213
    v_exp_f32 v215, v167
    v_mfma_f32_16x16x32_bf16 v[104:107], a[88:91], v[192:195], v[104:107]
    ds_read_b128 a[24:27], v224 offset:640
    v_add_f32 v232, v232, v218
    v_add_f32 v219, v214, v215
    v_mfma_f32_16x16x32_bf16 v[108:111], a[92:95], v[192:195], v[108:111]
    v_cvt_pk_bf16_f32 v187, v214, v215
    v_add_f32 v232, v232, v219
    v_cmp_nge_f32 vcc, s32, v232
    v_mfma_f32_16x16x32_bf16 v[176:179], a[32:35], v[144:147], v[204:207]
    ds_read_b128 a[12:15], v224 offset:192
    v_exp_f32 v208, v168
    v_mfma_f32_16x16x32_bf16 v[180:183], a[48:51], v[144:147], v[204:207]
    s_cbranch_vccnz L_stub_121
L_back_122:
    v_add_f32 v220, v220, v232
    v_mfma_f32_16x16x32_bf16 v[176:179], a[36:39], v[148:151], v[176:179]
    ds_read_b128 a[28:31], v224 offset:704
    v_exp_f32 v209, v169
    v_mfma_f32_16x16x32_bf16 v[180:183], a[52:55], v[148:151], v[180:183]
    s_mov_b32 s27, 212992
    v_exp_f32 v210, v170
    v_mfma_f32_16x16x32_bf16 v[176:179], a[40:43], v[152:155], v[176:179]
    s_add_u32 m0, s28, 33792
    ds_read_b64_tr_b16 a[64:65], v225 offset:0
    v_add_f32 v233, v208, v209
    v_mfma_f32_16x16x32_bf16 v[180:183], a[56:59], v[152:155], v[180:183]
    s_waitcnt vmcnt(3)
    buffer_load_dwordx4 v228, s[4:7], s27 offen nt lds
    v_mfma_f32_16x16x32_bf16 v[176:179], a[44:47], v[156:159], v[176:179]
    ds_read_b64_tr_b16 a[66:67], v225 offset:512
    v_cvt_pk_bf16_f32 v188, v208, v209
    v_mfma_f32_16x16x32_bf16 v[180:183], a[60:63], v[156:159], v[180:183]
    v_exp_f32 v211, v171
    v_mfma_f32_16x16x32_bf16 v[16:19], a[96:99], v[184:187], v[16:19]
    ds_read_b64_tr_b16 a[68:69], v225 offset:32
    v_add_f32 v217, v210, v211
    v_mfma_f32_16x16x32_bf16 v[20:23], a[100:103], v[184:187], v[20:23]
    v_cvt_pk_bf16_f32 v189, v210, v211
    v_add_f32 v233, v233, v217
    v_mfma_f32_16x16x32_bf16 v[24:27], a[104:107], v[184:187], v[24:27]
    ds_read_b64_tr_b16 a[70:71], v225 offset:544
    v_exp_f32 v212, v172
    v_mfma_f32_16x16x32_bf16 v[28:31], a[108:111], v[184:187], v[28:31]
    v_exp_f32 v213, v173
    v_mfma_f32_16x16x32_bf16 v[32:35], a[112:115], v[184:187], v[32:35]
    ds_read_b64_tr_b16 a[72:73], v225 offset:64
    v_exp_f32 v214, v174
    v_mfma_f32_16x16x32_bf16 v[36:39], a[116:119], v[184:187], v[36:39]
    v_add_f32 v218, v212, v213
    v_exp_f32 v215, v175
    v_mfma_f32_16x16x32_bf16 v[40:43], a[120:123], v[184:187], v[40:43]
    v_cvt_pk_bf16_f32 v190, v212, v213
    v_add_f32 v233, v233, v218
    v_add_f32 v219, v214, v215
    v_mfma_f32_16x16x32_bf16 v[44:47], a[124:127], v[184:187], v[44:47]
    s_waitcnt lgkmcnt(5)
    v_cvt_pk_bf16_f32 v191, v214, v215
    v_add_f32 v233, v233, v219
    v_cmp_nge_f32 vcc, s32, v233
    v_mfma_f32_16x16x32_bf16 v[160:163], a[0:3], v[112:115], v[196:199]
    s_add_u32 m0, s28, 34592
    ds_read_b64_tr_b16 a[74:75], v225 offset:576
    v_exp_f32 v208, v176
    v_mfma_f32_16x16x32_bf16 v[164:167], a[16:19], v[112:115], v[196:199]
    s_waitcnt vmcnt(3)
    s_cbranch_vccnz L_stub_123
L_back_124:
    buffer_load_dwordx4 v228, s[4:7], s27 offen offset:256 nt lds
    v_mfma_f32_16x16x32_bf16 v[160:163], a[4:7], v[116:119], v[160:163]
    ds_read_b64_tr_b16 a[76:77], v225 offset:96
    v_exp_f32 v209, v177
    v_mfma_f32_16x16x32_bf16 v[164:167], a[20:23], v[116:119], v[164:167]
    v_add_f32 v221, v221, v233
    v_add_f32 v234, v208, v209
    v_mfma_f32_16x16x32_bf16 v[160:163], a[8:11], v[120:123], v[160:163]
    ds_read_b64_tr_b16 a[78:79], v225 offset:608
    v_cvt_pk_bf16_f32 v192, v208, v209
    v_mfma_f32_16x16x32_bf16 v[164:167], a[24:27], v[120:123], v[164:167]
    v_exp_f32 v210, v178
    v_mfma_f32_16x16x32_bf16 v[160:163], a[12:15], v[124:127], v[160:163]
    ds_read_b64_tr_b16 a[80:81], v225 offset:128
    v_exp_f32 v211, v179
    v_mfma_f32_16x16x32_bf16 v[164:167], a[28:31], v[124:127], v[164:167]
    v_add_f32 v217, v210, v211
    v_cvt_pk_bf16_f32 v193, v210, v211
    v_mfma_f32_16x16x32_bf16 v[48:51], a[96:99], v[188:191], v[48:51]
    ds_read_b64_tr_b16 a[82:83], v225 offset:640
    v_exp_f32 v212, v180
    v_mfma_f32_16x16x32_bf16 v[52:55], a[100:103], v[188:191], v[52:55]
    v_exp_f32 v213, v181
    v_mfma_f32_16x16x32_bf16 v[56:59], a[104:107], v[188:191], v[56:59]
    ds_read_b64_tr_b16 a[84:85], v225 offset:160
    v_add_f32 v234, v234, v217
    v_add_f32 v218, v212, v213
    v_mfma_f32_16x16x32_bf16 v[60:63], a[108:111], v[188:191], v[60:63]
    v_cvt_pk_bf16_f32 v194, v212, v213
    v_exp_f32 v214, v182
    v_mfma_f32_16x16x32_bf16 v[64:67], a[112:115], v[188:191], v[64:67]
    s_add_u32 m0, s28, 42240
    ds_read_b64_tr_b16 a[86:87], v225 offset:672
    v_exp_f32 v215, v183
    v_mfma_f32_16x16x32_bf16 v[68:71], a[116:119], v[188:191], v[68:71]
    s_waitcnt vmcnt(3)
    buffer_load_dwordx4 v228, s[8:11], s27 offen nt lds
    v_mfma_f32_16x16x32_bf16 v[72:75], a[120:123], v[188:191], v[72:75]
    ds_read_b64_tr_b16 a[88:89], v225 offset:192
    v_add_f32 v234, v234, v218
    v_add_f32 v219, v214, v215
    v_mfma_f32_16x16x32_bf16 v[76:79], a[124:127], v[188:191], v[76:79]
    v_cvt_pk_bf16_f32 v195, v214, v215
    v_add_f32 v234, v234, v219
    v_cmp_nge_f32 vcc, s32, v234
    v_mfma_f32_16x16x32_bf16 v[168:171], a[0:3], v[128:131], v[200:203]
    ds_read_b64_tr_b16 a[90:91], v225 offset:704
    v_exp_f32 v208, v160
    v_mfma_f32_16x16x32_bf16 v[172:175], a[16:19], v[128:131], v[200:203]
    s_cbranch_vccnz L_stub_125
L_back_126:
    v_add_f32 v222, v222, v234
    v_mfma_f32_16x16x32_bf16 v[168:171], a[4:7], v[132:135], v[168:171]
    ds_read_b64_tr_b16 a[92:93], v225 offset:224
    v_exp_f32 v209, v161
    v_mfma_f32_16x16x32_bf16 v[172:175], a[20:23], v[132:135], v[172:175]
    v_add_f32 v232, v208, v209
    v_cvt_pk_bf16_f32 v184, v208, v209
    v_mfma_f32_16x16x32_bf16 v[168:171], a[8:11], v[136:139], v[168:171]
    ds_read_b64_tr_b16 a[94:95], v225 offset:736
    v_exp_f32 v210, v162
    v_mfma_f32_16x16x32_bf16 v[172:175], a[24:27], v[136:139], v[172:175]
    v_exp_f32 v211, v163
    v_mfma_f32_16x16x32_bf16 v[168:171], a[12:15], v[140:143], v[168:171]
    ds_read_b128 a[32:35], v224 offset:16896
    v_add_f32 v217, v210, v211
    v_mfma_f32_16x16x32_bf16 v[172:175], a[28:31], v[140:143], v[172:175]
    v_exp_f32 v212, v164
    v_mfma_f32_16x16x32_bf16 v[80:83], a[96:99], v[192:195], v[80:83]
    s_add_u32 m0, s28, 43040
    ds_read_b128 a[48:51], v224 offset:17408
    v_cvt_pk_bf16_f32 v185, v210, v211
    v_mfma_f32_16x16x32_bf16 v[84:87], a[100:103], v[192:195], v[84:87]
    s_waitcnt vmcnt(3)
    buffer_load_dwordx4 v228, s[8:11], s27 offen offset:256 nt lds
    v_mfma_f32_16x16x32_bf16 v[88:91], a[104:107], v[192:195], v[88:91]
    ds_read_b128 a[36:39], v224 offset:16960
    v_exp_f32 v213, v165
    v_mfma_f32_16x16x32_bf16 v[92:95], a[108:111], v[192:195], v[92:95]
    v_add_f32 v232, v232, v217
    v_add_f32 v218, v212, v213
    v_mfma_f32_16x16x32_bf16 v[96:99], a[112:115], v[192:195], v[96:99]
    ds_read_b128 a[52:55], v224 offset:17472
    v_exp_f32 v214, v166
    v_mfma_f32_16x16x32_bf16 v[100:103], a[116:119], v[192:195], v[100:103]
    v_cvt_pk_bf16_f32 v186, v212, v213
    v_exp_f32 v215, v167
    v_mfma_f32_16x16x32_bf16 v[104:107], a[120:123], v[192:195], v[104:107]
    ds_read_b128 a[40:43], v224 offset:17024
    v_add_f32 v232, v232, v218
    v_add_f32 v219, v214, v215
    v_mfma_f32_16x16x32_bf16 v[108:111], a[124:127], v[192:195], v[108:111]
    v_cvt_pk_bf16_f32 v187, v214, v215
    v_add_f32 v232, v232, v219
    v_cmp_nge_f32 vcc, s32, v232
    v_mfma_f32_16x16x32_bf16 v[176:179], a[0:3], v[144:147], v[204:207]
    ds_read_b128 a[56:59], v224 offset:17536
    v_exp_f32 v208, v168
    v_mfma_f32_16x16x32_bf16 v[180:183], a[16:19], v[144:147], v[204:207]
    s_cbranch_vccnz L_stub_127
L_back_128:
    v_exp_f32 v209, v169
    v_mfma_f32_16x16x32_bf16 v[176:179], a[4:7], v[148:151], v[176:179]
    ds_read_b128 a[44:47], v224 offset:17088
    v_add_f32 v220, v220, v232
    v_add_f32 v233, v208, v209
    v_mfma_f32_16x16x32_bf16 v[180:183], a[20:23], v[148:151], v[180:183]
    v_exp_f32 v210, v170
    v_mfma_f32_16x16x32_bf16 v[176:179], a[8:11], v[152:155], v[176:179]
    s_add_u32 m0, s28, 50688
    ds_read_b128 a[60:63], v224 offset:17600
    v_cvt_pk_bf16_f32 v188, v208, v209
    v_mfma_f32_16x16x32_bf16 v[180:183], a[24:27], v[152:155], v[180:183]
    s_waitcnt vmcnt(3)
    buffer_load_dwordx4 v229, s[4:7], s27 offen nt lds
    v_mfma_f32_16x16x32_bf16 v[176:179], a[12:15], v[156:159], v[176:179]
    ds_read_b64_tr_b16 a[96:97], v225 offset:16896
    v_exp_f32 v211, v171
    v_mfma_f32_16x16x32_bf16 v[180:183], a[28:31], v[156:159], v[180:183]
    s_waitcnt lgkmcnt(9)
    ds_read_b64_tr_b16 a[98:99], v225 offset:17408
    v_add_f32 v217, v210, v211
    v_mfma_f32_16x16x32_bf16 v[16:19], a[64:67], v[184:187], v[16:19]
    ds_read_b64_tr_b16 a[100:101], v225 offset:16928
    v_cvt_pk_bf16_f32 v189, v210, v211
    v_mfma_f32_16x16x32_bf16 v[20:23], a[68:71], v[184:187], v[20:23]
    v_exp_f32 v212, v172
    v_mfma_f32_16x16x32_bf16 v[24:27], a[72:75], v[184:187], v[24:27]
    ds_read_b64_tr_b16 a[102:103], v225 offset:17440
    v_exp_f32 v213, v173
    v_mfma_f32_16x16x32_bf16 v[28:31], a[76:79], v[184:187], v[28:31]
    ds_read_b64_tr_b16 a[104:105], v225 offset:16960
    v_add_f32 v233, v233, v217
    v_add_f32 v218, v212, v213
    v_mfma_f32_16x16x32_bf16 v[32:35], a[80:83], v[184:187], v[32:35]
    ds_read_b64_tr_b16 a[106:107], v225 offset:17472
    v_exp_f32 v214, v174
    v_mfma_f32_16x16x32_bf16 v[36:39], a[84:87], v[184:187], v[36:39]
    v_cvt_pk_bf16_f32 v190, v212, v213
    v_exp_f32 v215, v175
    v_mfma_f32_16x16x32_bf16 v[40:43], a[88:91], v[184:187], v[40:43]
    ds_read_b64_tr_b16 a[108:109], v225 offset:16992
    v_add_f32 v233, v233, v218
    v_add_f32 v219, v214, v215
    v_mfma_f32_16x16x32_bf16 v[44:47], a[92:95], v[184:187], v[44:47]
    s_waitcnt lgkmcnt(7)
    v_cvt_pk_bf16_f32 v191, v214, v215
    v_add_f32 v233, v233, v219
    v_cmp_nge_f32 vcc, s32, v233
    v_mfma_f32_16x16x32_bf16 v[160:163], a[32:35], v[112:115], v[196:199]
    s_add_u32 m0, s28, 51488
    ds_read_b64_tr_b16 a[110:111], v225 offset:17504
    v_exp_f32 v208, v176
    v_mfma_f32_16x16x32_bf16 v[164:167], a[48:51], v[112:115], v[196:199]
    s_waitcnt vmcnt(3)
    s_cbranch_vccnz L_stub_129
L_back_130:
    buffer_load_dwordx4 v229, s[4:7], s27 offen offset:256 nt lds
    v_mfma_f32_16x16x32_bf16 v[160:163], a[36:39], v[116:119], v[160:163]
    ds_read_b64_tr_b16 a[112:113], v225 offset:17024
    v_exp_f32 v209, v177
    v_mfma_f32_16x16x32_bf16 v[164:167], a[52:55], v[116:119], v[164:167]
    v_add_f32 v221, v221, v233
    v_add_f32 v234, v208, v209
    v_mfma_f32_16x16x32_bf16 v[160:163], a[40:43], v[120:123], v[160:163]
    ds_read_b64_tr_b16 a[114:115], v225 offset:17536
    v_cvt_pk_bf16_f32 v192, v208, v209
    v_mfma_f32_16x16x32_bf16 v[164:167], a[56:59], v[120:123], v[164:167]
    ds_read_b64_tr_b16 a[116:117], v225 offset:17056
    v_exp_f32 v210, v178
    v_mfma_f32_16x16x32_bf16 v[160:163], a[44:47], v[124:127], v[160:163]
    ds_read_b64_tr_b16 a[118:119], v225 offset:17568
    v_exp_f32 v211, v179
    v_mfma_f32_16x16x32_bf16 v[164:167], a[60:63], v[124:127], v[164:167]
    v_add_f32 v217, v210, v211
    v_cvt_pk_bf16_f32 v193, v210, v211
    v_mfma_f32_16x16x32_bf16 v[48:51], a[64:67], v[188:191], v[48:51]
    ds_read_b64_tr_b16 a[120:121], v225 offset:17088
    v_exp_f32 v212, v180
    v_mfma_f32_16x16x32_bf16 v[52:55], a[68:71], v[188:191], v[52:55]
    v_exp_f32 v213, v181
    v_mfma_f32_16x16x32_bf16 v[56:59], a[72:75], v[188:191], v[56:59]
    ds_read_b64_tr_b16 a[122:123], v225 offset:17600
    v_add_f32 v234, v234, v217
    v_add_f32 v218, v212, v213
    v_mfma_f32_16x16x32_bf16 v[60:63], a[76:79], v[188:191], v[60:63]
    v_cvt_pk_bf16_f32 v194, v212, v213
    v_exp_f32 v214, v182
    v_mfma_f32_16x16x32_bf16 v[64:67], a[80:83], v[188:191], v[64:67]
    s_add_u32 m0, s28, 59136
    ds_read_b64_tr_b16 a[124:125], v225 offset:17120
    v_exp_f32 v215, v183
    v_mfma_f32_16x16x32_bf16 v[68:71], a[84:87], v[188:191], v[68:71]
    s_waitcnt vmcnt(3)
    buffer_load_dwordx4 v229, s[8:11], s27 offen nt lds
    v_mfma_f32_16x16x32_bf16 v[72:75], a[88:91], v[188:191], v[72:75]
    ds_read_b64_tr_b16 a[126:127], v225 offset:17632
    v_add_f32 v234, v234, v218
    v_add_f32 v219, v214, v215
    v_mfma_f32_16x16x32_bf16 v[76:79], a[92:95], v[188:191], v[76:79]
    v_cvt_pk_bf16_f32 v195, v214, v215
    v_add_f32 v234, v234, v219
    v_cmp_nge_f32 vcc, s32, v234
    v_mfma_f32_16x16x32_bf16 v[168:171], a[32:35], v[128:131], v[200:203]
    v_exp_f32 v208, v160
    v_mfma_f32_16x16x32_bf16 v[172:175], a[48:51], v[128:131], v[200:203]
    s_cbranch_vccnz L_stub_131
L_back_132:
    v_add_u32 v224, 0, v226
    v_add_f32 v222, v222, v234
    v_mfma_f32_16x16x32_bf16 v[168:171], a[36:39], v[132:135], v[168:171]
    v_add_u32 v225, 0, v227
    v_exp_f32 v209, v161
    v_mfma_f32_16x16x32_bf16 v[172:175], a[52:55], v[132:135], v[172:175]
    s_waitcnt lgkmcnt(0)
    s_barrier
    v_mfma_f32_16x16x32_bf16 v[168:171], a[40:43], v[136:139], v[168:171]
    ds_read_b128 a[0:3], v224 offset:0
    v_add_f32 v232, v208, v209
    v_mfma_f32_16x16x32_bf16 v[172:175], a[56:59], v[136:139], v[172:175]
    v_exp_f32 v210, v162
    v_mfma_f32_16x16x32_bf16 v[168:171], a[44:47], v[140:143], v[168:171]
    ds_read_b128 a[16:19], v224 offset:512
    v_exp_f32 v211, v163
    v_mfma_f32_16x16x32_bf16 v[172:175], a[60:63], v[140:143], v[172:175]
    v_cvt_pk_bf16_f32 v184, v208, v209
    v_add_f32 v217, v210, v211
    v_mfma_f32_16x16x32_bf16 v[80:83], a[64:67], v[192:195], v[80:83]
    s_add_u32 m0, s28, 59936
    ds_read_b128 a[4:7], v224 offset:64
    v_exp_f32 v212, v164
    v_mfma_f32_16x16x32_bf16 v[84:87], a[68:71], v[192:195], v[84:87]
    s_waitcnt vmcnt(3)
    buffer_load_dwordx4 v229, s[8:11], s27 offen offset:256 nt lds
    v_mfma_f32_16x16x32_bf16 v[88:91], a[72:75], v[192:195], v[88:91]
    ds_read_b128 a[20:23], v224 offset:576
    v_exp_f32 v213, v165
    v_mfma_f32_16x16x32_bf16 v[92:95], a[76:79], v[192:195], v[92:95]
    v_cvt_pk_bf16_f32 v185, v210, v211
    v_add_f32 v232, v232, v217
    v_add_f32 v218, v212, v213
    v_mfma_f32_16x16x32_bf16 v[96:99], a[80:83], v[192:195], v[96:99]
    ds_read_b128 a[8:11], v224 offset:128
    v_exp_f32 v214, v166
    v_mfma_f32_16x16x32_bf16 v[100:103], a[84:87], v[192:195], v[100:103]
    v_cvt_pk_bf16_f32 v186, v212, v213
    v_exp_f32 v215, v167
    v_mfma_f32_16x16x32_bf16 v[104:107], a[88:91], v[192:195], v[104:107]
    ds_read_b128 a[24:27], v224 offset:640
    v_add_f32 v232, v232, v218
    v_add_f32 v219, v214, v215
    v_mfma_f32_16x16x32_bf16 v[108:111], a[92:95], v[192:195], v[108:111]
    v_cvt_pk_bf16_f32 v187, v214, v215
    v_add_f32 v232, v232, v219
    v_cmp_nge_f32 vcc, s32, v232
    v_mfma_f32_16x16x32_bf16 v[176:179], a[32:35], v[144:147], v[204:207]
    ds_read_b128 a[12:15], v224 offset:192
    v_exp_f32 v208, v168
    v_mfma_f32_16x16x32_bf16 v[180:183], a[48:51], v[144:147], v[204:207]
    s_cbranch_vccnz L_stub_133
L_back_134:
    v_add_f32 v220, v220, v232
    v_mfma_f32_16x16x32_bf16 v[176:179], a[36:39], v[148:151], v[176:179]
    ds_read_b128 a[28:31], v224 offset:704
    v_exp_f32 v209, v169
    v_mfma_f32_16x16x32_bf16 v[180:183], a[52:55], v[148:151], v[180:183]
    s_mov_b32 s27, 229376
    v_exp_f32 v210, v170
    v_mfma_f32_16x16x32_bf16 v[176:179], a[40:43], v[152:155], v[176:179]
    s_add_u32 m0, s28, 67584
    ds_read_b64_tr_b16 a[64:65], v225 offset:0
    v_add_f32 v233, v208, v209
    v_mfma_f32_16x16x32_bf16 v[180:183], a[56:59], v[152:155], v[180:183]
    s_waitcnt vmcnt(3)
    buffer_load_dwordx4 v228, s[4:7], s27 offen nt lds
    v_mfma_f32_16x16x32_bf16 v[176:179], a[44:47], v[156:159], v[176:179]
    ds_read_b64_tr_b16 a[66:67], v225 offset:512
    v_cvt_pk_bf16_f32 v188, v208, v209
    v_mfma_f32_16x16x32_bf16 v[180:183], a[60:63], v[156:159], v[180:183]
    v_exp_f32 v211, v171
    v_mfma_f32_16x16x32_bf16 v[16:19], a[96:99], v[184:187], v[16:19]
    ds_read_b64_tr_b16 a[68:69], v225 offset:32
    v_add_f32 v217, v210, v211
    v_mfma_f32_16x16x32_bf16 v[20:23], a[100:103], v[184:187], v[20:23]
    v_cvt_pk_bf16_f32 v189, v210, v211
    v_add_f32 v233, v233, v217
    v_mfma_f32_16x16x32_bf16 v[24:27], a[104:107], v[184:187], v[24:27]
    ds_read_b64_tr_b16 a[70:71], v225 offset:544
    v_exp_f32 v212, v172
    v_mfma_f32_16x16x32_bf16 v[28:31], a[108:111], v[184:187], v[28:31]
    v_exp_f32 v213, v173
    v_mfma_f32_16x16x32_bf16 v[32:35], a[112:115], v[184:187], v[32:35]
    ds_read_b64_tr_b16 a[72:73], v225 offset:64
    v_exp_f32 v214, v174
    v_mfma_f32_16x16x32_bf16 v[36:39], a[116:119], v[184:187], v[36:39]
    v_add_f32 v218, v212, v213
    v_exp_f32 v215, v175
    v_mfma_f32_16x16x32_bf16 v[40:43], a[120:123], v[184:187], v[40:43]
    v_cvt_pk_bf16_f32 v190, v212, v213
    v_add_f32 v233, v233, v218
    v_add_f32 v219, v214, v215
    v_mfma_f32_16x16x32_bf16 v[44:47], a[124:127], v[184:187], v[44:47]
    s_waitcnt lgkmcnt(5)
    v_cvt_pk_bf16_f32 v191, v214, v215
    v_add_f32 v233, v233, v219
    v_cmp_nge_f32 vcc, s32, v233
    v_mfma_f32_16x16x32_bf16 v[160:163], a[0:3], v[112:115], v[196:199]
    s_add_u32 m0, s28, 68384
    ds_read_b64_tr_b16 a[74:75], v225 offset:576
    v_exp_f32 v208, v176
    v_mfma_f32_16x16x32_bf16 v[164:167], a[16:19], v[112:115], v[196:199]
    s_waitcnt vmcnt(3)
    s_cbranch_vccnz L_stub_135
L_back_136:
    buffer_load_dwordx4 v228, s[4:7], s27 offen offset:256 nt lds
    v_mfma_f32_16x16x32_bf16 v[160:163], a[4:7], v[116:119], v[160:163]
    ds_read_b64_tr_b16 a[76:77], v225 offset:96
    v_exp_f32 v209, v177
    v_mfma_f32_16x16x32_bf16 v[164:167], a[20:23], v[116:119], v[164:167]
    v_add_f32 v221, v221, v233
    v_add_f32 v234, v208, v209
    v_mfma_f32_16x16x32_bf16 v[160:163], a[8:11], v[120:123], v[160:163]
    ds_read_b64_tr_b16 a[78:79], v225 offset:608
    v_cvt_pk_bf16_f32 v192, v208, v209
    v_mfma_f32_16x16x32_bf16 v[164:167], a[24:27], v[120:123], v[164:167]
    v_exp_f32 v210, v178
    v_mfma_f32_16x16x32_bf16 v[160:163], a[12:15], v[124:127], v[160:163]
    ds_read_b64_tr_b16 a[80:81], v225 offset:128
    v_exp_f32 v211, v179
    v_mfma_f32_16x16x32_bf16 v[164:167], a[28:31], v[124:127], v[164:167]
    v_add_f32 v217, v210, v211
    v_cvt_pk_bf16_f32 v193, v210, v211
    v_mfma_f32_16x16x32_bf16 v[48:51], a[96:99], v[188:191], v[48:51]
    ds_read_b64_tr_b16 a[82:83], v225 offset:640
    v_exp_f32 v212, v180
    v_mfma_f32_16x16x32_bf16 v[52:55], a[100:103], v[188:191], v[52:55]
    v_exp_f32 v213, v181
    v_mfma_f32_16x16x32_bf16 v[56:59], a[104:107], v[188:191], v[56:59]
    ds_read_b64_tr_b16 a[84:85], v225 offset:160
    v_add_f32 v234, v234, v217
    v_add_f32 v218, v212, v213
    v_mfma_f32_16x16x32_bf16 v[60:63], a[108:111], v[188:191], v[60:63]
    v_cvt_pk_bf16_f32 v194, v212, v213
    v_exp_f32 v214, v182
    v_mfma_f32_16x16x32_bf16 v[64:67], a[112:115], v[188:191], v[64:67]
    s_add_u32 m0, s28, 76032
    ds_read_b64_tr_b16 a[86:87], v225 offset:672
    v_exp_f32 v215, v183
    v_mfma_f32_16x16x32_bf16 v[68:71], a[116:119], v[188:191], v[68:71]
    s_waitcnt vmcnt(3)
    buffer_load_dwordx4 v228, s[8:11], s27 offen nt lds
    v_mfma_f32_16x16x32_bf16 v[72:75], a[120:123], v[188:191], v[72:75]
    ds_read_b64_tr_b16 a[88:89], v225 offset:192
    v_add_f32 v234, v234, v218
    v_add_f32 v219, v214, v215
    v_mfma_f32_16x16x32_bf16 v[76:79], a[124:127], v[188:191], v[76:79]
    v_cvt_pk_bf16_f32 v195, v214, v215
    v_add_f32 v234, v234, v219
    v_cmp_nge_f32 vcc, s32, v234
    v_mfma_f32_16x16x32_bf16 v[168:171], a[0:3], v[128:131], v[200:203]
    ds_read_b64_tr_b16 a[90:91], v225 offset:704
    v_exp_f32 v208, v160
    v_mfma_f32_16x16x32_bf16 v[172:175], a[16:19], v[128:131], v[200:203]
    s_cbranch_vccnz L_stub_137
L_back_138:
    v_add_f32 v222, v222, v234
    v_mfma_f32_16x16x32_bf16 v[168:171], a[4:7], v[132:135], v[168:171]
    ds_read_b64_tr_b16 a[92:93], v225 offset:224
    v_exp_f32 v209, v161
    v_mfma_f32_16x16x32_bf16 v[172:175], a[20:23], v[132:135], v[172:175]
    v_add_f32 v232, v208, v209
    v_cvt_pk_bf16_f32 v184, v208, v209
    v_mfma_f32_16x16x32_bf16 v[168:171], a[8:11], v[136:139], v[168:171]
    ds_read_b64_tr_b16 a[94:95], v225 offset:736
    v_exp_f32 v210, v162
    v_mfma_f32_16x16x32_bf16 v[172:175], a[24:27], v[136:139], v[172:175]
    v_exp_f32 v211, v163
    v_mfma_f32_16x16x32_bf16 v[168:171], a[12:15], v[140:143], v[168:171]
    ds_read_b128 a[32:35], v224 offset:16896
    v_add_f32 v217, v210, v211
    v_mfma_f32_16x16x32_bf16 v[172:175], a[28:31], v[140:143], v[172:175]
    v_exp_f32 v212, v164
    v_mfma_f32_16x16x32_bf16 v[80:83], a[96:99], v[192:195], v[80:83]
    s_add_u32 m0, s28, 76832
    ds_read_b128 a[48:51], v224 offset:17408
    v_cvt_pk_bf16_f32 v185, v210, v211
    v_mfma_f32_16x16x32_bf16 v[84:87], a[100:103], v[192:195], v[84:87]
    s_waitcnt vmcnt(3)
    buffer_load_dwordx4 v228, s[8:11], s27 offen offset:256 nt lds
    v_mfma_f32_16x16x32_bf16 v[88:91], a[104:107], v[192:195], v[88:91]
    ds_read_b128 a[36:39], v224 offset:16960
    v_exp_f32 v213, v165
    v_mfma_f32_16x16x32_bf16 v[92:95], a[108:111], v[192:195], v[92:95]
    v_add_f32 v232, v232, v217
    v_add_f32 v218, v212, v213
    v_mfma_f32_16x16x32_bf16 v[96:99], a[112:115], v[192:195], v[96:99]
    ds_read_b128 a[52:55], v224 offset:17472
    v_exp_f32 v214, v166
    v_mfma_f32_16x16x32_bf16 v[100:103], a[116:119], v[192:195], v[100:103]
    v_cvt_pk_bf16_f32 v186, v212, v213
    v_exp_f32 v215, v167
    v_mfma_f32_16x16x32_bf16 v[104:107], a[120:123], v[192:195], v[104:107]
    ds_read_b128 a[40:43], v224 offset:17024
    v_add_f32 v232, v232, v218
    v_add_f32 v219, v214, v215
    v_mfma_f32_16x16x32_bf16 v[108:111], a[124:127], v[192:195], v[108:111]
    v_cvt_pk_bf16_f32 v187, v214, v215
    v_add_f32 v232, v232, v219
    v_cmp_nge_f32 vcc, s32, v232
    v_mfma_f32_16x16x32_bf16 v[176:179], a[0:3], v[144:147], v[204:207]
    ds_read_b128 a[56:59], v224 offset:17536
    v_exp_f32 v208, v168
    v_mfma_f32_16x16x32_bf16 v[180:183], a[16:19], v[144:147], v[204:207]
    s_cbranch_vccnz L_stub_139
L_back_140:
    v_exp_f32 v209, v169
    v_mfma_f32_16x16x32_bf16 v[176:179], a[4:7], v[148:151], v[176:179]
    ds_read_b128 a[44:47], v224 offset:17088
    v_add_f32 v220, v220, v232
    v_add_f32 v233, v208, v209
    v_mfma_f32_16x16x32_bf16 v[180:183], a[20:23], v[148:151], v[180:183]
    v_exp_f32 v210, v170
    v_mfma_f32_16x16x32_bf16 v[176:179], a[8:11], v[152:155], v[176:179]
    s_add_u32 m0, s28, 84480
    ds_read_b128 a[60:63], v224 offset:17600
    v_cvt_pk_bf16_f32 v188, v208, v209
    v_mfma_f32_16x16x32_bf16 v[180:183], a[24:27], v[152:155], v[180:183]
    s_waitcnt vmcnt(3)
    buffer_load_dwordx4 v229, s[4:7], s27 offen nt lds
    v_mfma_f32_16x16x32_bf16 v[176:179], a[12:15], v[156:159], v[176:179]
    ds_read_b64_tr_b16 a[96:97], v225 offset:16896
    v_exp_f32 v211, v171
    v_mfma_f32_16x16x32_bf16 v[180:183], a[28:31], v[156:159], v[180:183]
    s_waitcnt lgkmcnt(9)
    ds_read_b64_tr_b16 a[98:99], v225 offset:17408
    v_add_f32 v217, v210, v211
    v_mfma_f32_16x16x32_bf16 v[16:19], a[64:67], v[184:187], v[16:19]
    ds_read_b64_tr_b16 a[100:101], v225 offset:16928
    v_cvt_pk_bf16_f32 v189, v210, v211
    v_mfma_f32_16x16x32_bf16 v[20:23], a[68:71], v[184:187], v[20:23]
    v_exp_f32 v212, v172
    v_mfma_f32_16x16x32_bf16 v[24:27], a[72:75], v[184:187], v[24:27]
    ds_read_b64_tr_b16 a[102:103], v225 offset:17440
    v_exp_f32 v213, v173
    v_mfma_f32_16x16x32_bf16 v[28:31], a[76:79], v[184:187], v[28:31]
    ds_read_b64_tr_b16 a[104:105], v225 offset:16960
    v_add_f32 v233, v233, v217
    v_add_f32 v218, v212, v213
    v_mfma_f32_16x16x32_bf16 v[32:35], a[80:83], v[184:187], v[32:35]
    ds_read_b64_tr_b16 a[106:107], v225 offset:17472
    v_exp_f32 v214, v174
    v_mfma_f32_16x16x32_bf16 v[36:39], a[84:87], v[184:187], v[36:39]
    v_cvt_pk_bf16_f32 v190, v212, v213
    v_exp_f32 v215, v175
    v_mfma_f32_16x16x32_bf16 v[40:43], a[88:91], v[184:187], v[40:43]
    ds_read_b64_tr_b16 a[108:109], v225 offset:16992
    v_add_f32 v233, v233, v218
    v_add_f32 v219, v214, v215
    v_mfma_f32_16x16x32_bf16 v[44:47], a[92:95], v[184:187], v[44:47]
    s_waitcnt lgkmcnt(7)
    v_cvt_pk_bf16_f32 v191, v214, v215
    v_add_f32 v233, v233, v219
    v_cmp_nge_f32 vcc, s32, v233
    v_mfma_f32_16x16x32_bf16 v[160:163], a[32:35], v[112:115], v[196:199]
    s_add_u32 m0, s28, 85280
    ds_read_b64_tr_b16 a[110:111], v225 offset:17504
    v_exp_f32 v208, v176
    v_mfma_f32_16x16x32_bf16 v[164:167], a[48:51], v[112:115], v[196:199]
    s_waitcnt vmcnt(3)
    s_cbranch_vccnz L_stub_141
L_back_142:
    buffer_load_dwordx4 v229, s[4:7], s27 offen offset:256 nt lds
    v_mfma_f32_16x16x32_bf16 v[160:163], a[36:39], v[116:119], v[160:163]
    ds_read_b64_tr_b16 a[112:113], v225 offset:17024
    v_exp_f32 v209, v177
    v_mfma_f32_16x16x32_bf16 v[164:167], a[52:55], v[116:119], v[164:167]
    v_add_f32 v221, v221, v233
    v_add_f32 v234, v208, v209
    v_mfma_f32_16x16x32_bf16 v[160:163], a[40:43], v[120:123], v[160:163]
    ds_read_b64_tr_b16 a[114:115], v225 offset:17536
    v_cvt_pk_bf16_f32 v192, v208, v209
    v_mfma_f32_16x16x32_bf16 v[164:167], a[56:59], v[120:123], v[164:167]
    ds_read_b64_tr_b16 a[116:117], v225 offset:17056
    v_exp_f32 v210, v178
    v_mfma_f32_16x16x32_bf16 v[160:163], a[44:47], v[124:127], v[160:163]
    ds_read_b64_tr_b16 a[118:119], v225 offset:17568
    v_exp_f32 v211, v179
    v_mfma_f32_16x16x32_bf16 v[164:167], a[60:63], v[124:127], v[164:167]
    v_add_f32 v217, v210, v211
    v_cvt_pk_bf16_f32 v193, v210, v211
    v_mfma_f32_16x16x32_bf16 v[48:51], a[64:67], v[188:191], v[48:51]
    ds_read_b64_tr_b16 a[120:121], v225 offset:17088
    v_exp_f32 v212, v180
    v_mfma_f32_16x16x32_bf16 v[52:55], a[68:71], v[188:191], v[52:55]
    v_exp_f32 v213, v181
    v_mfma_f32_16x16x32_bf16 v[56:59], a[72:75], v[188:191], v[56:59]
    ds_read_b64_tr_b16 a[122:123], v225 offset:17600
    v_add_f32 v234, v234, v217
    v_add_f32 v218, v212, v213
    v_mfma_f32_16x16x32_bf16 v[60:63], a[76:79], v[188:191], v[60:63]
    v_cvt_pk_bf16_f32 v194, v212, v213
    v_exp_f32 v214, v182
    v_mfma_f32_16x16x32_bf16 v[64:67], a[80:83], v[188:191], v[64:67]
    s_add_u32 m0, s28, 92928
    ds_read_b64_tr_b16 a[124:125], v225 offset:17120
    v_exp_f32 v215, v183
    v_mfma_f32_16x16x32_bf16 v[68:71], a[84:87], v[188:191], v[68:71]
    s_waitcnt vmcnt(3)
    buffer_load_dwordx4 v229, s[8:11], s27 offen nt lds
    v_mfma_f32_16x16x32_bf16 v[72:75], a[88:91], v[188:191], v[72:75]
    ds_read_b64_tr_b16 a[126:127], v225 offset:17632
    v_add_f32 v234, v234, v218
    v_add_f32 v219, v214, v215
    v_mfma_f32_16x16x32_bf16 v[76:79], a[92:95], v[188:191], v[76:79]
    v_cvt_pk_bf16_f32 v195, v214, v215
    v_add_f32 v234, v234, v219
    v_cmp_nge_f32 vcc, s32, v234
    v_mfma_f32_16x16x32_bf16 v[168:171], a[32:35], v[128:131], v[200:203]
    v_exp_f32 v208, v160
    v_mfma_f32_16x16x32_bf16 v[172:175], a[48:51], v[128:131], v[200:203]
    s_cbranch_vccnz L_stub_143
L_back_144:
    v_add_u32 v224, 33792, v226
    v_add_f32 v222, v222, v234
    v_mfma_f32_16x16x32_bf16 v[168:171], a[36:39], v[132:135], v[168:171]
    v_add_u32 v225, 33792, v227
    v_exp_f32 v209, v161
    v_mfma_f32_16x16x32_bf16 v[172:175], a[52:55], v[132:135], v[172:175]
    s_waitcnt lgkmcnt(0)
    s_barrier
    v_mfma_f32_16x16x32_bf16 v[168:171], a[40:43], v[136:139], v[168:171]
    ds_read_b128 a[0:3], v224 offset:0
    v_add_f32 v232, v208, v209
    v_mfma_f32_16x16x32_bf16 v[172:175], a[56:59], v[136:139], v[172:175]
    v_exp_f32 v210, v162
    v_mfma_f32_16x16x32_bf16 v[168:171], a[44:47], v[140:143], v[168:171]
    ds_read_b128 a[16:19], v224 offset:512
    v_exp_f32 v211, v163
    v_mfma_f32_16x16x32_bf16 v[172:175], a[60:63], v[140:143], v[172:175]
    v_cvt_pk_bf16_f32 v184, v208, v209
    v_add_f32 v217, v210, v211
    v_mfma_f32_16x16x32_bf16 v[80:83], a[64:67], v[192:195], v[80:83]
    s_add_u32 m0, s28, 93728
    ds_read_b128 a[4:7], v224 offset:64
    v_exp_f32 v212, v164
    v_mfma_f32_16x16x32_bf16 v[84:87], a[68:71], v[192:195], v[84:87]
    s_waitcnt vmcnt(3)
    buffer_load_dwordx4 v229, s[8:11], s27 offen offset:256 nt lds
    v_mfma_f32_16x16x32_bf16 v[88:91], a[72:75], v[192:195], v[88:91]
    ds_read_b128 a[20:23], v224 offset:576
    v_exp_f32 v213, v165
    v_mfma_f32_16x16x32_bf16 v[92:95], a[76:79], v[192:195], v[92:95]
    v_cvt_pk_bf16_f32 v185, v210, v211
    v_add_f32 v232, v232, v217
    v_add_f32 v218, v212, v213
    v_mfma_f32_16x16x32_bf16 v[96:99], a[80:83], v[192:195], v[96:99]
    ds_read_b128 a[8:11], v224 offset:128
    v_exp_f32 v214, v166
    v_mfma_f32_16x16x32_bf16 v[100:103], a[84:87], v[192:195], v[100:103]
    v_cvt_pk_bf16_f32 v186, v212, v213
    v_exp_f32 v215, v167
    v_mfma_f32_16x16x32_bf16 v[104:107], a[88:91], v[192:195], v[104:107]
    ds_read_b128 a[24:27], v224 offset:640
    v_add_f32 v232, v232, v218
    v_add_f32 v219, v214, v215
    v_mfma_f32_16x16x32_bf16 v[108:111], a[92:95], v[192:195], v[108:111]
    v_cvt_pk_bf16_f32 v187, v214, v215
    v_add_f32 v232, v232, v219
    v_cmp_nge_f32 vcc, s32, v232
    v_mfma_f32_16x16x32_bf16 v[176:179], a[32:35], v[144:147], v[204:207]
    ds_read_b128 a[12:15], v224 offset:192
    v_exp_f32 v208, v168
    v_mfma_f32_16x16x32_bf16 v[180:183], a[48:51], v[144:147], v[204:207]
    s_cbranch_vccnz L_stub_145
L_back_146:
    v_add_f32 v220, v220, v232
    v_mfma_f32_16x16x32_bf16 v[176:179], a[36:39], v[148:151], v[176:179]
    ds_read_b128 a[28:31], v224 offset:704
    v_exp_f32 v209, v169
    v_mfma_f32_16x16x32_bf16 v[180:183], a[52:55], v[148:151], v[180:183]
    s_mov_b32 s27, 245760
    v_exp_f32 v210, v170
    v_mfma_f32_16x16x32_bf16 v[176:179], a[40:43], v[152:155], v[176:179]
    s_add_u32 m0, s28, 0
    ds_read_b64_tr_b16 a[64:65], v225 offset:0
    v_add_f32 v233, v208, v209
    v_mfma_f32_16x16x32_bf16 v[180:183], a[56:59], v[152:155], v[180:183]
    s_waitcnt vmcnt(3)
    buffer_load_dwordx4 v228, s[4:7], s27 offen nt lds
    v_mfma_f32_16x16x32_bf16 v[176:179], a[44:47], v[156:159], v[176:179]
    ds_read_b64_tr_b16 a[66:67], v225 offset:512
    v_cvt_pk_bf16_f32 v188, v208, v209
    v_mfma_f32_16x16x32_bf16 v[180:183], a[60:63], v[156:159], v[180:183]
    v_exp_f32 v211, v171
    v_mfma_f32_16x16x32_bf16 v[16:19], a[96:99], v[184:187], v[16:19]
    ds_read_b64_tr_b16 a[68:69], v225 offset:32
    v_add_f32 v217, v210, v211
    v_mfma_f32_16x16x32_bf16 v[20:23], a[100:103], v[184:187], v[20:23]
    v_cvt_pk_bf16_f32 v189, v210, v211
    v_add_f32 v233, v233, v217
    v_mfma_f32_16x16x32_bf16 v[24:27], a[104:107], v[184:187], v[24:27]
    ds_read_b64_tr_b16 a[70:71], v225 offset:544
    v_exp_f32 v212, v172
    v_mfma_f32_16x16x32_bf16 v[28:31], a[108:111], v[184:187], v[28:31]
    v_exp_f32 v213, v173
    v_mfma_f32_16x16x32_bf16 v[32:35], a[112:115], v[184:187], v[32:35]
    ds_read_b64_tr_b16 a[72:73], v225 offset:64
    v_exp_f32 v214, v174
    v_mfma_f32_16x16x32_bf16 v[36:39], a[116:119], v[184:187], v[36:39]
    v_add_f32 v218, v212, v213
    v_exp_f32 v215, v175
    v_mfma_f32_16x16x32_bf16 v[40:43], a[120:123], v[184:187], v[40:43]
    v_cvt_pk_bf16_f32 v190, v212, v213
    v_add_f32 v233, v233, v218
    v_add_f32 v219, v214, v215
    v_mfma_f32_16x16x32_bf16 v[44:47], a[124:127], v[184:187], v[44:47]
    s_waitcnt lgkmcnt(5)
    v_cvt_pk_bf16_f32 v191, v214, v215
    v_add_f32 v233, v233, v219
    v_cmp_nge_f32 vcc, s32, v233
    v_mfma_f32_16x16x32_bf16 v[160:163], a[0:3], v[112:115], v[196:199]
    s_add_u32 m0, s28, 800
    ds_read_b64_tr_b16 a[74:75], v225 offset:576
    v_exp_f32 v208, v176
    v_mfma_f32_16x16x32_bf16 v[164:167], a[16:19], v[112:115], v[196:199]
    s_waitcnt vmcnt(3)
    s_cbranch_vccnz L_stub_147
L_back_148:
    buffer_load_dwordx4 v228, s[4:7], s27 offen offset:256 nt lds
    v_mfma_f32_16x16x32_bf16 v[160:163], a[4:7], v[116:119], v[160:163]
    ds_read_b64_tr_b16 a[76:77], v225 offset:96
    v_exp_f32 v209, v177
    v_mfma_f32_16x16x32_bf16 v[164:167], a[20:23], v[116:119], v[164:167]
    v_add_f32 v221, v221, v233
    v_add_f32 v234, v208, v209
    v_mfma_f32_16x16x32_bf16 v[160:163], a[8:11], v[120:123], v[160:163]
    ds_read_b64_tr_b16 a[78:79], v225 offset:608
    v_cvt_pk_bf16_f32 v192, v208, v209
    v_mfma_f32_16x16x32_bf16 v[164:167], a[24:27], v[120:123], v[164:167]
    v_exp_f32 v210, v178
    v_mfma_f32_16x16x32_bf16 v[160:163], a[12:15], v[124:127], v[160:163]
    ds_read_b64_tr_b16 a[80:81], v225 offset:128
    v_exp_f32 v211, v179
    v_mfma_f32_16x16x32_bf16 v[164:167], a[28:31], v[124:127], v[164:167]
    v_add_f32 v217, v210, v211
    v_cvt_pk_bf16_f32 v193, v210, v211
    v_mfma_f32_16x16x32_bf16 v[48:51], a[96:99], v[188:191], v[48:51]
    ds_read_b64_tr_b16 a[82:83], v225 offset:640
    v_exp_f32 v212, v180
    v_mfma_f32_16x16x32_bf16 v[52:55], a[100:103], v[188:191], v[52:55]
    v_exp_f32 v213, v181
    v_mfma_f32_16x16x32_bf16 v[56:59], a[104:107], v[188:191], v[56:59]
    ds_read_b64_tr_b16 a[84:85], v225 offset:160
    v_add_f32 v234, v234, v217
    v_add_f32 v218, v212, v213
    v_mfma_f32_16x16x32_bf16 v[60:63], a[108:111], v[188:191], v[60:63]
    v_cvt_pk_bf16_f32 v194, v212, v213
    v_exp_f32 v214, v182
    v_mfma_f32_16x16x32_bf16 v[64:67], a[112:115], v[188:191], v[64:67]
    s_add_u32 m0, s28, 8448
    ds_read_b64_tr_b16 a[86:87], v225 offset:672
    v_exp_f32 v215, v183
    v_mfma_f32_16x16x32_bf16 v[68:71], a[116:119], v[188:191], v[68:71]
    s_waitcnt vmcnt(3)
    buffer_load_dwordx4 v228, s[8:11], s27 offen nt lds
    v_mfma_f32_16x16x32_bf16 v[72:75], a[120:123], v[188:191], v[72:75]
    ds_read_b64_tr_b16 a[88:89], v225 offset:192
    v_add_f32 v234, v234, v218
    v_add_f32 v219, v214, v215
    v_mfma_f32_16x16x32_bf16 v[76:79], a[124:127], v[188:191], v[76:79]
    v_cvt_pk_bf16_f32 v195, v214, v215
    v_add_f32 v234, v234, v219
    v_cmp_nge_f32 vcc, s32, v234
    v_mfma_f32_16x16x32_bf16 v[168:171], a[0:3], v[128:131], v[200:203]
    ds_read_b64_tr_b16 a[90:91], v225 offset:704
    v_exp_f32 v208, v160
    v_mfma_f32_16x16x32_bf16 v[172:175], a[16:19], v[128:131], v[200:203]
    s_cbranch_vccnz L_stub_149
L_back_150:
    v_add_f32 v222, v222, v234
    v_mfma_f32_16x16x32_bf16 v[168:171], a[4:7], v[132:135], v[168:171]
    ds_read_b64_tr_b16 a[92:93], v225 offset:224
    v_exp_f32 v209, v161
    v_mfma_f32_16x16x32_bf16 v[172:175], a[20:23], v[132:135], v[172:175]
    v_add_f32 v232, v208, v209
    v_cvt_pk_bf16_f32 v184, v208, v209
    v_mfma_f32_16x16x32_bf16 v[168:171], a[8:11], v[136:139], v[168:171]
    ds_read_b64_tr_b16 a[94:95], v225 offset:736
    v_exp_f32 v210, v162
    v_mfma_f32_16x16x32_bf16 v[172:175], a[24:27], v[136:139], v[172:175]
    v_exp_f32 v211, v163
    v_mfma_f32_16x16x32_bf16 v[168:171], a[12:15], v[140:143], v[168:171]
    ds_read_b128 a[32:35], v224 offset:16896
    v_add_f32 v217, v210, v211
    v_mfma_f32_16x16x32_bf16 v[172:175], a[28:31], v[140:143], v[172:175]
    v_exp_f32 v212, v164
    v_mfma_f32_16x16x32_bf16 v[80:83], a[96:99], v[192:195], v[80:83]
    s_add_u32 m0, s28, 9248
    ds_read_b128 a[48:51], v224 offset:17408
    v_cvt_pk_bf16_f32 v185, v210, v211
    v_mfma_f32_16x16x32_bf16 v[84:87], a[100:103], v[192:195], v[84:87]
    s_waitcnt vmcnt(3)
    buffer_load_dwordx4 v228, s[8:11], s27 offen offset:256 nt lds
    v_mfma_f32_16x16x32_bf16 v[88:91], a[104:107], v[192:195], v[88:91]
    ds_read_b128 a[36:39], v224 offset:16960
    v_exp_f32 v213, v165
    v_mfma_f32_16x16x32_bf16 v[92:95], a[108:111], v[192:195], v[92:95]
    v_add_f32 v232, v232, v217
    v_add_f32 v218, v212, v213
    v_mfma_f32_16x16x32_bf16 v[96:99], a[112:115], v[192:195], v[96:99]
    ds_read_b128 a[52:55], v224 offset:17472
    v_exp_f32 v214, v166
    v_mfma_f32_16x16x32_bf16 v[100:103], a[116:119], v[192:195], v[100:103]
    v_cvt_pk_bf16_f32 v186, v212, v213
    v_exp_f32 v215, v167
    v_mfma_f32_16x16x32_bf16 v[104:107], a[120:123], v[192:195], v[104:107]
    ds_read_b128 a[40:43], v224 offset:17024
    v_add_f32 v232, v232, v218
    v_add_f32 v219, v214, v215
    v_mfma_f32_16x16x32_bf16 v[108:111], a[124:127], v[192:195], v[108:111]
    v_cvt_pk_bf16_f32 v187, v214, v215
    v_add_f32 v232, v232, v219
    v_cmp_nge_f32 vcc, s32, v232
    v_mfma_f32_16x16x32_bf16 v[176:179], a[0:3], v[144:147], v[204:207]
    ds_read_b128 a[56:59], v224 offset:17536
    v_exp_f32 v208, v168
    v_mfma_f32_16x16x32_bf16 v[180:183], a[16:19], v[144:147], v[204:207]
    s_cbranch_vccnz L_stub_151
L_back_152:
    v_exp_f32 v209, v169
    v_mfma_f32_16x16x32_bf16 v[176:179], a[4:7], v[148:151], v[176:179]
    ds_read_b128 a[44:47], v224 offset:17088
    v_add_f32 v220, v220, v232
    v_add_f32 v233, v208, v209
    v_mfma_f32_16x16x32_bf16 v[180:183], a[20:23], v[148:151], v[180:183]
    v_exp_f32 v210, v170
    v_mfma_f32_16x16x32_bf16 v[176:179], a[8:11], v[152:155], v[176:179]
    s_add_u32 m0, s28, 16896
    ds_read_b128 a[60:63], v224 offset:17600
    v_cvt_pk_bf16_f32 v188, v208, v209
    v_mfma_f32_16x16x32_bf16 v[180:183], a[24:27], v[152:155], v[180:183]
    s_waitcnt vmcnt(3)
    buffer_load_dwordx4 v229, s[4:7], s27 offen nt lds
    v_mfma_f32_16x16x32_bf16 v[176:179], a[12:15], v[156:159], v[176:179]
    ds_read_b64_tr_b16 a[96:97], v225 offset:16896
    v_exp_f32 v211, v171
    v_mfma_f32_16x16x32_bf16 v[180:183], a[28:31], v[156:159], v[180:183]
    s_waitcnt lgkmcnt(9)
    ds_read_b64_tr_b16 a[98:99], v225 offset:17408
    v_add_f32 v217, v210, v211
    v_mfma_f32_16x16x32_bf16 v[16:19], a[64:67], v[184:187], v[16:19]
    ds_read_b64_tr_b16 a[100:101], v225 offset:16928
    v_cvt_pk_bf16_f32 v189, v210, v211
    v_mfma_f32_16x16x32_bf16 v[20:23], a[68:71], v[184:187], v[20:23]
    v_exp_f32 v212, v172
    v_mfma_f32_16x16x32_bf16 v[24:27], a[72:75], v[184:187], v[24:27]
    ds_read_b64_tr_b16 a[102:103], v225 offset:17440
    v_exp_f32 v213, v173
    v_mfma_f32_16x16x32_bf16 v[28:31], a[76:79], v[184:187], v[28:31]
    ds_read_b64_tr_b16 a[104:105], v225 offset:16960
    v_add_f32 v233, v233, v217
    v_add_f32 v218, v212, v213
    v_mfma_f32_16x16x32_bf16 v[32:35], a[80:83], v[184:187], v[32:35]
    ds_read_b64_tr_b16 a[106:107], v225 offset:17472
    v_exp_f32 v214, v174
    v_mfma_f32_16x16x32_bf16 v[36:39], a[84:87], v[184:187], v[36:39]
    v_cvt_pk_bf16_f32 v190, v212, v213
    v_exp_f32 v215, v175
    v_mfma_f32_16x16x32_bf16 v[40:43], a[88:91], v[184:187], v[40:43]
    ds_read_b64_tr_b16 a[108:109], v225 offset:16992
    v_add_f32 v233, v233, v218
    v_add_f32 v219, v214, v215
    v_mfma_f32_16x16x32_bf16 v[44:47], a[92:95], v[184:187], v[44:47]
    s_waitcnt lgkmcnt(7)
    v_cvt_pk_bf16_f32 v191, v214, v215
    v_add_f32 v233, v233, v219
    v_cmp_nge_f32 vcc, s32, v233
    v_mfma_f32_16x16x32_bf16 v[160:163], a[32:35], v[112:115], v[196:199]
    s_add_u32 m0, s28, 17696
    ds_read_b64_tr_b16 a[110:111], v225 offset:17504
    v_exp_f32 v208, v176
    v_mfma_f32_16x16x32_bf16 v[164:167], a[48:51], v[112:115], v[196:199]
    s_waitcnt vmcnt(3)
    s_cbranch_vccnz L_stub_153
L_back_154:
    buffer_load_dwordx4 v229, s[4:7], s27 offen offset:256 nt lds
    v_mfma_f32_16x16x32_bf16 v[160:163], a[36:39], v[116:119], v[160:163]
    ds_read_b64_tr_b16 a[112:113], v225 offset:17024
    v_exp_f32 v209, v177
    v_mfma_f32_16x16x32_bf16 v[164:167], a[52:55], v[116:119], v[164:167]
    v_add_f32 v221, v221, v233
    v_add_f32 v234, v208, v209
    v_mfma_f32_16x16x32_bf16 v[160:163], a[40:43], v[120:123], v[160:163]
    ds_read_b64_tr_b16 a[114:115], v225 offset:17536
    v_cvt_pk_bf16_f32 v192, v208, v209
    v_mfma_f32_16x16x32_bf16 v[164:167], a[56:59], v[120:123], v[164:167]
    ds_read_b64_tr_b16 a[116:117], v225 offset:17056
    v_exp_f32 v210, v178
    v_mfma_f32_16x16x32_bf16 v[160:163], a[44:47], v[124:127], v[160:163]
    ds_read_b64_tr_b16 a[118:119], v225 offset:17568
    v_exp_f32 v211, v179
    v_mfma_f32_16x16x32_bf16 v[164:167], a[60:63], v[124:127], v[164:167]
    v_add_f32 v217, v210, v211
    v_cvt_pk_bf16_f32 v193, v210, v211
    v_mfma_f32_16x16x32_bf16 v[48:51], a[64:67], v[188:191], v[48:51]
    ds_read_b64_tr_b16 a[120:121], v225 offset:17088
    v_exp_f32 v212, v180
    v_mfma_f32_16x16x32_bf16 v[52:55], a[68:71], v[188:191], v[52:55]
    v_exp_f32 v213, v181
    v_mfma_f32_16x16x32_bf16 v[56:59], a[72:75], v[188:191], v[56:59]
    ds_read_b64_tr_b16 a[122:123], v225 offset:17600
    v_add_f32 v234, v234, v217
    v_add_f32 v218, v212, v213
    v_mfma_f32_16x16x32_bf16 v[60:63], a[76:79], v[188:191], v[60:63]
    v_cvt_pk_bf16_f32 v194, v212, v213
    v_exp_f32 v214, v182
    v_mfma_f32_16x16x32_bf16 v[64:67], a[80:83], v[188:191], v[64:67]
    s_add_u32 m0, s28, 25344
    ds_read_b64_tr_b16 a[124:125], v225 offset:17120
    v_exp_f32 v215, v183
    v_mfma_f32_16x16x32_bf16 v[68:71], a[84:87], v[188:191], v[68:71]
    s_waitcnt vmcnt(3)
    buffer_load_dwordx4 v229, s[8:11], s27 offen nt lds
    v_mfma_f32_16x16x32_bf16 v[72:75], a[88:91], v[188:191], v[72:75]
    ds_read_b64_tr_b16 a[126:127], v225 offset:17632
    v_add_f32 v234, v234, v218
    v_add_f32 v219, v214, v215
    v_mfma_f32_16x16x32_bf16 v[76:79], a[92:95], v[188:191], v[76:79]
    v_cvt_pk_bf16_f32 v195, v214, v215
    v_add_f32 v234, v234, v219
    v_cmp_nge_f32 vcc, s32, v234
    v_mfma_f32_16x16x32_bf16 v[168:171], a[32:35], v[128:131], v[200:203]
    v_exp_f32 v208, v160
    v_mfma_f32_16x16x32_bf16 v[172:175], a[48:51], v[128:131], v[200:203]
    s_cbranch_vccnz L_stub_155
L_back_156:
    v_add_u32 v224, 67584, v226
    v_add_f32 v222, v222, v234
    v_mfma_f32_16x16x32_bf16 v[168:171], a[36:39], v[132:135], v[168:171]
    v_add_u32 v225, 67584, v227
    v_exp_f32 v209, v161
    v_mfma_f32_16x16x32_bf16 v[172:175], a[52:55], v[132:135], v[172:175]
    s_waitcnt lgkmcnt(0)
    s_barrier
    v_mfma_f32_16x16x32_bf16 v[168:171], a[40:43], v[136:139], v[168:171]
    ds_read_b128 a[0:3], v224 offset:0
    v_add_f32 v232, v208, v209
    v_cvt_pk_bf16_f32 v184, v208, v209
    v_mfma_f32_16x16x32_bf16 v[172:175], a[56:59], v[136:139], v[172:175]
    v_exp_f32 v210, v162
    v_exp_f32 v211, v163
    v_mfma_f32_16x16x32_bf16 v[168:171], a[44:47], v[140:143], v[168:171]
    ds_read_b128 a[16:19], v224 offset:512
    v_add_f32 v217, v210, v211
    v_cvt_pk_bf16_f32 v185, v210, v211
    v_mfma_f32_16x16x32_bf16 v[172:175], a[60:63], v[140:143], v[172:175]
    v_add_f32 v232, v232, v217
    v_exp_f32 v212, v164
    v_mfma_f32_16x16x32_bf16 v[80:83], a[64:67], v[192:195], v[80:83]
    s_add_u32 m0, s28, 26144
    ds_read_b128 a[4:7], v224 offset:64
    v_exp_f32 v213, v165
    v_mfma_f32_16x16x32_bf16 v[84:87], a[68:71], v[192:195], v[84:87]
    s_waitcnt vmcnt(3)
    buffer_load_dwordx4 v229, s[8:11], s27 offen offset:256 nt lds
    v_mfma_f32_16x16x32_bf16 v[88:91], a[72:75], v[192:195], v[88:91]
    s_add_u32 m0, s76, 49152
    ds_read_b128 a[20:23], v224 offset:576
    v_add_f32 v218, v212, v213
    v_cvt_pk_bf16_f32 v186, v212, v213
    v_mfma_f32_16x16x32_bf16 v[92:95], a[76:79], v[192:195], v[92:95]
    buffer_load_dwordx4 v247, s[64:67], s74 offen lds
    v_mfma_f32_16x16x32_bf16 v[96:99], a[80:83], v[192:195], v[96:99]
    ds_read_b128 a[8:11], v224 offset:128
    v_exp_f32 v214, v166
    v_mfma_f32_16x16x32_bf16 v[100:103], a[84:87], v[192:195], v[100:103]
    s_add_u32 m0, s76, 50176
    v_add_f32 v232, v232, v218
    v_exp_f32 v215, v167
    v_mfma_f32_16x16x32_bf16 v[104:107], a[88:91], v[192:195], v[104:107]
    buffer_load_dwordx4 v248, s[64:67], s74 offen lds
    ds_read_b128 a[24:27], v224 offset:640
    v_add_f32 v219, v214, v215
    v_mfma_f32_16x16x32_bf16 v[108:111], a[92:95], v[192:195], v[108:111]
    v_cvt_pk_bf16_f32 v187, v214, v215
    v_add_f32 v232, v232, v219
    v_cmp_nge_f32 vcc, s32, v232
    v_mfma_f32_16x16x32_bf16 v[176:179], a[32:35], v[144:147], v[204:207]
    s_add_u32 m0, s76, 51200
    ds_read_b128 a[12:15], v224 offset:192
    v_exp_f32 v208, v168
    v_mfma_f32_16x16x32_bf16 v[180:183], a[48:51], v[144:147], v[204:207]
    s_cbranch_vccnz L_stub_157
L_back_158:
    buffer_load_dwordx4 v249, s[64:67], s74 offen lds
    v_mfma_f32_16x16x32_bf16 v[176:179], a[36:39], v[148:151], v[176:179]
    ds_read_b128 a[28:31], v224 offset:704
    v_exp_f32 v209, v169
    v_mfma_f32_16x16x32_bf16 v[180:183], a[52:55], v[148:151], v[180:183]
    s_add_u32 m0, s76, 52224
    v_add_f32 v220, v220, v232
    v_exp_f32 v210, v170
    v_mfma_f32_16x16x32_bf16 v[176:179], a[40:43], v[152:155], v[176:179]
    buffer_load_dwordx4 v250, s[64:67], s74 offen lds
    ds_read_b64_tr_b16 a[64:65], v225 offset:0
    v_add_f32 v233, v208, v209
    v_mfma_f32_16x16x32_bf16 v[180:183], a[56:59], v[152:155], v[180:183]
    s_add_u32 s74, s74, 36864
    s_cmp_eq_u32 s74, 1179648
    s_cselect_b32 s74, 0, s74
    v_cvt_pk_bf16_f32 v188, v208, v209
    v_mfma_f32_16x16x32_bf16 v[176:179], a[44:47], v[156:159], v[176:179]
    s_add_u32 m0, s76, 114688
    ds_read_b64_tr_b16 a[66:67], v225 offset:512
    v_exp_f32 v211, v171
    v_mfma_f32_16x16x32_bf16 v[180:183], a[60:63], v[156:159], v[180:183]
    buffer_load_dwordx4 v247, s[64:67], s74 offen lds
    v_mfma_f32_16x16x32_bf16 v[16:19], a[96:99], v[184:187], v[16:19]
    ds_read_b64_tr_b16 a[68:69], v225 offset:32
    v_add_f32 v217, v210, v211
    v_cvt_pk_bf16_f32 v189, v210, v211
    v_mfma_f32_16x16x32_bf16 v[20:23], a[100:103], v[184:187], v[20:23]
    s_add_u32 m0, s76, 115712
    v_exp_f32 v212, v172
    v_exp_f32 v213, v173
    v_mfma_f32_16x16x32_bf16 v[24:27], a[104:107], v[184:187], v[24:27]
    buffer_load_dwordx4 v248, s[64:67], s74 offen lds
    ds_read_b64_tr_b16 a[70:71], v225 offset:544
    v_add_f32 v233, v233, v217
    v_mfma_f32_16x16x32_bf16 v[28:31], a[108:111], v[184:187], v[28:31]
    v_add_f32 v218, v212, v213
    v_exp_f32 v214, v174
    v_mfma_f32_16x16x32_bf16 v[32:35], a[112:115], v[184:187], v[32:35]
    s_add_u32 m0, s76, 116736
    ds_read_b64_tr_b16 a[72:73], v225 offset:64
    v_cvt_pk_bf16_f32 v190, v212, v213
    v_exp_f32 v215, v175
    v_mfma_f32_16x16x32_bf16 v[36:39], a[116:119], v[184:187], v[36:39]
    buffer_load_dwordx4 v249, s[64:67], s74 offen lds
    v_mfma_f32_16x16x32_bf16 v[40:43], a[120:123], v[184:187], v[40:43]
    v_add_f32 v233, v233, v218
    v_add_f32 v219, v214, v215
    v_cvt_pk_bf16_f32 v191, v214, v215
    v_mfma_f32_16x16x32_bf16 v[44:47], a[124:127], v[184:187], v[44:47]
    s_waitcnt lgkmcnt(5)
    s_add_u32 m0, s76, 117760
    v_add_f32 v233, v233, v219
    v_cmp_nge_f32 vcc, s32, v233
    v_mfma_f32_16x16x32_bf16 v[160:163], a[0:3], v[112:115], v[196:199]
    buffer_load_dwordx4 v250, s[64:67], s74 offen lds
    ds_read_b64_tr_b16 a[74:75], v225 offset:576
    v_exp_f32 v208, v176
    v_mfma_f32_16x16x32_bf16 v[164:167], a[16:19], v[112:115], v[196:199]
    s_add_u32 s74, s74, 36864
    s_cbranch_vccnz L_stub_159
L_back_160:
    s_cmp_eq_u32 s74, 1179648
    s_cselect_b32 s74, 0, s74
    v_mfma_f32_16x16x32_bf16 v[160:163], a[4:7], v[116:119], v[160:163]
    s_add_u32 m0, s76, 131072
    ds_read_b64_tr_b16 a[76:77], v225 offset:96
    v_add_f32 v221, v221, v233
    v_exp_f32 v209, v177
    v_mfma_f32_16x16x32_bf16 v[164:167], a[20:23], v[116:119], v[164:167]
    buffer_load_dwordx4 v247, s[64:67], s74 offen lds
    v_mfma_f32_16x16x32_bf16 v[160:163], a[8:11], v[120:123], v[160:163]
    ds_read_b64_tr_b16 a[78:79], v225 offset:608
    v_exp_f32 v210, v178
    v_mfma_f32_16x16x32_bf16 v[164:167], a[24:27], v[120:123], v[164:167]
    s_add_u32 m0, s76, 132096
    v_add_f32 v234, v208, v209
    v_exp_f32 v211, v179
    v_mfma_f32_16x16x32_bf16 v[160:163], a[12:15], v[124:127], v[160:163]
    buffer_load_dwordx4 v248, s[64:67], s74 offen lds
    ds_read_b64_tr_b16 a[80:81], v225 offset:128
    v_cvt_pk_bf16_f32 v192, v208, v209
    v_mfma_f32_16x16x32_bf16 v[164:167], a[28:31], v[124:127], v[164:167]
    v_add_f32 v217, v210, v211
    v_exp_f32 v212, v180
    v_mfma_f32_16x16x32_bf16 v[48:51], a[96:99], v[188:191], v[48:51]
    s_add_u32 m0, s76, 133120
    ds_read_b64_tr_b16 a[82:83], v225 offset:640
    v_exp_f32 v213, v181
    v_mfma_f32_16x16x32_bf16 v[52:55], a[100:103], v[188:191], v[52:55]
    buffer_load_dwordx4 v249, s[64:67], s74 offen lds
    v_mfma_f32_16x16x32_bf16 v[56:59], a[104:107], v[188:191], v[56:59]
    ds_read_b64_tr_b16 a[84:85], v225 offset:160
    v_cvt_pk_bf16_f32 v193, v210, v211
    v_add_f32 v234, v234, v217
    v_add_f32 v218, v212, v213
    v_mfma_f32_16x16x32_bf16 v[60:63], a[108:111], v[188:191], v[60:63]
    s_add_u32 m0, s76, 134144
    v_exp_f32 v214, v182
    v_exp_f32 v215, v183
    v_mfma_f32_16x16x32_bf16 v[64:67], a[112:115], v[188:191], v[64:67]
    buffer_load_dwordx4 v250, s[64:67], s74 offen lds
    ds_read_b64_tr_b16 a[86:87], v225 offset:672
    v_cvt_pk_bf16_f32 v194, v212, v213
    v_mfma_f32_16x16x32_bf16 v[68:71], a[116:119], v[188:191], v[68:71]
    s_add_u32 s74, s74, 36864
    s_cmp_eq_u32 s74, 1179648
    s_cselect_b32 s74, 0, s74
    v_add_f32 v234, v234, v218
    v_add_f32 v219, v214, v215
    v_mfma_f32_16x16x32_bf16 v[72:75], a[120:123], v[188:191], v[72:75]
    s_add_u32 m0, s76, 147456
    ds_read_b64_tr_b16 a[88:89], v225 offset:192
    v_cvt_pk_bf16_f32 v195, v214, v215
    v_add_f32 v234, v234, v219
    v_cmp_nge_f32 vcc, s32, v234
    v_mfma_f32_16x16x32_bf16 v[76:79], a[124:127], v[188:191], v[76:79]
    buffer_load_dwordx4 v247, s[64:67], s74 offen lds
    v_mfma_f32_16x16x32_bf16 v[168:171], a[0:3], v[128:131], v[200:203]
    ds_read_b64_tr_b16 a[90:91], v225 offset:704
    v_exp_f32 v208, v160
    v_mfma_f32_16x16x32_bf16 v[172:175], a[16:19], v[128:131], v[200:203]
    s_add_u32 m0, s76, 148480
    s_cbranch_vccnz L_stub_161
L_back_162:
    v_exp_f32 v209, v161
    v_mfma_f32_16x16x32_bf16 v[168:171], a[4:7], v[132:135], v[168:171]
    buffer_load_dwordx4 v248, s[64:67], s74 offen lds
    ds_read_b64_tr_b16 a[92:93], v225 offset:224
    v_add_f32 v222, v222, v234
    v_mfma_f32_16x16x32_bf16 v[172:175], a[20:23], v[132:135], v[172:175]
    v_add_f32 v232, v208, v209
    v_exp_f32 v210, v162
    v_mfma_f32_16x16x32_bf16 v[168:171], a[8:11], v[136:139], v[168:171]
    s_add_u32 m0, s76, 149504
    ds_read_b64_tr_b16 a[94:95], v225 offset:736
    v_exp_f32 v211, v163
    v_mfma_f32_16x16x32_bf16 v[172:175], a[24:27], v[136:139], v[172:175]
    buffer_load_dwordx4 v249, s[64:67], s74 offen lds
    v_mfma_f32_16x16x32_bf16 v[168:171], a[12:15], v[140:143], v[168:171]
    ds_read_b128 a[32:35], v224 offset:16896
    v_cvt_pk_bf16_f32 v184, v208, v209
    v_exp_f32 v212, v164
    v_mfma_f32_16x16x32_bf16 v[172:175], a[28:31], v[140:143], v[172:175]
    s_add_u32 m0, s76, 150528
    v_add_f32 v217, v210, v211
    v_exp_f32 v213, v165
    v_mfma_f32_16x16x32_bf16 v[80:83], a[96:99], v[192:195], v[80:83]
    s_waitcnt vmcnt(11)
    buffer_load_dwordx4 v250, s[64:67], s74 offen lds
    ds_read_b128 a[48:51], v224 offset:17408
    v_cvt_pk_bf16_f32 v185, v210, v211
    v_mfma_f32_16x16x32_bf16 v[84:87], a[100:103], v[192:195], v[84:87]
    s_add_u32 s74, s74, 36864
    ds_read_b64_tr_b16 a[128:129], v251 offset:49152
    s_cmp_eq_u32 s74, 1179648
    s_cselect_b32 s74, 0, s74
    v_add_f32 v232, v232, v217
    v_mfma_f32_16x16x32_bf16 v[88:91], a[104:107], v[192:195], v[88:91]
    ds_read_b128 a[36:39], v224 offset:16960
    ds_read_b64_tr_b16 a[130:131], v251 offset:51200
    v_add_f32 v218, v212, v213
    v_mfma_f32_16x16x32_bf16 v[92:95], a[108:111], v[192:195], v[92:95]
    ds_read_b64_tr_b16 a[132:133], v252 offset:49152
    v_cvt_pk_bf16_f32 v186, v212, v213
    v_add_f32 v232, v232, v218
    v_mfma_f32_16x16x32_bf16 v[96:99], a[112:115], v[192:195], v[96:99]
    ds_read_b128 a[52:55], v224 offset:17472
    ds_read_b64_tr_b16 a[134:135], v252 offset:51200
    v_exp_f32 v214, v166
    v_mfma_f32_16x16x32_bf16 v[100:103], a[116:119], v[192:195], v[100:103]
    ds_read_b64_tr_b16 a[136:137], v251 offset:50176
    v_exp_f32 v215, v167
    v_mfma_f32_16x16x32_bf16 v[104:107], a[120:123], v[192:195], v[104:107]
    ds_read_b128 a[40:43], v224 offset:17024
    ds_read_b64_tr_b16 a[138:139], v251 offset:52224
    v_add_f32 v219, v214, v215
    v_mfma_f32_16x16x32_bf16 v[108:111], a[124:127], v[192:195], v[108:111]
    ds_read_b64_tr_b16 a[140:141], v252 offset:50176
    v_cvt_pk_bf16_f32 v187, v214, v215
    v_add_f32 v232, v232, v219
    v_cmp_nge_f32 vcc, s32, v232
    v_mfma_f32_16x16x32_bf16 v[176:179], a[0:3], v[144:147], v[204:207]
    ds_read_b128 a[56:59], v224 offset:17536
    ds_read_b64_tr_b16 a[142:143], v252 offset:52224
    v_exp_f32 v208, v168
    v_mfma_f32_16x16x32_bf16 v[180:183], a[16:19], v[144:147], v[204:207]
    s_cbranch_vccnz L_stub_163
L_back_164:
    v_exp_f32 v209, v169
    v_mfma_f32_16x16x32_bf16 v[176:179], a[4:7], v[148:151], v[176:179]
    ds_read_b128 a[44:47], v224 offset:17088
    v_add_f32 v220, v220, v232
    v_add_f32 v233, v208, v209
    v_mfma_f32_16x16x32_bf16 v[180:183], a[20:23], v[148:151], v[180:183]
    v_exp_f32 v210, v170
    v_exp_f32 v211, v171
    v_mfma_f32_16x16x32_bf16 v[176:179], a[8:11], v[152:155], v[176:179]
    s_waitcnt lgkmcnt(1)
    ds_read_b128 a[60:63], v224 offset:17600
    s_waitcnt vmcnt(8)
    s_add_u32 m0, s76, 49152
    v_cvt_pk_bf16_f32 v188, v208, v209
    v_mfma_f32_16x16x32_bf16 v[180:183], a[24:27], v[152:155], v[180:183]
    buffer_load_dwordx4 v247, s[64:67], s74 offen lds
    ds_read_b64_tr_b16 a[144:145], v242 offset:49152
    v_add_f32 v217, v210, v211
    v_mfma_f32_16x16x32_bf16 v[176:179], a[12:15], v[156:159], v[176:179]
    ds_read_b64_tr_b16 a[96:97], v225 offset:16896
    ds_read_b64_tr_b16 a[146:147], v242 offset:51200
    v_exp_f32 v212, v172
    v_mfma_f32_16x16x32_bf16 v[180:183], a[28:31], v[156:159], v[180:183]
    ds_read_b64_tr_b16 a[98:99], v225 offset:17408
    ds_read_b64_tr_b16 a[148:149], v243 offset:49152
    s_add_u32 m0, s76, 50176
    v_cvt_pk_bf16_f32 v189, v210, v211
    v_mfma_f32_16x16x32_bf16 v[16:19], a[64:67], v[184:187], v[16:19]
    buffer_load_dwordx4 v248, s[64:67], s74 offen lds
    ds_read_b64_tr_b16 a[100:101], v225 offset:16928
    ds_read_b64_tr_b16 a[150:151], v243 offset:51200
    v_add_f32 v233, v233, v217
    v_mfma_f32_16x16x32_bf16 v[20:23], a[68:71], v[184:187], v[20:23]
    ds_read_b64_tr_b16 a[152:153], v242 offset:50176
    v_exp_f32 v213, v173
    v_mfma_f32_16x16x32_bf16 v[24:27], a[72:75], v[184:187], v[24:27]
    s_add_u32 m0, s76, 51200
    ds_read_b64_tr_b16 a[102:103], v225 offset:17440
    ds_read_b64_tr_b16 a[154:155], v242 offset:52224
    v_exp_f32 v214, v174
    v_mfma_f32_16x16x32_bf16 v[28:31], a[76:79], v[184:187], v[28:31]
    buffer_load_dwordx4 v249, s[64:67], s74 offen lds
    ds_read_b64_tr_b16 a[104:105], v225 offset:16960
    ds_read_b64_tr_b16 a[156:157], v243 offset:50176
    v_add_f32 v218, v212, v213
    v_mfma_f32_16x16x32_bf16 v[32:35], a[80:83], v[184:187], v[32:35]
    ds_read_b64_tr_b16 a[106:107], v225 offset:17472
    ds_read_b64_tr_b16 a[158:159], v243 offset:52224
    v_exp_f32 v215, v175
    v_mfma_f32_16x16x32_bf16 v[36:39], a[84:87], v[184:187], v[36:39]
    s_add_u32 m0, s76, 52224
    v_cvt_pk_bf16_f32 v190, v212, v213
    v_add_f32 v233, v233, v218
    v_add_f32 v219, v214, v215
    v_cvt_pk_bf16_f32 v191, v214, v215
    v_mfma_f32_16x16x32_bf16 v[40:43], a[88:91], v[184:187], v[40:43]
    buffer_load_dwordx4 v250, s[64:67], s74 offen lds
    ds_read_b64_tr_b16 a[108:109], v225 offset:16992
    v_add_f32 v233, v233, v219
    v_mfma_f32_16x16x32_bf16 v[44:47], a[92:95], v[184:187], v[44:47]
    s_waitcnt lgkmcnt(15)
    s_add_u32 s74, s74, 36864
    s_cmp_eq_u32 s74, 1179648
    s_cselect_b32 s74, 0, s74
    v_cmp_nge_f32 vcc, s32, v233
    v_mfma_f32_16x16x32_bf16 v[160:163], a[32:35], v[112:115], v[196:199]
    s_waitcnt lgkmcnt(1)
    ds_read_b64_tr_b16 a[110:111], v225 offset:17504
    s_waitcnt vmcnt(8)
    s_add_u32 m0, s76, 114688
    v_exp_f32 v208, v176
    v_mfma_f32_16x16x32_bf16 v[164:167], a[48:51], v[112:115], v[196:199]
    s_cbranch_vccnz L_stub_165
L_back_166:
    buffer_load_dwordx4 v247, s[64:67], s74 offen lds
    ds_read_b64_tr_b16 a[160:161], v244 offset:0
    v_add_f32 v221, v221, v233
    v_mfma_f32_16x16x32_bf16 v[160:163], a[36:39], v[116:119], v[160:163]
    ds_read_b64_tr_b16 a[112:113], v225 offset:17024
    ds_read_b64_tr_b16 a[162:163], v244 offset:2048
    v_exp_f32 v209, v177
    v_mfma_f32_16x16x32_bf16 v[164:167], a[52:55], v[116:119], v[164:167]
    s_add_u32 m0, s76, 115712
    ds_read_b64_tr_b16 a[164:165], v245 offset:0
    v_add_f32 v234, v208, v209
    v_exp_f32 v210, v178
    v_mfma_f32_16x16x32_bf16 v[160:163], a[40:43], v[120:123], v[160:163]
    buffer_load_dwordx4 v248, s[64:67], s74 offen lds
    ds_read_b64_tr_b16 a[114:115], v225 offset:17536
    ds_read_b64_tr_b16 a[166:167], v245 offset:2048
    v_cvt_pk_bf16_f32 v192, v208, v209
    v_mfma_f32_16x16x32_bf16 v[164:167], a[56:59], v[120:123], v[164:167]
    ds_read_b64_tr_b16 a[116:117], v225 offset:17056
    ds_read_b64_tr_b16 a[168:169], v244 offset:1024
    v_exp_f32 v211, v179
    v_mfma_f32_16x16x32_bf16 v[160:163], a[44:47], v[124:127], v[160:163]
    s_add_u32 m0, s76, 116736
    ds_read_b64_tr_b16 a[118:119], v225 offset:17568
    ds_read_b64_tr_b16 a[170:171], v244 offset:3072
    v_add_f32 v217, v210, v211
    v_cvt_pk_bf16_f32 v193, v210, v211
    v_mfma_f32_16x16x32_bf16 v[164:167], a[60:63], v[124:127], v[164:167]
    buffer_load_dwordx4 v249, s[64:67], s74 offen lds
    ds_read_b64_tr_b16 a[172:173], v245 offset:1024
    v_add_f32 v234, v234, v217
    v_mfma_f32_16x16x32_bf16 v[48:51], a[64:67], v[188:191], v[48:51]
    ds_read_b64_tr_b16 a[120:121], v225 offset:17088
    ds_read_b64_tr_b16 a[174:175], v245 offset:3072
    v_exp_f32 v212, v180
    v_mfma_f32_16x16x32_bf16 v[52:55], a[68:71], v[188:191], v[52:55]
    s_add_u32 m0, s76, 117760
    v_exp_f32 v213, v181
    v_exp_f32 v214, v182
    v_mfma_f32_16x16x32_bf16 v[56:59], a[72:75], v[188:191], v[56:59]
    buffer_load_dwordx4 v250, s[64:67], s74 offen lds
    ds_read_b64_tr_b16 a[122:123], v225 offset:17600
    v_add_f32 v218, v212, v213
    v_mfma_f32_16x16x32_bf16 v[60:63], a[76:79], v[188:191], v[60:63]
    s_add_u32 s74, s74, 36864
    s_cmp_eq_u32 s74, 1179648
    s_cselect_b32 s74, 0, s74
    v_exp_f32 v215, v183
    v_mfma_f32_16x16x32_bf16 v[64:67], a[80:83], v[188:191], v[64:67]
    s_waitcnt lgkmcnt(1)
    ds_read_b64_tr_b16 a[124:125], v225 offset:17120
    s_waitcnt vmcnt(8)
    s_add_u32 m0, s76, 131072
    v_cvt_pk_bf16_f32 v194, v212, v213
    v_mfma_f32_16x16x32_bf16 v[68:71], a[84:87], v[188:191], v[68:71]
    buffer_load_dwordx4 v247, s[64:67], s74 offen lds
    ds_read_b64_tr_b16 a[176:177], v244 offset:16384
    v_add_f32 v234, v234, v218
    v_mfma_f32_16x16x32_bf16 v[72:75], a[88:91], v[188:191], v[72:75]
    ds_read_b64_tr_b16 a[126:127], v225 offset:17632
    ds_read_b64_tr_b16 a[178:179], v244 offset:18432
    v_add_f32 v219, v214, v215
    v_cvt_pk_bf16_f32 v195, v214, v215
    v_mfma_f32_16x16x32_bf16 v[76:79], a[92:95], v[188:191], v[76:79]
    ds_read_b64_tr_b16 a[180:181], v245 offset:16384
    s_add_u32 m0, s76, 132096
    v_add_f32 v234, v234, v219
    v_cmp_nge_f32 vcc, s32, v234
    v_mfma_f32_16x16x32_bf16 v[168:171], a[32:35], v[128:131], v[200:203]
    buffer_load_dwordx4 v248, s[64:67], s74 offen lds
    ds_read_b64_tr_b16 a[182:183], v245 offset:18432
    v_exp_f32 v208, v160
    v_mfma_f32_16x16x32_bf16 v[172:175], a[48:51], v[128:131], v[200:203]
    s_cbranch_vccnz L_stub_167
L_back_168:
    ds_read_b64_tr_b16 a[184:185], v244 offset:17408
    v_add_u32 v224, 0, v226
    v_mfma_f32_16x16x32_bf16 v[168:171], a[36:39], v[132:135], v[168:171]
    ds_read_b64_tr_b16 a[186:187], v244 offset:19456
    v_add_u32 v225, 0, v227
    v_exp_f32 v209, v161
    v_mfma_f32_16x16x32_bf16 v[172:175], a[52:55], v[132:135], v[172:175]
    s_waitcnt lgkmcnt(0)
    s_barrier
    ds_read_b64_tr_b16 a[188:189], v245 offset:17408
    v_add_f32 v222, v222, v234
    v_mfma_f32_16x16x32_bf16 v[168:171], a[40:43], v[136:139], v[168:171]
    s_add_u32 m0, s76, 133120
    ds_read_b128 a[0:3], v224 offset:0
    ds_read_b64_tr_b16 a[190:191], v245 offset:19456
    v_add_f32 v232, v208, v209
    v_mfma_f32_16x16x32_bf16 v[172:175], a[56:59], v[136:139], v[172:175]
    buffer_load_dwordx4 v249, s[64:67], s74 offen lds
    v_mfma_f32_16x16x32_bf16 v[168:171], a[44:47], v[140:143], v[168:171]
    ds_read_b128 a[16:19], v224 offset:512
    v_exp_f32 v210, v162
    v_mfma_f32_16x16x32_bf16 v[172:175], a[60:63], v[140:143], v[172:175]
    s_add_u32 m0, s76, 134144
    v_cvt_pk_bf16_f32 v184, v208, v209
    v_exp_f32 v211, v163
    v_mfma_f32_16x16x32_bf16 v[80:83], a[64:67], v[192:195], v[80:83]
    buffer_load_dwordx4 v250, s[64:67], s74 offen lds
    ds_read_b128 a[4:7], v224 offset:64
    v_add_f32 v217, v210, v211
    v_mfma_f32_16x16x32_bf16 v[84:87], a[68:71], v[192:195], v[84:87]
    s_add_u32 s74, s74, 36864
    s_cmp_eq_u32 s74, 1179648
    s_cselect_b32 s74, 0, s74
    v_exp_f32 v212, v164
    v_mfma_f32_16x16x32_bf16 v[88:91], a[72:75], v[192:195], v[88:91]
    s_add_u32 m0, s76, 65536
    ds_read_b128 a[20:23], v224 offset:576
    v_cvt_pk_bf16_f32 v185, v210, v211
    v_exp_f32 v213, v165
    v_mfma_f32_16x16x32_bf16 v[92:95], a[76:79], v[192:195], v[92:95]
    buffer_load_dwordx4 v247, s[64:67], s74 offen lds
    v_mfma_f32_16x16x32_bf16 v[96:99], a[80:83], v[192:195], v[96:99]
    ds_read_b128 a[8:11], v224 offset:128
    v_add_f32 v232, v232, v217
    v_add_f32 v218, v212, v213
    v_cvt_pk_bf16_f32 v186, v212, v213
    v_mfma_f32_16x16x32_bf16 v[100:103], a[84:87], v[192:195], v[100:103]
    s_add_u32 m0, s76, 66560
    v_exp_f32 v214, v166
    v_exp_f32 v215, v167
    v_mfma_f32_16x16x32_bf16 v[104:107], a[88:91], v[192:195], v[104:107]
    buffer_load_dwordx4 v248, s[64:67], s74 offen lds
    ds_read_b128 a[24:27], v224 offset:640
    v_add_f32 v232, v232, v218
    v_mfma_f32_16x16x32_bf16 v[108:111], a[92:95], v[192:195], v[108:111]
    v_add_f32 v219, v214, v215
    v_cvt_pk_bf16_f32 v187, v214, v215
    v_add_f32 v232, v232, v219
    v_cmp_nge_f32 vcc, s32, v232
    v_mfma_f32_16x16x32_bf16 v[176:179], a[32:35], v[144:147], v[204:207]
    s_add_u32 m0, s76, 67584
    ds_read_b128 a[12:15], v224 offset:192
    v_exp_f32 v208, v168
    v_mfma_f32_16x16x32_bf16 v[180:183], a[48:51], v[144:147], v[204:207]
    s_cbranch_vccnz L_stub_169
L_back_170:
    buffer_load_dwordx4 v249, s[64:67], s74 offen lds
    v_mfma_f32_16x16x32_bf16 v[176:179], a[36:39], v[148:151], v[176:179]
    s_waitcnt vmcnt(11)
    ds_read_b128 a[28:31], v224 offset:704
    v_exp_f32 v209, v169
    v_mfma_f32_16x16x32_bf16 v[180:183], a[52:55], v[148:151], v[180:183]
    s_add_u32 m0, s76, 68608
    ds_read_b64_tr_b16 a[192:193], v251 offset:49152
    v_exp_f32 v210, v170
    v_mfma_f32_16x16x32_bf16 v[176:179], a[40:43], v[152:155], v[176:179]
    buffer_load_dwordx4 v250, s[64:67], s74 offen lds
    ds_read_b64_tr_b16 a[64:65], v225 offset:0
    ds_read_b64_tr_b16 a[194:195], v251 offset:51200
    v_add_f32 v220, v220, v232
    v_mfma_f32_16x16x32_bf16 v[180:183], a[56:59], v[152:155], v[180:183]
    s_add_u32 s74, s74, 36864
    ds_read_b64_tr_b16 a[196:197], v252 offset:49152
    s_cmp_eq_u32 s74, 1179648
    s_cselect_b32 s74, 0, s74
    v_add_f32 v233, v208, v209
    v_mfma_f32_16x16x32_bf16 v[176:179], a[44:47], v[156:159], v[176:179]
    s_add_u32 m0, s76, 81920
    ds_read_b64_tr_b16 a[66:67], v225 offset:512
    ds_read_b64_tr_b16 a[198:199], v252 offset:51200
    v_exp_f32 v211, v171
    v_mfma_f32_16x16x32_bf16 v[180:183], a[60:63], v[156:159], v[180:183]
    buffer_load_dwordx4 v247, s[64:67], s74 offen lds
    ds_read_b64_tr_b16 a[200:201], v251 offset:50176
    v_cvt_pk_bf16_f32 v188, v208, v209
    v_mfma_f32_16x16x32_bf16 v[16:19], a[96:99], v[184:187], v[16:19]
    ds_read_b64_tr_b16 a[68:69], v225 offset:32
    ds_read_b64_tr_b16 a[202:203], v251 offset:52224
    v_add_f32 v217, v210, v211
    v_mfma_f32_16x16x32_bf16 v[20:23], a[100:103], v[184:187], v[20:23]
    s_add_u32 m0, s76, 82944
    ds_read_b64_tr_b16 a[204:205], v252 offset:50176
    v_cvt_pk_bf16_f32 v189, v210, v211
    v_exp_f32 v212, v172
    v_mfma_f32_16x16x32_bf16 v[24:27], a[104:107], v[184:187], v[24:27]
    buffer_load_dwordx4 v248, s[64:67], s74 offen lds
    ds_read_b64_tr_b16 a[70:71], v225 offset:544
    ds_read_b64_tr_b16 a[206:207], v252 offset:52224
    v_add_f32 v233, v233, v217
    v_mfma_f32_16x16x32_bf16 v[28:31], a[108:111], v[184:187], v[28:31]
    v_exp_f32 v213, v173
    v_exp_f32 v214, v174
    v_mfma_f32_16x16x32_bf16 v[32:35], a[112:115], v[184:187], v[32:35]
    s_add_u32 m0, s76, 83968
    ds_read_b64_tr_b16 a[72:73], v225 offset:64
    v_add_f32 v218, v212, v213
    v_exp_f32 v215, v175
    v_mfma_f32_16x16x32_bf16 v[36:39], a[116:119], v[184:187], v[36:39]
    buffer_load_dwordx4 v249, s[64:67], s74 offen lds
    v_mfma_f32_16x16x32_bf16 v[40:43], a[120:123], v[184:187], v[40:43]
    s_waitcnt vmcnt(11)
    v_cvt_pk_bf16_f32 v190, v212, v213
    v_add_f32 v233, v233, v218
    v_add_f32 v219, v214, v215
    v_cvt_pk_bf16_f32 v191, v214, v215
    v_mfma_f32_16x16x32_bf16 v[44:47], a[124:127], v[184:187], v[44:47]
    s_waitcnt lgkmcnt(13)
    ds_read_b64_tr_b16 a[208:209], v242 offset:49152
    s_add_u32 m0, s76, 84992
    v_add_f32 v233, v233, v219
    v_cmp_nge_f32 vcc, s32, v233
    v_mfma_f32_16x16x32_bf16 v[160:163], a[0:3], v[112:115], v[196:199]
    buffer_load_dwordx4 v250, s[64:67], s74 offen lds
    ds_read_b64_tr_b16 a[74:75], v225 offset:576
    ds_read_b64_tr_b16 a[210:211], v242 offset:51200
    v_exp_f32 v208, v176
    v_mfma_f32_16x16x32_bf16 v[164:167], a[16:19], v[112:115], v[196:199]
    s_add_u32 s74, s74, 36864
    s_cbranch_vccnz L_stub_171
L_back_172:
    ds_read_b64_tr_b16 a[212:213], v243 offset:49152
    s_cmp_eq_u32 s74, 1179648
    s_cselect_b32 s74, 0, s74
    v_add_f32 v221, v221, v233
    v_mfma_f32_16x16x32_bf16 v[160:163], a[4:7], v[116:119], v[160:163]
    s_waitcnt lgkmcnt(5)
    ds_read_b64_tr_b16 a[76:77], v225 offset:96
    ds_read_b64_tr_b16 a[214:215], v243 offset:51200
    s_add_u32 m0, s76, 49152
    v_exp_f32 v209, v177
    v_mfma_f32_16x16x32_bf16 v[164:167], a[20:23], v[116:119], v[164:167]
    s_mov_b32 s8, s48
    buffer_load_dwordx4 v247, s[64:67], s74 offen lds
    ds_read_b64_tr_b16 a[216:217], v242 offset:50176
    v_add_f32 v234, v208, v209
    v_mfma_f32_16x16x32_bf16 v[160:163], a[8:11], v[120:123], v[160:163]
    ds_read_b64_tr_b16 a[78:79], v225 offset:608
    ds_read_b64_tr_b16 a[218:219], v242 offset:52224
    v_exp_f32 v210, v178
    v_mfma_f32_16x16x32_bf16 v[164:167], a[24:27], v[120:123], v[164:167]
    s_and_b32 s9, s49, 0xffff
    ds_read_b64_tr_b16 a[220:221], v243 offset:50176
    s_add_u32 m0, s76, 50176
    v_exp_f32 v211, v179
    v_mfma_f32_16x16x32_bf16 v[160:163], a[12:15], v[124:127], v[160:163]
    buffer_load_dwordx4 v248, s[64:67], s74 offen lds
    ds_read_b64_tr_b16 a[80:81], v225 offset:128
    ds_read_b64_tr_b16 a[222:223], v243 offset:52224
    v_cvt_pk_bf16_f32 v192, v208, v209
    v_mfma_f32_16x16x32_bf16 v[164:167], a[28:31], v[124:127], v[164:167]
    s_mov_b32 s10, 256
    v_add_f32 v217, v210, v211
    v_cvt_pk_bf16_f32 v193, v210, v211
    v_mfma_f32_16x16x32_bf16 v[48:51], a[96:99], v[188:191], v[48:51]
    s_add_u32 m0, s76, 51200
    ds_read_b64_tr_b16 a[82:83], v225 offset:640
    v_exp_f32 v212, v180
    v_mfma_f32_16x16x32_bf16 v[52:55], a[100:103], v[188:191], v[52:55]
    s_mov_b32 s11, 0x20000
    buffer_load_dwordx4 v249, s[64:67], s74 offen lds
    v_mfma_f32_16x16x32_bf16 v[56:59], a[104:107], v[188:191], v[56:59]
    ds_read_b64_tr_b16 a[84:85], v225 offset:160
    v_add_f32 v234, v234, v217
    v_exp_f32 v213, v181
    v_mfma_f32_16x16x32_bf16 v[60:63], a[108:111], v[188:191], v[60:63]
    v_add_f32 v218, v212, v213
    v_cvt_pk_bf16_f32 v194, v212, v213
    v_exp_f32 v214, v182
    v_mfma_f32_16x16x32_bf16 v[64:67], a[112:115], v[188:191], v[64:67]
    s_waitcnt vmcnt(11)
    ds_read_b64_tr_b16 a[86:87], v225 offset:672
    v_add_f32 v234, v234, v218
    v_exp_f32 v215, v183
    v_mfma_f32_16x16x32_bf16 v[68:71], a[116:119], v[188:191], v[68:71]
    buffer_load_dwordx2 v[254:255], off, s[8:11], 0 sc1
    ds_read_b64_tr_b16 a[224:225], v244 offset:0
    v_add_f32 v219, v214, v215
    v_mfma_f32_16x16x32_bf16 v[72:75], a[120:123], v[188:191], v[72:75]
    s_add_u32 m0, s76, 52224
    ds_read_b64_tr_b16 a[88:89], v225 offset:192
    ds_read_b64_tr_b16 a[226:227], v244 offset:2048
    v_cvt_pk_bf16_f32 v195, v214, v215
    v_add_f32 v234, v234, v219
    v_mfma_f32_16x16x32_bf16 v[76:79], a[124:127], v[188:191], v[76:79]
    buffer_load_dwordx4 v250, s[64:67], s74 offen lds
    ds_read_b64_tr_b16 a[228:229], v245 offset:0
    v_cmp_nge_f32 vcc, s32, v234
    v_mfma_f32_16x16x32_bf16 v[168:171], a[0:3], v[128:131], v[200:203]
    s_add_u32 s74, s74, 36864
    ds_read_b64_tr_b16 a[90:91], v225 offset:704
    ds_read_b64_tr_b16 a[230:231], v245 offset:2048
    s_cmp_eq_u32 s74, 1179648
    s_cselect_b32 s74, 0, s74
    v_exp_f32 v208, v160
    v_mfma_f32_16x16x32_bf16 v[172:175], a[16:19], v[128:131], v[200:203]
    s_add_u32 s12, s50, 16777216
    s_cbranch_vccnz L_stub_173
L_back_174:
    ds_read_b64_tr_b16 a[232:233], v244 offset:1024
    s_addc_u32 s13, s51, 0
    v_add_f32 v222, v222, v234
    v_mfma_f32_16x16x32_bf16 v[168:171], a[4:7], v[132:135], v[168:171]
    s_add_u32 m0, s76, 98304
    ds_read_b64_tr_b16 a[92:93], v225 offset:224
    ds_read_b64_tr_b16 a[234:235], v244 offset:3072
    v_exp_f32 v209, v161
    v_mfma_f32_16x16x32_bf16 v[172:175], a[20:23], v[132:135], v[172:175]
    s_and_b32 s13, s13, 0xffff
    buffer_load_dwordx4 v247, s[64:67], s74 offen lds
    ds_read_b64_tr_b16 a[236:237], v245 offset:1024
    v_add_f32 v232, v208, v209
    v_mfma_f32_16x16x32_bf16 v[168:171], a[8:11], v[136:139], v[168:171]
    ds_read_b64_tr_b16 a[94:95], v225 offset:736
    ds_read_b64_tr_b16 a[238:239], v245 offset:3072
    v_exp_f32 v210, v162
    v_mfma_f32_16x16x32_bf16 v[172:175], a[24:27], v[136:139], v[172:175]
    s_mov_b32 s14, 8192
    s_add_u32 m0, s76, 99328
    v_cvt_pk_bf16_f32 v184, v208, v209
    v_exp_f32 v211, v163
    v_mfma_f32_16x16x32_bf16 v[168:171], a[12:15], v[140:143], v[168:171]
    buffer_load_dwordx4 v248, s[64:67], s74 offen lds
    ds_read_b128 a[32:35], v224 offset:16896
    v_add_f32 v217, v210, v211
    v_mfma_f32_16x16x32_bf16 v[172:175], a[28:31], v[140:143], v[172:175]
    s_mov_b32 s15, 0x20000
    v_cvt_pk_bf16_f32 v185, v210, v211
    v_exp_f32 v212, v164
    v_mfma_f32_16x16x32_bf16 v[80:83], a[96:99], v[192:195], v[80:83]
    s_waitcnt vmcnt(11)
    ds_read_b128 a[48:51], v224 offset:17408
    s_add_u32 m0, s76, 100352
    v_add_f32 v232, v232, v217
    v_exp_f32 v213, v165
    v_mfma_f32_16x16x32_bf16 v[84:87], a[100:103], v[192:195], v[84:87]
    buffer_load_dwordx4 v249, s[64:67], s74 offen lds
    ds_read_b64_tr_b16 a[240:241], v242 offset:0
    v_add_f32 v218, v212, v213
    v_mfma_f32_16x16x32_bf16 v[88:91], a[104:107], v[192:195], v[88:91]
    ds_read_b128 a[36:39], v224 offset:16960
    ds_read_b64_tr_b16 a[242:243], v242 offset:2048
    v_exp_f32 v214, v166
    v_mfma_f32_16x16x32_bf16 v[92:95], a[108:111], v[192:195], v[92:95]
    s_add_u32 m0, s76, 101376
    ds_read_b64_tr_b16 a[244:245], v243 offset:0
    v_cvt_pk_bf16_f32 v186, v212, v213
    v_exp_f32 v215, v167
    v_mfma_f32_16x16x32_bf16 v[96:99], a[112:115], v[192:195], v[96:99]
    buffer_load_dwordx4 v250, s[64:67], s74 offen lds
    ds_read_b128 a[52:55], v224 offset:17472
    ds_read_b64_tr_b16 a[246:247], v243 offset:2048
    v_add_f32 v232, v232, v218
    v_mfma_f32_16x16x32_bf16 v[100:103], a[116:119], v[192:195], v[100:103]
    s_add_u32 s74, s74, 36864
    ds_read_b64_tr_b16 a[248:249], v242 offset:1024
    s_cmp_eq_u32 s74, 1179648
    s_cselect_b32 s74, 0, s74
    v_add_f32 v219, v214, v215
    v_mfma_f32_16x16x32_bf16 v[104:107], a[120:123], v[192:195], v[104:107]
    s_waitcnt lgkmcnt(15)
    ds_read_b128 a[40:43], v224 offset:17024
    ds_read_b64_tr_b16 a[250:251], v242 offset:3072
    s_add_u32 m0, s76, 114688
    v_cvt_pk_bf16_f32 v187, v214, v215
    v_add_f32 v232, v232, v219
    v_mfma_f32_16x16x32_bf16 v[108:111], a[124:127], v[192:195], v[108:111]
    buffer_load_dwordx4 v247, s[64:67], s74 offen lds
    ds_read_b64_tr_b16 a[252:253], v243 offset:1024
    v_cmp_nge_f32 vcc, s32, v232
    v_mfma_f32_16x16x32_bf16 v[176:179], a[0:3], v[144:147], v[204:207]
    ds_read_b128 a[56:59], v224 offset:17536
    ds_read_b64_tr_b16 a[254:255], v243 offset:3072
    v_exp_f32 v208, v168
    v_mfma_f32_16x16x32_bf16 v[180:183], a[16:19], v[144:147], v[204:207]
    s_add_u32 m0, s76, 115712
    s_cbranch_vccnz L_stub_175
L_back_176:
    v_exp_f32 v209, v169
    v_mfma_f32_16x16x32_bf16 v[176:179], a[4:7], v[148:151], v[176:179]
    buffer_load_dwordx4 v248, s[64:67], s74 offen lds
    ds_read_b128 a[44:47], v224 offset:17088
    v_add_f32 v220, v220, v232
    v_mfma_f32_16x16x32_bf16 v[180:183], a[20:23], v[148:151], v[180:183]
    v_add_f32 v233, v208, v209
    v_exp_f32 v210, v170
    v_mfma_f32_16x16x32_bf16 v[176:179], a[8:11], v[152:155], v[176:179]
    s_add_u32 m0, s76, 116736
    ds_read_b128 a[60:63], v224 offset:17600
    v_cvt_pk_bf16_f32 v188, v208, v209
    v_exp_f32 v211, v171
    v_mfma_f32_16x16x32_bf16 v[180:183], a[24:27], v[152:155], v[180:183]
    buffer_load_dwordx4 v249, s[64:67], s74 offen lds
    v_mfma_f32_16x16x32_bf16 v[176:179], a[12:15], v[156:159], v[176:179]
    ds_read_b64_tr_b16 a[96:97], v225 offset:16896
    v_add_f32 v217, v210, v211
    v_exp_f32 v212, v172
    v_mfma_f32_16x16x32_bf16 v[180:183], a[28:31], v[156:159], v[180:183]
    s_waitcnt lgkmcnt(15)
    ds_read_b64_tr_b16 a[98:99], v225 offset:17408
    s_add_u32 m0, s76, 117760
    v_exp_f32 v213, v173
    v_mfma_f32_16x16x32_bf16 v[16:19], a[64:67], v[184:187], v[16:19]
    buffer_load_dwordx4 v250, s[64:67], s74 offen lds
    ds_read_b64_tr_b16 a[100:101], v225 offset:16928
    v_cvt_pk_bf16_f32 v189, v210, v211
    v_mfma_f32_16x16x32_bf16 v[20:23], a[68:71], v[184:187], v[20:23]
    s_waitcnt vmcnt(13)
    s_add_u32 s74, s74, 36864
    s_cmp_eq_u32 s74, 1179648
    s_cselect_b32 s74, 0, s74
    v_add_f32 v233, v233, v217
    v_mfma_f32_16x16x32_bf16 v[24:27], a[72:75], v[184:187], v[24:27]
    s_waitcnt lgkmcnt(5)
    ds_read_b64_tr_b16 a[102:103], v225 offset:17440
    ds_read_b64_tr_b16 a[0:1], v242 offset:16384
    s_add_u32 m0, s76, 65536
    v_add_f32 v218, v212, v213
    v_mfma_f32_16x16x32_bf16 v[28:31], a[76:79], v[184:187], v[28:31]
    buffer_load_dwordx4 v247, s[64:67], s74 offen lds
    ds_read_b64_tr_b16 a[104:105], v225 offset:16960
    ds_read_b64_tr_b16 a[2:3], v242 offset:18432
    v_cvt_pk_bf16_f32 v190, v212, v213
    v_mfma_f32_16x16x32_bf16 v[32:35], a[80:83], v[184:187], v[32:35]
    ds_read_b64_tr_b16 a[106:107], v225 offset:17472
    ds_read_b64_tr_b16 a[4:5], v243 offset:16384
    v_exp_f32 v214, v174
    v_mfma_f32_16x16x32_bf16 v[36:39], a[84:87], v[184:187], v[36:39]
    s_add_u32 m0, s76, 66560
    ds_read_b64_tr_b16 a[6:7], v243 offset:18432
    v_add_f32 v233, v233, v218
    v_exp_f32 v215, v175
    v_mfma_f32_16x16x32_bf16 v[40:43], a[88:91], v[184:187], v[40:43]
    buffer_load_dwordx4 v248, s[64:67], s74 offen lds
    ds_read_b64_tr_b16 a[108:109], v225 offset:16992
    ds_read_b64_tr_b16 a[8:9], v242 offset:17408
    v_add_f32 v219, v214, v215
    v_mfma_f32_16x16x32_bf16 v[44:47], a[92:95], v[184:187], v[44:47]
    s_waitcnt lgkmcnt(12)
    ds_read_b64_tr_b16 a[10:11], v242 offset:19456
    v_cvt_pk_bf16_f32 v191, v214, v215
    v_add_f32 v233, v233, v219
    v_cmp_nge_f32 vcc, s32, v233
    v_mfma_f32_16x16x32_bf16 v[160:163], a[32:35], v[112:115], v[196:199]
    s_add_u32 m0, s76, 67584
    ds_read_b64_tr_b16 a[110:111], v225 offset:17504
    ds_read_b64_tr_b16 a[12:13], v243 offset:17408
    v_exp_f32 v208, v176
    v_mfma_f32_16x16x32_bf16 v[164:167], a[48:51], v[112:115], v[196:199]
    s_cbranch_vccnz L_stub_177
L_back_178:
    buffer_load_dwordx4 v249, s[64:67], s74 offen lds
    ds_read_b64_tr_b16 a[14:15], v243 offset:19456
    v_add_f32 v221, v221, v233
    v_mfma_f32_16x16x32_bf16 v[160:163], a[36:39], v[116:119], v[160:163]
    ds_read_b64_tr_b16 a[112:113], v225 offset:17024
    v_exp_f32 v209, v177
    v_mfma_f32_16x16x32_bf16 v[164:167], a[52:55], v[116:119], v[164:167]
    s_waitcnt vmcnt(11)
    s_add_u32 m0, s76, 68608
    v_exp_f32 v210, v178
    v_mfma_f32_16x16x32_bf16 v[160:163], a[40:43], v[120:123], v[160:163]
    buffer_load_dwordx4 v250, s[64:67], s74 offen lds
    ds_read_b64_tr_b16 a[114:115], v225 offset:17536
    ds_read_b64_tr_b16 a[16:17], v251 offset:49152
    v_add_f32 v234, v208, v209
    v_mfma_f32_16x16x32_bf16 v[164:167], a[56:59], v[120:123], v[164:167]
    s_add_u32 s74, s74, 36864
    ds_read_b64_tr_b16 a[116:117], v225 offset:17056
    ds_read_b64_tr_b16 a[18:19], v251 offset:51200
    s_cmp_eq_u32 s74, 1179648
    s_cselect_b32 s74, 0, s74
    v_cvt_pk_bf16_f32 v192, v208, v209
    v_mfma_f32_16x16x32_bf16 v[160:163], a[44:47], v[124:127], v[160:163]
    s_waitcnt lgkmcnt(5)
    ds_read_b64_tr_b16 a[118:119], v225 offset:17568
    ds_read_b64_tr_b16 a[20:21], v252 offset:49152
    s_add_u32 m0, s76, 81920
    v_exp_f32 v211, v179
    v_mfma_f32_16x16x32_bf16 v[164:167], a[60:63], v[124:127], v[164:167]
    buffer_load_dwordx4 v247, s[64:67], s74 offen lds
    ds_read_b64_tr_b16 a[22:23], v252 offset:51200
    v_add_f32 v217, v210, v211
    v_mfma_f32_16x16x32_bf16 v[48:51], a[64:67], v[188:191], v[48:51]
    ds_read_b64_tr_b16 a[120:121], v225 offset:17088
    ds_read_b64_tr_b16 a[24:25], v251 offset:50176
    v_exp_f32 v212, v180
    v_mfma_f32_16x16x32_bf16 v[52:55], a[68:71], v[188:191], v[52:55]
    s_add_u32 m0, s76, 82944
    ds_read_b64_tr_b16 a[26:27], v251 offset:52224
    v_exp_f32 v213, v181
    v_mfma_f32_16x16x32_bf16 v[56:59], a[72:75], v[188:191], v[56:59]
    buffer_load_dwordx4 v248, s[64:67], s74 offen lds
    ds_read_b64_tr_b16 a[122:123], v225 offset:17600
    ds_read_b64_tr_b16 a[28:29], v252 offset:50176
    v_cvt_pk_bf16_f32 v193, v210, v211
    v_mfma_f32_16x16x32_bf16 v[60:63], a[76:79], v[188:191], v[60:63]
    ds_read_b64_tr_b16 a[30:31], v252 offset:52224
    v_add_f32 v234, v234, v217
    v_exp_f32 v214, v182
    v_mfma_f32_16x16x32_bf16 v[64:67], a[80:83], v[188:191], v[64:67]
    s_add_u32 m0, s76, 83968
    ds_read_b64_tr_b16 a[124:125], v225 offset:17120
    v_add_f32 v218, v212, v213
    v_exp_f32 v215, v183
    v_mfma_f32_16x16x32_bf16 v[68:71], a[84:87], v[188:191], v[68:71]
    buffer_load_dwordx4 v249, s[64:67], s74 offen lds
    v_mfma_f32_16x16x32_bf16 v[72:75], a[88:91], v[188:191], v[72:75]
    ds_read_b64_tr_b16 a[126:127], v225 offset:17632
    v_cvt_pk_bf16_f32 v194, v212, v213
    v_add_f32 v234, v234, v218
    v_add_f32 v219, v214, v215
    v_mfma_f32_16x16x32_bf16 v[76:79], a[92:95], v[188:191], v[76:79]
    s_add_u32 m0, s76, 84992
    v_cvt_pk_bf16_f32 v195, v214, v215
    v_add_f32 v234, v234, v219
    v_cmp_nge_f32 vcc, s32, v234
    v_mfma_f32_16x16x32_bf16 v[168:171], a[32:35], v[128:131], v[200:203]
    buffer_load_dwordx4 v250, s[64:67], s74 offen lds
    v_mfma_f32_16x16x32_bf16 v[172:175], a[48:51], v[128:131], v[200:203]
    s_add_u32 s74, s74, 36864
    s_cbranch_vccnz L_stub_179
L_back_180:
    s_cmp_eq_u32 s74, 1179648
    s_cselect_b32 s74, 0, s74
    v_mfma_f32_16x16x32_bf16 v[168:171], a[36:39], v[132:135], v[168:171]
    s_waitcnt lgkmcnt(2)
    v_add_f32 v222, v222, v234
    v_exp_f32 v208, v160
    v_mfma_f32_16x16x32_bf16 v[172:175], a[52:55], v[132:135], v[172:175]
    s_waitcnt lgkmcnt(0)
    s_barrier
    v_mfma_f32_16x16x32_bf16 v[168:171], a[40:43], v[136:139], v[168:171]
    s_add_u32 m0, s76, 49152
    v_exp_f32 v209, v161
    v_exp_f32 v210, v162
    v_mfma_f32_16x16x32_bf16 v[172:175], a[56:59], v[136:139], v[172:175]
    buffer_load_dwordx4 v247, s[64:67], s74 offen lds
    v_mfma_f32_16x16x32_bf16 v[168:171], a[44:47], v[140:143], v[168:171]
    v_add_f32 v232, v208, v209
    v_exp_f32 v211, v163
    v_mfma_f32_16x16x32_bf16 v[172:175], a[60:63], v[140:143], v[172:175]
    s_add_u32 m0, s76, 50176
    v_cvt_pk_bf16_f32 v184, v208, v209
    v_add_f32 v217, v210, v211
    v_mfma_f32_16x16x32_bf16 v[80:83], a[64:67], v[192:195], v[80:83]
    buffer_load_dwordx4 v248, s[64:67], s74 offen lds
    v_mfma_f32_16x16x32_bf16 v[84:87], a[68:71], v[192:195], v[84:87]
    v_cvt_pk_bf16_f32 v185, v210, v211
    v_add_f32 v232, v232, v217
    v_exp_f32 v212, v164
    v_mfma_f32_16x16x32_bf16 v[88:91], a[72:75], v[192:195], v[88:91]
    s_add_u32 m0, s76, 51200
    v_exp_f32 v213, v165
    v_exp_f32 v214, v166
    v_mfma_f32_16x16x32_bf16 v[92:95], a[76:79], v[192:195], v[92:95]
    buffer_load_dwordx4 v249, s[64:67], s74 offen lds
    v_mfma_f32_16x16x32_bf16 v[96:99], a[80:83], v[192:195], v[96:99]
    v_add_f32 v218, v212, v213
    v_cvt_pk_bf16_f32 v186, v212, v213
    v_exp_f32 v215, v167
    v_mfma_f32_16x16x32_bf16 v[100:103], a[84:87], v[192:195], v[100:103]
    s_add_u32 m0, s76, 52224
    v_add_f32 v232, v232, v218
    v_add_f32 v219, v214, v215
    v_cvt_pk_bf16_f32 v187, v214, v215
    v_add_f32 v232, v232, v219
    v_mfma_f32_16x16x32_bf16 v[104:107], a[88:91], v[192:195], v[104:107]
    buffer_load_dwordx4 v250, s[64:67], s74 offen lds
    v_mfma_f32_16x16x32_bf16 v[108:111], a[92:95], v[192:195], v[108:111]
    s_add_u32 s74, s74, 36864
    s_cmp_eq_u32 s74, 1179648
    s_cselect_b32 s74, 0, s74
    v_cmp_nge_f32 vcc, s32, v232
    v_mfma_f32_16x16x32_bf16 v[176:179], a[32:35], v[144:147], v[204:207]
    s_add_u32 m0, s76, 0
    v_exp_f32 v208, v168
    v_exp_f32 v209, v169
    v_mfma_f32_16x16x32_bf16 v[180:183], a[48:51], v[144:147], v[204:207]
    s_waitcnt vmcnt(12)
    s_cbranch_vccnz L_stub_181
L_back_182:
    buffer_load_dwordx4 v247, s[64:67], s74 offen lds
    v_mfma_f32_16x16x32_bf16 v[176:179], a[36:39], v[148:151], v[176:179]
    ds_read_b64_tr_b16 a[64:65], v242 offset:32768
    ds_read_b64_tr_b16 a[80:81], v242 offset:49152
    v_exp_f32 v210, v170
    v_mfma_f32_16x16x32_bf16 v[180:183], a[52:55], v[148:151], v[180:183]
    s_add_u32 m0, s76, 1024
    ds_read_b64_tr_b16 a[66:67], v242 offset:34816
    ds_read_b64_tr_b16 a[82:83], v242 offset:51200
    v_exp_f32 v211, v171
    v_mfma_f32_16x16x32_bf16 v[176:179], a[40:43], v[152:155], v[176:179]
    buffer_load_dwordx4 v248, s[64:67], s74 offen lds
    ds_read_b64_tr_b16 a[68:69], v243 offset:32768
    ds_read_b64_tr_b16 a[84:85], v243 offset:49152
    v_add_f32 v220, v220, v232
    v_mfma_f32_16x16x32_bf16 v[180:183], a[56:59], v[152:155], v[180:183]
    ds_read_b64_tr_b16 a[70:71], v243 offset:34816
    ds_read_b64_tr_b16 a[86:87], v243 offset:51200
    v_exp_f32 v212, v172
    v_mfma_f32_16x16x32_bf16 v[176:179], a[44:47], v[156:159], v[176:179]
    s_add_u32 m0, s76, 2048
    ds_read_b64_tr_b16 a[72:73], v242 offset:33792
    ds_read_b64_tr_b16 a[88:89], v242 offset:50176
    v_add_f32 v233, v208, v209
    v_exp_f32 v213, v173
    v_mfma_f32_16x16x32_bf16 v[180:183], a[60:63], v[156:159], v[180:183]
    buffer_load_dwordx4 v249, s[64:67], s74 offen lds
    ds_read_b64_tr_b16 a[74:75], v242 offset:35840
    ds_read_b64_tr_b16 a[90:91], v242 offset:52224
    v_cvt_pk_bf16_f32 v188, v208, v209
    v_mfma_f32_16x16x32_bf16 v[16:19], a[96:99], v[184:187], v[16:19]
    ds_read_b64_tr_b16 a[76:77], v243 offset:33792
    ds_read_b64_tr_b16 a[92:93], v243 offset:50176
    v_exp_f32 v214, v174
    v_mfma_f32_16x16x32_bf16 v[20:23], a[100:103], v[184:187], v[20:23]
    s_waitcnt vmcnt(11)
    ds_read_b64_tr_b16 a[78:79], v243 offset:35840
    ds_read_b64_tr_b16 a[94:95], v243 offset:52224
    s_add_u32 m0, s76, 3072
    v_add_f32 v217, v210, v211
    v_mfma_f32_16x16x32_bf16 v[24:27], a[104:107], v[184:187], v[24:27]
    buffer_load_dwordx4 v250, s[64:67], s74 offen lds
    ds_read_b64_tr_b16 a[32:33], v242 offset:0
    v_cvt_pk_bf16_f32 v189, v210, v211
    v_mfma_f32_16x16x32_bf16 v[28:31], a[108:111], v[184:187], v[28:31]
    s_add_u32 s74, s74, 36864
    ds_read_b64_tr_b16 a[34:35], v242 offset:2048
    s_cmp_eq_u32 s74, 1179648
    s_cselect_b32 s74, 0, s74
    v_add_f32 v233, v233, v217
    v_mfma_f32_16x16x32_bf16 v[32:35], a[112:115], v[184:187], v[32:35]
    s_add_u32 m0, s76, 16384
    ds_read_b64_tr_b16 a[36:37], v243 offset:0
    v_add_f32 v218, v212, v213
    v_exp_f32 v215, v175
    v_mfma_f32_16x16x32_bf16 v[36:39], a[116:119], v[184:187], v[36:39]
    buffer_load_dwordx4 v247, s[64:67], s74 offen lds
    ds_read_b64_tr_b16 a[38:39], v243 offset:2048
    v_cvt_pk_bf16_f32 v190, v212, v213
    v_mfma_f32_16x16x32_bf16 v[40:43], a[120:123], v[184:187], v[40:43]
    ds_read_b64_tr_b16 a[40:41], v242 offset:1024
    v_add_f32 v233, v233, v218
    v_add_f32 v219, v214, v215
    v_cvt_pk_bf16_f32 v191, v214, v215
    v_mfma_f32_16x16x32_bf16 v[44:47], a[124:127], v[184:187], v[44:47]
    ds_read_b64_tr_b16 a[42:43], v242 offset:3072
    s_add_u32 m0, s76, 17408
    v_add_f32 v233, v233, v219
    v_cmp_nge_f32 vcc, s32, v233
    s_cbranch_vccnz L_stub_183
L_back_184:
    v_mfma_f32_16x16x32_bf16 v[48:51], a[96:99], v[188:191], v[48:51]
    buffer_load_dwordx4 v248, s[64:67], s74 offen lds
    ds_read_b64_tr_b16 a[44:45], v243 offset:1024
    v_exp_f32 v208, v176
    v_mfma_f32_16x16x32_bf16 v[52:55], a[100:103], v[188:191], v[52:55]
    ds_read_b64_tr_b16 a[46:47], v243 offset:3072
    v_exp_f32 v209, v177
    v_exp_f32 v210, v178
    v_mfma_f32_16x16x32_bf16 v[56:59], a[104:107], v[188:191], v[56:59]
    s_add_u32 m0, s76, 18432
    v_add_f32 v221, v221, v233
    v_add_f32 v234, v208, v209
    v_exp_f32 v211, v179
    v_exp_f32 v212, v180
    v_mfma_f32_16x16x32_bf16 v[60:63], a[108:111], v[188:191], v[60:63]
    buffer_load_dwordx4 v249, s[64:67], s74 offen lds
    v_cvt_pk_bf16_f32 v192, v208, v209
    v_add_f32 v217, v210, v211
    v_mfma_f32_16x16x32_bf16 v[64:67], a[112:115], v[188:191], v[64:67]
    s_waitcnt vmcnt(11)
    v_cvt_pk_bf16_f32 v193, v210, v211
    v_add_f32 v234, v234, v217
    v_exp_f32 v213, v181
    v_exp_f32 v214, v182
    v_mfma_f32_16x16x32_bf16 v[68:71], a[116:119], v[188:191], v[68:71]
    s_add_u32 m0, s76, 19456
    ds_read_b64_tr_b16 a[48:49], v242 offset:16384
    v_add_f32 v218, v212, v213
    v_cvt_pk_bf16_f32 v194, v212, v213
    v_add_f32 v234, v234, v218
    v_exp_f32 v215, v183
    v_mfma_f32_16x16x32_bf16 v[72:75], a[120:123], v[188:191], v[72:75]
    buffer_load_dwordx4 v250, s[64:67], s74 offen lds
    ds_read_b64_tr_b16 a[50:51], v242 offset:18432
    v_add_f32 v219, v214, v215
    v_cvt_pk_bf16_f32 v195, v214, v215
    v_mfma_f32_16x16x32_bf16 v[76:79], a[124:127], v[188:191], v[76:79]
    ds_read_b64_tr_b16 a[52:53], v243 offset:16384
    s_add_u32 s74, s74, 36864
    s_cmp_eq_u32 s74, 1179648
    s_cselect_b32 s74, 0, s74
    v_add_f32 v234, v234, v219
    v_cmp_nge_f32 vcc, s32, v234
    s_cbranch_vccnz L_stub_185
L_back_186:
    v_mfma_f32_16x16x32_bf16 v[80:83], a[96:99], v[192:195], v[80:83]
    ds_read_b64_tr_b16 a[54:55], v243 offset:18432
    v_mfma_f32_16x16x32_bf16 v[84:87], a[100:103], v[192:195], v[84:87]
    ds_read_b64_tr_b16 a[56:57], v242 offset:17408
    v_mfma_f32_16x16x32_bf16 v[88:91], a[104:107], v[192:195], v[88:91]
    ds_read_b64_tr_b16 a[58:59], v242 offset:19456
    v_mfma_f32_16x16x32_bf16 v[92:95], a[108:111], v[192:195], v[92:95]
    ds_read_b64_tr_b16 a[60:61], v243 offset:17408
    v_mfma_f32_16x16x32_bf16 v[96:99], a[112:115], v[192:195], v[96:99]
    ds_read_b64_tr_b16 a[62:63], v243 offset:19456
    v_mfma_f32_16x16x32_bf16 v[100:103], a[116:119], v[192:195], v[100:103]
    v_mfma_f32_16x16x32_bf16 v[104:107], a[120:123], v[192:195], v[104:107]
    v_mfma_f32_16x16x32_bf16 v[108:111], a[124:127], v[192:195], v[108:111]
    v_add_f32 v222, v222, v234
    s_add_u32 m0, s76, 32768
    s_nop 0
    buffer_load_dwordx4 v247, s[64:67], s74 offen lds
    s_add_u32 m0, s76, 33792
    s_nop 0
    buffer_load_dwordx4 v248, s[64:67], s74 offen lds
    s_add_u32 m0, s76, 34816
    s_nop 0
    buffer_load_dwordx4 v249, s[64:67], s74 offen lds
    s_add_u32 m0, s76, 35840
    s_nop 0
    buffer_load_dwordx4 v250, s[64:67], s74 offen lds
    s_add_u32 s74, s74, 36864
    s_cmp_eq_u32 s74, 1179648
    s_cselect_b32 s74, 0, s74
    s_waitcnt lgkmcnt(8)
    s_add_u32 m0, s76, 65536
    s_nop 0
    buffer_load_dwordx4 v247, s[64:67], s74 offen lds
    s_add_u32 m0, s76, 66560
    s_nop 0
    buffer_load_dwordx4 v248, s[64:67], s74 offen lds
    s_add_u32 m0, s76, 67584
    s_nop 0
    buffer_load_dwordx4 v249, s[64:67], s74 offen lds
    s_add_u32 m0, s76, 68608
    s_nop 0
    buffer_load_dwordx4 v250, s[64:67], s74 offen lds
    s_add_u32 s74, s74, 36864
    s_cmp_eq_u32 s74, 1179648
    s_cselect_b32 s74, 0, s74
    v_mov_b32 v216, v220
    s_nop 1
    v_permlane32_swap_b32 v220, v216
    v_add_f32 v220, v220, v216
    v_mov_b32 v216, v220
    s_nop 1
    v_permlane16_swap_b32 v220, v216
    v_add_f32 v220, v220, v216
    v_rcp_f32 v218, v220
    s_nop 0
    v_pk_mul_f32 v[16:17], v[16:17], v[218:219] op_sel_hi:[1,0]
    v_pk_mul_f32 v[18:19], v[18:19], v[218:219] op_sel_hi:[1,0]
    v_pk_mul_f32 v[20:21], v[20:21], v[218:219] op_sel_hi:[1,0]
    v_pk_mul_f32 v[22:23], v[22:23], v[218:219] op_sel_hi:[1,0]
    v_pk_mul_f32 v[24:25], v[24:25], v[218:219] op_sel_hi:[1,0]
    v_pk_mul_f32 v[26:27], v[26:27], v[218:219] op_sel_hi:[1,0]
    v_pk_mul_f32 v[28:29], v[28:29], v[218:219] op_sel_hi:[1,0]
    v_pk_mul_f32 v[30:31], v[30:31], v[218:219] op_sel_hi:[1,0]
    v_pk_mul_f32 v[32:33], v[32:33], v[218:219] op_sel_hi:[1,0]
    v_pk_mul_f32 v[34:35], v[34:35], v[218:219] op_sel_hi:[1,0]
    v_pk_mul_f32 v[36:37], v[36:37], v[218:219] op_sel_hi:[1,0]
    v_pk_mul_f32 v[38:39], v[38:39], v[218:219] op_sel_hi:[1,0]
    v_pk_mul_f32 v[40:41], v[40:41], v[218:219] op_sel_hi:[1,0]
    v_pk_mul_f32 v[42:43], v[42:43], v[218:219] op_sel_hi:[1,0]
    v_pk_mul_f32 v[44:45], v[44:45], v[218:219] op_sel_hi:[1,0]
    v_pk_mul_f32 v[46:47], v[46:47], v[218:219] op_sel_hi:[1,0]
    v_cvt_pk_bf16_f32 v112, v16, v17
    v_cvt_pk_bf16_f32 v113, v18, v19
    v_cvt_pk_bf16_f32 v114, v20, v21
    v_cvt_pk_bf16_f32 v115, v22, v23
    buffer_store_dwordx4 v[112:115], v230, s[20:23], s56 offen offset:0 sc1
    v_cvt_pk_bf16_f32 v116, v24, v25
    v_cvt_pk_bf16_f32 v117, v26, v27
    v_cvt_pk_bf16_f32 v118, v28, v29
    v_cvt_pk_bf16_f32 v119, v30, v31
    buffer_store_dwordx4 v[116:119], v230, s[20:23], s56 offen offset:2048 sc1
    v_cvt_pk_bf16_f32 v120, v32, v33
    v_cvt_pk_bf16_f32 v121, v34, v35
    v_cvt_pk_bf16_f32 v122, v36, v37
    v_cvt_pk_bf16_f32 v123, v38, v39
    buffer_store_dwordx4 v[120:123], v231, s[20:23], s56 offen offset:0 sc1
    v_cvt_pk_bf16_f32 v124, v40, v41
    v_cvt_pk_bf16_f32 v125, v42, v43
    v_cvt_pk_bf16_f32 v126, v44, v45
    v_cvt_pk_bf16_f32 v127, v46, v47
    buffer_store_dwordx4 v[124:127], v231, s[20:23], s56 offen offset:2048 sc1
    s_waitcnt vmcnt(20)
    ds_read_b64_tr_b16 a[96:97], v251 offset:49152
    ds_read_b64_tr_b16 a[98:99], v251 offset:51200
    ds_read_b64_tr_b16 a[100:101], v252 offset:49152
    ds_read_b64_tr_b16 a[102:103], v252 offset:51200
    ds_read_b64_tr_b16 a[104:105], v251 offset:50176
    ds_read_b64_tr_b16 a[106:107], v251 offset:52224
    ds_read_b64_tr_b16 a[108:109], v252 offset:50176
    ds_read_b64_tr_b16 a[110:111], v252 offset:52224
    v_mov_b32 v216, v221
    s_nop 1
    v_permlane32_swap_b32 v221, v216
    v_add_f32 v221, v221, v216
    v_mov_b32 v216, v221
    s_nop 1
    v_permlane16_swap_b32 v221, v216
    v_add_f32 v221, v221, v216
    v_rcp_f32 v218, v221
    s_nop 0
    v_pk_mul_f32 v[48:49], v[48:49], v[218:219] op_sel_hi:[1,0]
    v_pk_mul_f32 v[50:51], v[50:51], v[218:219] op_sel_hi:[1,0]
    v_pk_mul_f32 v[52:53], v[52:53], v[218:219] op_sel_hi:[1,0]
    v_pk_mul_f32 v[54:55], v[54:55], v[218:219] op_sel_hi:[1,0]
    v_pk_mul_f32 v[56:57], v[56:57], v[218:219] op_sel_hi:[1,0]
    v_pk_mul_f32 v[58:59], v[58:59], v[218:219] op_sel_hi:[1,0]
    v_pk_mul_f32 v[60:61], v[60:61], v[218:219] op_sel_hi:[1,0]
    v_pk_mul_f32 v[62:63], v[62:63], v[218:219] op_sel_hi:[1,0]
    v_pk_mul_f32 v[64:65], v[64:65], v[218:219] op_sel_hi:[1,0]
    v_pk_mul_f32 v[66:67], v[66:67], v[218:219] op_sel_hi:[1,0]
    v_pk_mul_f32 v[68:69], v[68:69], v[218:219] op_sel_hi:[1,0]
    v_pk_mul_f32 v[70:71], v[70:71], v[218:219] op_sel_hi:[1,0]
    v_pk_mul_f32 v[72:73], v[72:73], v[218:219] op_sel_hi:[1,0]
    v_pk_mul_f32 v[74:75], v[74:75], v[218:219] op_sel_hi:[1,0]
    v_pk_mul_f32 v[76:77], v[76:77], v[218:219] op_sel_hi:[1,0]
    v_pk_mul_f32 v[78:79], v[78:79], v[218:219] op_sel_hi:[1,0]
    v_cvt_pk_bf16_f32 v128, v48, v49
    v_cvt_pk_bf16_f32 v129, v50, v51
    v_cvt_pk_bf16_f32 v130, v52, v53
    v_cvt_pk_bf16_f32 v131, v54, v55
    buffer_store_dwordx4 v[128:131], v230, s[20:23], s57 offen offset:0 sc1
    v_cvt_pk_bf16_f32 v132, v56, v57
    v_cvt_pk_bf16_f32 v133, v58, v59
    v_cvt_pk_bf16_f32 v134, v60, v61
    v_cvt_pk_bf16_f32 v135, v62, v63
    buffer_store_dwordx4 v[132:135], v230, s[20:23], s57 offen offset:2048 sc1
    v_cvt_pk_bf16_f32 v136, v64, v65
    v_cvt_pk_bf16_f32 v137, v66, v67
    v_cvt_pk_bf16_f32 v138, v68, v69
    v_cvt_pk_bf16_f32 v139, v70, v71
    buffer_store_dwordx4 v[136:139], v231, s[20:23], s57 offen offset:0 sc1
    v_cvt_pk_bf16_f32 v140, v72, v73
    v_cvt_pk_bf16_f32 v141, v74, v75
    v_cvt_pk_bf16_f32 v142, v76, v77
    v_cvt_pk_bf16_f32 v143, v78, v79
    buffer_store_dwordx4 v[140:143], v231, s[20:23], s57 offen offset:2048 sc1
    s_waitcnt vmcnt(20)
    ds_read_b64_tr_b16 a[112:113], v251 offset:0
    ds_read_b64_tr_b16 a[114:115], v251 offset:2048
    ds_read_b64_tr_b16 a[116:117], v252 offset:0
    ds_read_b64_tr_b16 a[118:119], v252 offset:2048
    ds_read_b64_tr_b16 a[120:121], v251 offset:1024
    ds_read_b64_tr_b16 a[122:123], v251 offset:3072
    ds_read_b64_tr_b16 a[124:125], v252 offset:1024
    ds_read_b64_tr_b16 a[126:127], v252 offset:3072
    v_mov_b32 v216, v222
    s_nop 1
    v_permlane32_swap_b32 v222, v216
    v_add_f32 v222, v222, v216
    v_mov_b32 v216, v222
    s_nop 1
    v_permlane16_swap_b32 v222, v216
    v_add_f32 v222, v222, v216
    v_rcp_f32 v218, v222
    s_nop 0
    v_pk_mul_f32 v[80:81], v[80:81], v[218:219] op_sel_hi:[1,0]
    v_pk_mul_f32 v[82:83], v[82:83], v[218:219] op_sel_hi:[1,0]
    v_pk_mul_f32 v[84:85], v[84:85], v[218:219] op_sel_hi:[1,0]
    v_pk_mul_f32 v[86:87], v[86:87], v[218:219] op_sel_hi:[1,0]
    v_pk_mul_f32 v[88:89], v[88:89], v[218:219] op_sel_hi:[1,0]
    v_pk_mul_f32 v[90:91], v[90:91], v[218:219] op_sel_hi:[1,0]
    v_pk_mul_f32 v[92:93], v[92:93], v[218:219] op_sel_hi:[1,0]
    v_pk_mul_f32 v[94:95], v[94:95], v[218:219] op_sel_hi:[1,0]
    v_pk_mul_f32 v[96:97], v[96:97], v[218:219] op_sel_hi:[1,0]
    v_pk_mul_f32 v[98:99], v[98:99], v[218:219] op_sel_hi:[1,0]
    v_pk_mul_f32 v[100:101], v[100:101], v[218:219] op_sel_hi:[1,0]
    v_pk_mul_f32 v[102:103], v[102:103], v[218:219] op_sel_hi:[1,0]
    v_pk_mul_f32 v[104:105], v[104:105], v[218:219] op_sel_hi:[1,0]
    v_pk_mul_f32 v[106:107], v[106:107], v[218:219] op_sel_hi:[1,0]
    v_pk_mul_f32 v[108:109], v[108:109], v[218:219] op_sel_hi:[1,0]
    v_pk_mul_f32 v[110:111], v[110:111], v[218:219] op_sel_hi:[1,0]
    v_cvt_pk_bf16_f32 v144, v80, v81
    v_cvt_pk_bf16_f32 v145, v82, v83
    v_cvt_pk_bf16_f32 v146, v84, v85
    v_cvt_pk_bf16_f32 v147, v86, v87
    buffer_store_dwordx4 v[144:147], v230, s[20:23], s58 offen offset:0 sc1
    v_cvt_pk_bf16_f32 v148, v88, v89
    v_cvt_pk_bf16_f32 v149, v90, v91
    v_cvt_pk_bf16_f32 v150, v92, v93
    v_cvt_pk_bf16_f32 v151, v94, v95
    buffer_store_dwordx4 v[148:151], v230, s[20:23], s58 offen offset:2048 sc1
    v_cvt_pk_bf16_f32 v152, v96, v97
    v_cvt_pk_bf16_f32 v153, v98, v99
    v_cvt_pk_bf16_f32 v154, v100, v101
    v_cvt_pk_bf16_f32 v155, v102, v103
    buffer_store_dwordx4 v[152:155], v231, s[20:23], s58 offen offset:0 sc1
    v_cvt_pk_bf16_f32 v156, v104, v105
    v_cvt_pk_bf16_f32 v157, v106, v107
    v_cvt_pk_bf16_f32 v158, v108, v109
    v_cvt_pk_bf16_f32 v159, v110, v111
    buffer_store_dwordx4 v[156:159], v231, s[20:23], s58 offen offset:2048 sc1
    s_mov_b32 s52, 0
    v_mov_b32 v8, 0
L_tok:
    v_readfirstlane_b32 s53, v254
    s_nop 0
    s_cmp_lg_u32 s53, 0
    s_cbranch_scc1 L_tok_ok
    buffer_load_dwordx2 v[254:255], off, s[8:11], 0 sc1
    s_add_u32 s52, s52, 1
    s_cmp_lt_u32 s52, 0x40000
    s_waitcnt vmcnt(0)
    s_cbranch_scc1 L_tok
L_tok_ok:
    s_lshl_b32 s53, s25, 5
    s_add_u32 s53, s53, s26
    s_lshl_b32 s53, s53, 2
    s_add_u32 s53, s53, s24
    s_lshl_b32 s53, s53, 3
    s_waitcnt vmcnt(20)
    ds_read_b64_tr_b16 v[144:145], v251 offset:16384
    ds_read_b64_tr_b16 v[146:147], v251 offset:18432
    ds_read_b64_tr_b16 v[148:149], v252 offset:16384
    ds_read_b64_tr_b16 v[150:151], v252 offset:18432
    ds_read_b64_tr_b16 v[152:153], v251 offset:17408
    ds_read_b64_tr_b16 v[154:155], v251 offset:19456
    ds_read_b64_tr_b16 v[156:157], v252 offset:17408
    ds_read_b64_tr_b16 v[158:159], v252 offset:19456
    s_waitcnt vmcnt(0)
    s_mov_b64 exec, 1
    buffer_store_dwordx2 v[254:255], v8, s[12:15], s53 offen sc1
    s_mov_b64 exec, -1
    s_cmp_eq_u32 s77, 0
    s_cbranch_scc1 L_fin
    v_add_u32 v6, 0x40000, v246
    s_waitcnt lgkmcnt(15)
    s_add_u32 m0, s76, 81920
    s_nop 0
    buffer_load_dwordx4 v247, s[64:67], s74 offen lds
    s_add_u32 m0, s76, 82944
    s_nop 0
    buffer_load_dwordx4 v248, s[64:67], s74 offen lds
    s_add_u32 m0, s76, 83968
    s_nop 0
    buffer_load_dwordx4 v249, s[64:67], s74 offen lds
    s_add_u32 m0, s76, 84992
    s_nop 0
    buffer_load_dwordx4 v250, s[64:67], s74 offen lds
    s_add_u32 s74, s74, 36864
    s_cmp_eq_u32 s74, 1179648
    s_cselect_b32 s74, 0, s74
    s_add_u32 m0, s76, 98304
    s_nop 0
    buffer_load_dwordx4 v247, s[64:67], s74 offen lds
    s_add_u32 m0, s76, 99328
    s_nop 0
    buffer_load_dwordx4 v248, s[64:67], s74 offen lds
    s_add_u32 m0, s76, 100352
    s_nop 0
    buffer_load_dwordx4 v249, s[64:67], s74 offen lds
    s_add_u32 m0, s76, 101376
    s_nop 0
    buffer_load_dwordx4 v250, s[64:67], s74 offen lds
    s_add_u32 s74, s74, 36864
    s_cmp_eq_u32 s74, 1179648
    s_cselect_b32 s74, 0, s74
    s_add_u32 m0, s76, 114688
    s_nop 0
    buffer_load_dwordx4 v247, s[64:67], s74 offen lds
    s_add_u32 m0, s76, 115712
    s_nop 0
    buffer_load_dwordx4 v248, s[64:67], s74 offen lds
    s_add_u32 m0, s76, 116736
    s_nop 0
    buffer_load_dwordx4 v249, s[64:67], s74 offen lds
    s_add_u32 m0, s76, 117760
    s_nop 0
    buffer_load_dwordx4 v250, s[64:67], s74 offen lds
    s_add_u32 s74, s74, 36864
    s_cmp_eq_u32 s74, 1179648
    s_cselect_b32 s74, 0, s74
    s_add_u32 m0, s76, 131072
    s_nop 0
    buffer_load_dwordx4 v247, s[64:67], s74 offen lds
    s_add_u32 m0, s76, 132096
    s_nop 0
    buffer_load_dwordx4 v248, s[64:67], s74 offen lds
    s_add_u32 m0, s76, 133120
    s_nop 0
    buffer_load_dwordx4 v249, s[64:67], s74 offen lds
    s_add_u32 m0, s76, 134144
    s_nop 0
    buffer_load_dwordx4 v250, s[64:67], s74 offen lds
    s_add_u32 s74, s74, 36864
    s_cmp_eq_u32 s74, 1179648
    s_cselect_b32 s74, 0, s74
    s_add_u32 m0, s76, 147456
    s_nop 0
    buffer_load_dwordx4 v247, s[64:67], s74 offen lds
    s_add_u32 m0, s76, 148480
    s_nop 0
    buffer_load_dwordx4 v248, s[64:67], s74 offen lds
    s_add_u32 m0, s76, 149504
    s_nop 0
    buffer_load_dwordx4 v249, s[64:67], s74 offen lds
    s_add_u32 m0, s76, 150528
    s_nop 0
    buffer_load_dwordx4 v250, s[64:67], s74 offen lds
    s_add_u32 s74, s74, 36864
    s_cmp_eq_u32 s74, 1179648
    s_cselect_b32 s74, 0, s74
    s_add_u32 m0, s76, 49152
    s_nop 0
    buffer_load_dwordx4 v247, s[64:67], s74 offen lds
    s_add_u32 m0, s76, 50176
    s_nop 0
    buffer_load_dwordx4 v248, s[64:67], s74 offen lds
    s_add_u32 m0, s76, 51200
    s_nop 0
    buffer_load_dwordx4 v249, s[64:67], s74 offen lds
    s_add_u32 m0, s76, 52224
    s_nop 0
    buffer_load_dwordx4 v250, s[64:67], s74 offen lds
    s_add_u32 s74, s74, 36864
    s_cmp_eq_u32 s74, 1179648
    s_cselect_b32 s74, 0, s74
    s_waitcnt lgkmcnt(8)
    s_add_u32 m0, s76, 0
    s_nop 0
    buffer_load_dwordx4 v247, s[64:67], s74 offen lds
    s_add_u32 m0, s76, 1024
    s_nop 0
    buffer_load_dwordx4 v248, s[64:67], s74 offen lds
    s_add_u32 m0, s76, 2048
    s_nop 0
    buffer_load_dwordx4 v249, s[64:67], s74 offen lds
    s_add_u32 m0, s76, 3072
    s_nop 0
    buffer_load_dwordx4 v250, s[64:67], s74 offen lds
    s_add_u32 s74, s74, 36864
    s_cmp_eq_u32 s74, 1179648
    s_cselect_b32 s74, 0, s74
    s_waitcnt lgkmcnt(0)
    s_add_u32 m0, s76, 16384
    s_nop 0
    buffer_load_dwordx4 v247, s[64:67], s74 offen lds
    s_add_u32 m0, s76, 17408
    s_nop 0
    buffer_load_dwordx4 v248, s[64:67], s74 offen lds
    s_add_u32 m0, s76, 18432
    s_nop 0
    buffer_load_dwordx4 v249, s[64:67], s74 offen lds
    s_add_u32 m0, s76, 19456
    s_nop 0
    buffer_load_dwordx4 v250, s[64:67], s74 offen lds
    s_add_u32 s74, s74, 36864
    s_cmp_eq_u32 s74, 1179648
    s_cselect_b32 s74, 0, s74
    ds_read_b64_tr_b16 v[160:161], v251 offset:32768
    ds_read_b64_tr_b16 v[162:163], v251 offset:34816
    ds_read_b64_tr_b16 v[164:165], v252 offset:32768
    ds_read_b64_tr_b16 v[166:167], v252 offset:34816
    ds_read_b64_tr_b16 v[168:169], v251 offset:33792
    ds_read_b64_tr_b16 v[170:171], v251 offset:35840
    ds_read_b64_tr_b16 v[172:173], v252 offset:33792
    ds_read_b64_tr_b16 v[174:175], v252 offset:35840
    s_waitcnt lgkmcnt(0)
    s_add_u32 m0, s76, 32768
    s_nop 0
    buffer_load_dwordx4 v247, s[64:67], s74 offen lds
    s_add_u32 m0, s76, 33792
    s_nop 0
    buffer_load_dwordx4 v248, s[64:67], s74 offen lds
    s_add_u32 m0, s76, 34816
    s_nop 0
    buffer_load_dwordx4 v249, s[64:67], s74 offen lds
    s_add_u32 m0, s76, 35840
    s_nop 0
    buffer_load_dwordx4 v250, s[64:67], s74 offen lds
    s_add_u32 s74, s74, 36864
    s_cmp_eq_u32 s74, 1179648
    s_cselect_b32 s74, 0, s74
    ds_read_b64_tr_b16 v[176:177], v242 offset:0
    ds_read_b64_tr_b16 v[178:179], v242 offset:2048
    ds_read_b64_tr_b16 v[180:181], v243 offset:0
    ds_read_b64_tr_b16 v[182:183], v243 offset:2048
    ds_read_b64_tr_b16 v[184:185], v242 offset:1024
    ds_read_b64_tr_b16 v[186:187], v242 offset:3072
    ds_read_b64_tr_b16 v[188:189], v243 offset:1024
    ds_read_b64_tr_b16 v[190:191], v243 offset:3072
    s_waitcnt lgkmcnt(0)
    s_add_u32 m0, s76, 65536
    s_nop 0
    buffer_load_dwordx4 v247, s[64:67], s74 offen lds
    s_add_u32 m0, s76, 66560
    s_nop 0
    buffer_load_dwordx4 v248, s[64:67], s74 offen lds
    s_add_u32 m0, s76, 67584
    s_nop 0
    buffer_load_dwordx4 v249, s[64:67], s74 offen lds
    s_add_u32 m0, s76, 68608
    s_nop 0
    buffer_load_dwordx4 v250, s[64:67], s74 offen lds
    s_add_u32 s74, s74, 36864
    s_cmp_eq_u32 s74, 1179648
    s_cselect_b32 s74, 0, s74
    s_waitcnt vmcnt(36)
    ds_read_b64_tr_b16 v[192:193], v242 offset:16384
    ds_read_b64_tr_b16 v[194:195], v242 offset:18432
    ds_read_b64_tr_b16 v[196:197], v243 offset:16384
    ds_read_b64_tr_b16 v[198:199], v243 offset:18432
    ds_read_b64_tr_b16 v[200:201], v242 offset:17408
    ds_read_b64_tr_b16 v[202:203], v242 offset:19456
    ds_read_b64_tr_b16 v[204:205], v243 offset:17408
    ds_read_b64_tr_b16 v[206:207], v243 offset:19456
    s_waitcnt lgkmcnt(0)
    s_add_u32 m0, s76, 81920
    s_nop 0
    buffer_load_dwordx4 v247, s[64:67], s74 offen lds
    s_add_u32 m0, s76, 82944
    s_nop 0
    buffer_load_dwordx4 v248, s[64:67], s74 offen lds
    s_add_u32 m0, s76, 83968
    s_nop 0
    buffer_load_dwordx4 v249, s[64:67], s74 offen lds
    s_add_u32 m0, s76, 84992
    s_nop 0
    buffer_load_dwordx4 v250, s[64:67], s74 offen lds
    s_add_u32 s74, s74, 36864
    s_cmp_eq_u32 s74, 1179648
    s_cselect_b32 s74, 0, s74
    buffer_load_dwordx2 v[4:5], v253, s[12:15], 0 offen sc1
    s_waitcnt vmcnt(37)
    ds_read_b64_tr_b16 v[208:209], v242 offset:32768
    ds_read_b64_tr_b16 v[210:211], v242 offset:34816
    ds_read_b64_tr_b16 v[212:213], v243 offset:32768
    ds_read_b64_tr_b16 v[214:215], v243 offset:34816
    ds_read_b64_tr_b16 v[216:217], v242 offset:33792
    ds_read_b64_tr_b16 v[218:219], v242 offset:35840
    ds_read_b64_tr_b16 v[220:221], v243 offset:33792
    ds_read_b64_tr_b16 v[222:223], v243 offset:35840
    s_waitcnt lgkmcnt(0)
    s_add_u32 m0, s76, 98304
    s_nop 0
    buffer_load_dwordx4 v247, s[64:67], s74 offen lds
    s_add_u32 m0, s76, 99328
    s_nop 0
    buffer_load_dwordx4 v248, s[64:67], s74 offen lds
    s_add_u32 m0, s76, 100352
    s_nop 0
    buffer_load_dwordx4 v249, s[64:67], s74 offen lds
    s_add_u32 m0, s76, 101376
    s_nop 0
    buffer_load_dwordx4 v250, s[64:67], s74 offen lds
    s_add_u32 s74, s74, 36864
    s_cmp_eq_u32 s74, 1179648
    s_cselect_b32 s74, 0, s74
    s_waitcnt vmcnt(37)
    ds_read_b64_tr_b16 v[224:225], v242 offset:49152
    ds_read_b64_tr_b16 v[226:227], v242 offset:51200
    ds_read_b64_tr_b16 v[228:229], v243 offset:49152
    ds_read_b64_tr_b16 v[230:231], v243 offset:51200
    ds_read_b64_tr_b16 v[232:233], v242 offset:50176
    ds_read_b64_tr_b16 v[234:235], v242 offset:52224
    ds_read_b64_tr_b16 v[236:237], v243 offset:50176
    ds_read_b64_tr_b16 v[238:239], v243 offset:52224
    s_waitcnt lgkmcnt(0)
    s_add_u32 m0, s76, 114688
    s_nop 0
    buffer_load_dwordx4 v247, s[64:67], s74 offen lds
    s_add_u32 m0, s76, 115712
    s_nop 0
    buffer_load_dwordx4 v248, s[64:67], s74 offen lds
    s_add_u32 m0, s76, 116736
    s_nop 0
    buffer_load_dwordx4 v249, s[64:67], s74 offen lds
    s_add_u32 m0, s76, 117760
    s_nop 0
    buffer_load_dwordx4 v250, s[64:67], s74 offen lds
    s_add_u32 s74, s74, 36864
    s_cmp_eq_u32 s74, 1179648
    s_cselect_b32 s74, 0, s74
    s_mov_b32 s52, 0
    s_waitcnt vmcnt(8)
L_poll:
    v_cmp_eq_u64 vcc, v[4:5], v[254:255]
    s_and_b32 s53, vcc_lo, s78
    s_cmp_eq_u32 s53, s78
    s_cbranch_scc1 L_poll_ok
    buffer_load_dwordx2 v[4:5], v253, s[12:15], 0 offen sc1
    s_add_u32 s52, s52, 1
    s_cmp_lt_u32 s52, 0x40000
    s_waitcnt vmcnt(0)
    s_cbranch_scc1 L_poll
L_poll_ok:
    buffer_load_dwordx4 v[80:83], v246, s[68:71], s75 offen offset:0 sc1
    buffer_load_dwordx4 v[84:87], v6, s[68:71], s75 offen offset:0 sc1
    buffer_load_dwordx4 v[88:91], v246, s[68:71], s75 offen offset:1024 sc1
    buffer_load_dwordx4 v[92:95], v6, s[68:71], s75 offen offset:1024 sc1
    s_add_u32 s75, s75, 2048
    s_and_b32 s75, s75, 0xffff
    buffer_load_dwordx4 v[96:99], v246, s[68:71], s75 offen offset:0 sc1
    buffer_load_dwordx4 v[100:103], v6, s[68:71], s75 offen offset:0 sc1
    buffer_load_dwordx4 v[104:107], v246, s[68:71], s75 offen offset:1024 sc1
    buffer_load_dwordx4 v[108:111], v6, s[68:71], s75 offen offset:1024 sc1
    s_add_u32 s75, s75, 2048
    s_and_b32 s75, s75, 0xffff
    buffer_load_dwordx4 v[112:115], v246, s[68:71], s75 offen offset:0 sc1
    buffer_load_dwordx4 v[116:119], v6, s[68:71], s75 offen offset:0 sc1
    buffer_load_dwordx4 v[120:123], v246, s[68:71], s75 offen offset:1024 sc1
    buffer_load_dwordx4 v[124:127], v6, s[68:71], s75 offen offset:1024 sc1
    s_add_u32 s75, s75, 2048
    s_and_b32 s75, s75, 0xffff
    s_waitcnt vmcnt(8)
    v_mfma_f32_32x32x16_bf16 v[16:31], a[128:131], v[80:83], 0
    buffer_load_dwordx4 v[128:131], v246, s[68:71], s75 offen offset:0 sc1
    v_mfma_f32_32x32x16_bf16 v[32:47], a[128:131], v[84:87], 0
    v_mfma_f32_32x32x16_bf16 v[48:63], a[132:135], v[80:83], 0
    buffer_load_dwordx4 v[132:135], v6, s[68:71], s75 offen offset:0 sc1
    v_mfma_f32_32x32x16_bf16 v[64:79], a[132:135], v[84:87], 0
    v_mfma_f32_32x32x16_bf16 v[16:31], a[136:139], v[88:91], v[16:31]
    buffer_load_dwordx4 v[136:139], v246, s[68:71], s75 offen offset:1024 sc1
    v_mfma_f32_32x32x16_bf16 v[32:47], a[136:139], v[92:95], v[32:47]
    v_mfma_f32_32x32x16_bf16 v[48:63], a[140:143], v[88:91], v[48:63]
    buffer_load_dwordx4 v[140:143], v6, s[68:71], s75 offen offset:1024 sc1
    v_mfma_f32_32x32x16_bf16 v[64:79], a[140:143], v[92:95], v[64:79]
    s_add_u32 s75, s75, 2048
    s_and_b32 s75, s75, 0xffff
    s_waitcnt vmcnt(8)
    v_mfma_f32_32x32x16_bf16 v[16:31], a[144:147], v[96:99], v[16:31]
    buffer_load_dwordx4 v[80:83], v246, s[68:71], s75 offen offset:0 sc1
    v_mfma_f32_32x32x16_bf16 v[32:47], a[144:147], v[100:103], v[32:47]
    v_mfma_f32_32x32x16_bf16 v[48:63], a[148:151], v[96:99], v[48:63]
    buffer_load_dwordx4 v[84:87], v6, s[68:71], s75 offen offset:0 sc1
    v_mfma_f32_32x32x16_bf16 v[64:79], a[148:151], v[100:103], v[64:79]
    v_mfma_f32_32x32x16_bf16 v[16:31], a[152:155], v[104:107], v[16:31]
    buffer_load_dwordx4 v[88:91], v246, s[68:71], s75 offen offset:1024 sc1
    v_mfma_f32_32x32x16_bf16 v[32:47], a[152:155], v[108:111], v[32:47]
    v_mfma_f32_32x32x16_bf16 v[48:63], a[156:159], v[104:107], v[48:63]
    buffer_load_dwordx4 v[92:95], v6, s[68:71], s75 offen offset:1024 sc1
    v_mfma_f32_32x32x16_bf16 v[64:79], a[156:159], v[108:111], v[64:79]
    s_add_u32 s75, s75, 2048
    s_and_b32 s75, s75, 0xffff
    s_waitcnt vmcnt(8)
    v_mfma_f32_32x32x16_bf16 v[16:31], a[160:163], v[112:115], v[16:31]
    buffer_load_dwordx4 v[96:99], v246, s[68:71], s75 offen offset:0 sc1
    v_mfma_f32_32x32x16_bf16 v[32:47], a[160:163], v[116:119], v[32:47]
    v_mfma_f32_32x32x16_bf16 v[48:63], a[164:167], v[112:115], v[48:63]
    buffer_load_dwordx4 v[100:103], v6, s[68:71], s75 offen offset:0 sc1
    v_mfma_f32_32x32x16_bf16 v[64:79], a[164:167], v[116:119], v[64:79]
    v_mfma_f32_32x32x16_bf16 v[16:31], a[168:171], v[120:123], v[16:31]
    buffer_load_dwordx4 v[104:107], v246, s[68:71], s75 offen offset:1024 sc1
    v_mfma_f32_32x32x16_bf16 v[32:47], a[168:171], v[124:127], v[32:47]
    v_mfma_f32_32x32x16_bf16 v[48:63], a[172:175], v[120:123], v[48:63]
    buffer_load_dwordx4 v[108:111], v6, s[68:71], s75 offen offset:1024 sc1
    v_mfma_f32_32x32x16_bf16 v[64:79], a[172:175], v[124:127], v[64:79]
    s_add_u32 s75, s75, 2048
    s_and_b32 s75, s75, 0xffff
    s_waitcnt vmcnt(8)
    v_mfma_f32_32x32x16_bf16 v[16:31], a[176:179], v[128:131], v[16:31]
    buffer_load_dwordx4 v[112:115], v246, s[68:71], s75 offen offset:0 sc1
    v_mfma_f32_32x32x16_bf16 v[32:47], a[176:179], v[132:135], v[32:47]
    v_mfma_f32_32x32x16_bf16 v[48:63], a[180:183], v[128:131], v[48:63]
    buffer_load_dwordx4 v[116:119], v6, s[68:71], s75 offen offset:0 sc1
    v_mfma_f32_32x32x16_bf16 v[64:79], a[180:183], v[132:135], v[64:79]
    v_mfma_f32_32x32x16_bf16 v[16:31], a[184:187], v[136:139], v[16:31]
    buffer_load_dwordx4 v[120:123], v246, s[68:71], s75 offen offset:1024 sc1
    v_mfma_f32_32x32x16_bf16 v[32:47], a[184:187], v[140:143], v[32:47]
    v_mfma_f32_32x32x16_bf16 v[48:63], a[188:191], v[136:139], v[48:63]
    buffer_load_dwordx4 v[124:127], v6, s[68:71], s75 offen offset:1024 sc1
    v_mfma_f32_32x32x16_bf16 v[64:79], a[188:191], v[140:143], v[64:79]
    s_add_u32 s75, s75, 2048
    s_and_b32 s75, s75, 0xffff
    s_waitcnt vmcnt(8)
    v_mfma_f32_32x32x16_bf16 v[16:31], a[192:195], v[80:83], v[16:31]
    buffer_load_dwordx4 v[128:131], v246, s[68:71], s75 offen offset:0 sc1
    v_mfma_f32_32x32x16_bf16 v[32:47], a[192:195], v[84:87], v[32:47]
    v_mfma_f32_32x32x16_bf16 v[48:63], a[196:199], v[80:83], v[48:63]
    buffer_load_dwordx4 v[132:135], v6, s[68:71], s75 offen offset:0 sc1
    v_mfma_f32_32x32x16_bf16 v[64:79], a[196:199], v[84:87], v[64:79]
    v_mfma_f32_32x32x16_bf16 v[16:31], a[200:203], v[88:91], v[16:31]
    buffer_load_dwordx4 v[136:139], v246, s[68:71], s75 offen offset:1024 sc1
    v_mfma_f32_32x32x16_bf16 v[32:47], a[200:203], v[92:95], v[32:47]
    v_mfma_f32_32x32x16_bf16 v[48:63], a[204:207], v[88:91], v[48:63]
    buffer_load_dwordx4 v[140:143], v6, s[68:71], s75 offen offset:1024 sc1
    v_mfma_f32_32x32x16_bf16 v[64:79], a[204:207], v[92:95], v[64:79]
    s_add_u32 s75, s75, 2048
    s_and_b32 s75, s75, 0xffff
    s_waitcnt vmcnt(8)
    v_mfma_f32_32x32x16_bf16 v[16:31], a[208:211], v[96:99], v[16:31]
    buffer_load_dwordx4 v[80:83], v246, s[68:71], s75 offen offset:0 sc1
    v_mfma_f32_32x32x16_bf16 v[32:47], a[208:211], v[100:103], v[32:47]
    v_mfma_f32_32x32x16_bf16 v[48:63], a[212:215], v[96:99], v[48:63]
    buffer_load_dwordx4 v[84:87], v6, s[68:71], s75 offen offset:0 sc1
    v_mfma_f32_32x32x16_bf16 v[64:79], a[212:215], v[100:103], v[64:79]
    v_mfma_f32_32x32x16_bf16 v[16:31], a[216:219], v[104:107], v[16:31]
    buffer_load_dwordx4 v[88:91], v246, s[68:71], s75 offen offset:1024 sc1
    v_mfma_f32_32x32x16_bf16 v[32:47], a[216:219], v[108:111], v[32:47]
    v_mfma_f32_32x32x16_bf16 v[48:63], a[220:223], v[104:107], v[48:63]
    buffer_load_dwordx4 v[92:95], v6, s[68:71], s75 offen offset:1024 sc1
    v_mfma_f32_32x32x16_bf16 v[64:79], a[220:223], v[108:111], v[64:79]
    s_add_u32 s75, s75, 2048
    s_and_b32 s75, s75, 0xffff
    s_waitcnt vmcnt(8)
    v_mfma_f32_32x32x16_bf16 v[16:31], a[224:227], v[112:115], v[16:31]
    buffer_load_dwordx4 v[96:99], v246, s[68:71], s75 offen offset:0 sc1
    v_mfma_f32_32x32x16_bf16 v[32:47], a[224:227], v[116:119], v[32:47]
    v_mfma_f32_32x32x16_bf16 v[48:63], a[228:231], v[112:115], v[48:63]
    buffer_load_dwordx4 v[100:103], v6, s[68:71], s75 offen offset:0 sc1
    v_mfma_f32_32x32x16_bf16 v[64:79], a[228:231], v[116:119], v[64:79]
    v_mfma_f32_32x32x16_bf16 v[16:31], a[232:235], v[120:123], v[16:31]
    buffer_load_dwordx4 v[104:107], v246, s[68:71], s75 offen offset:1024 sc1
    v_mfma_f32_32x32x16_bf16 v[32:47], a[232:235], v[124:127], v[32:47]
    v_mfma_f32_32x32x16_bf16 v[48:63], a[236:239], v[120:123], v[48:63]
    buffer_load_dwordx4 v[108:111], v6, s[68:71], s75 offen offset:1024 sc1
    v_mfma_f32_32x32x16_bf16 v[64:79], a[236:239], v[124:127], v[64:79]
    s_add_u32 s75, s75, 2048
    s_and_b32 s75, s75, 0xffff
    s_waitcnt vmcnt(8)
    v_mfma_f32_32x32x16_bf16 v[16:31], a[240:243], v[128:131], v[16:31]
    buffer_load_dwordx4 v[112:115], v246, s[68:71], s75 offen offset:0 sc1
    v_mfma_f32_32x32x16_bf16 v[32:47], a[240:243], v[132:135], v[32:47]
    v_mfma_f32_32x32x16_bf16 v[48:63], a[244:247], v[128:131], v[48:63]
    buffer_load_dwordx4 v[116:119], v6, s[68:71], s75 offen offset:0 sc1
    v_mfma_f32_32x32x16_bf16 v[64:79], a[244:247], v[132:135], v[64:79]
    v_mfma_f32_32x32x16_bf16 v[16:31], a[248:251], v[136:139], v[16:31]
    buffer_load_dwordx4 v[120:123], v246, s[68:71], s75 offen offset:1024 sc1
    v_mfma_f32_32x32x16_bf16 v[32:47], a[248:251], v[140:143], v[32:47]
    v_mfma_f32_32x32x16_bf16 v[48:63], a[252:255], v[136:139], v[48:63]
    buffer_load_dwordx4 v[124:127], v6, s[68:71], s75 offen offset:1024 sc1
    v_mfma_f32_32x32x16_bf16 v[64:79], a[252:255], v[140:143], v[64:79]
    s_add_u32 s75, s75, 2048
    s_and_b32 s75, s75, 0xffff
    s_waitcnt vmcnt(8)
    v_mfma_f32_32x32x16_bf16 v[16:31], a[0:3], v[80:83], v[16:31]
    buffer_load_dwordx4 v[128:131], v246, s[68:71], s75 offen offset:0 sc1
    v_mfma_f32_32x32x16_bf16 v[32:47], a[0:3], v[84:87], v[32:47]
    v_mfma_f32_32x32x16_bf16 v[48:63], a[4:7], v[80:83], v[48:63]
    buffer_load_dwordx4 v[132:135], v6, s[68:71], s75 offen offset:0 sc1
    v_mfma_f32_32x32x16_bf16 v[64:79], a[4:7], v[84:87], v[64:79]
    v_mfma_f32_32x32x16_bf16 v[16:31], a[8:11], v[88:91], v[16:31]
    buffer_load_dwordx4 v[136:139], v246, s[68:71], s75 offen offset:1024 sc1
    v_mfma_f32_32x32x16_bf16 v[32:47], a[8:11], v[92:95], v[32:47]
    v_mfma_f32_32x32x16_bf16 v[48:63], a[12:15], v[88:91], v[48:63]
    buffer_load_dwordx4 v[140:143], v6, s[68:71], s75 offen offset:1024 sc1
    v_mfma_f32_32x32x16_bf16 v[64:79], a[12:15], v[92:95], v[64:79]
    s_add_u32 s75, s75, 2048
    s_and_b32 s75, s75, 0xffff
    s_waitcnt vmcnt(8)
    v_mfma_f32_32x32x16_bf16 v[16:31], a[16:19], v[96:99], v[16:31]
    buffer_load_dwordx4 v[80:83], v246, s[68:71], s75 offen offset:0 sc1
    v_mfma_f32_32x32x16_bf16 v[32:47], a[16:19], v[100:103], v[32:47]
    v_mfma_f32_32x32x16_bf16 v[48:63], a[20:23], v[96:99], v[48:63]
    buffer_load_dwordx4 v[84:87], v6, s[68:71], s75 offen offset:0 sc1
    v_mfma_f32_32x32x16_bf16 v[64:79], a[20:23], v[100:103], v[64:79]
    v_mfma_f32_32x32x16_bf16 v[16:31], a[24:27], v[104:107], v[16:31]
    buffer_load_dwordx4 v[88:91], v246, s[68:71], s75 offen offset:1024 sc1
    v_mfma_f32_32x32x16_bf16 v[32:47], a[24:27], v[108:111], v[32:47]
    v_mfma_f32_32x32x16_bf16 v[48:63], a[28:31], v[104:107], v[48:63]
    buffer_load_dwordx4 v[92:95], v6, s[68:71], s75 offen offset:1024 sc1
    v_mfma_f32_32x32x16_bf16 v[64:79], a[28:31], v[108:111], v[64:79]
    s_add_u32 s75, s75, 2048
    s_and_b32 s75, s75, 0xffff
    s_waitcnt vmcnt(8)
    v_mfma_f32_32x32x16_bf16 v[16:31], a[64:67], v[112:115], v[16:31]
    buffer_load_dwordx4 v[96:99], v246, s[68:71], s75 offen offset:0 sc1
    v_mfma_f32_32x32x16_bf16 v[32:47], a[64:67], v[116:119], v[32:47]
    v_mfma_f32_32x32x16_bf16 v[48:63], a[68:71], v[112:115], v[48:63]
    buffer_load_dwordx4 v[100:103], v6, s[68:71], s75 offen offset:0 sc1
    v_mfma_f32_32x32x16_bf16 v[64:79], a[68:71], v[116:119], v[64:79]
    v_mfma_f32_32x32x16_bf16 v[16:31], a[72:75], v[120:123], v[16:31]
    buffer_load_dwordx4 v[104:107], v246, s[68:71], s75 offen offset:1024 sc1
    v_mfma_f32_32x32x16_bf16 v[32:47], a[72:75], v[124:127], v[32:47]
    v_mfma_f32_32x32x16_bf16 v[48:63], a[76:79], v[120:123], v[48:63]
    buffer_load_dwordx4 v[108:111], v6, s[68:71], s75 offen offset:1024 sc1
    v_mfma_f32_32x32x16_bf16 v[64:79], a[76:79], v[124:127], v[64:79]
    s_add_u32 s75, s75, 2048
    s_and_b32 s75, s75, 0xffff
    s_waitcnt vmcnt(8)
    v_mfma_f32_32x32x16_bf16 v[16:31], a[80:83], v[128:131], v[16:31]
    buffer_load_dwordx4 v[112:115], v246, s[68:71], s75 offen offset:0 sc1
    v_mfma_f32_32x32x16_bf16 v[32:47], a[80:83], v[132:135], v[32:47]
    v_mfma_f32_32x32x16_bf16 v[48:63], a[84:87], v[128:131], v[48:63]
    buffer_load_dwordx4 v[116:119], v6, s[68:71], s75 offen offset:0 sc1
    v_mfma_f32_32x32x16_bf16 v[64:79], a[84:87], v[132:135], v[64:79]
    v_mfma_f32_32x32x16_bf16 v[16:31], a[88:91], v[136:139], v[16:31]
    buffer_load_dwordx4 v[120:123], v246, s[68:71], s75 offen offset:1024 sc1
    v_mfma_f32_32x32x16_bf16 v[32:47], a[88:91], v[140:143], v[32:47]
    v_mfma_f32_32x32x16_bf16 v[48:63], a[92:95], v[136:139], v[48:63]
    buffer_load_dwordx4 v[124:127], v6, s[68:71], s75 offen offset:1024 sc1
    v_mfma_f32_32x32x16_bf16 v[64:79], a[92:95], v[140:143], v[64:79]
    s_add_u32 s75, s75, 2048
    s_and_b32 s75, s75, 0xffff
    s_waitcnt vmcnt(8)
    v_mfma_f32_32x32x16_bf16 v[16:31], a[32:35], v[80:83], v[16:31]
    buffer_load_dwordx4 v[128:131], v246, s[68:71], s75 offen offset:0 sc1
    v_mfma_f32_32x32x16_bf16 v[32:47], a[32:35], v[84:87], v[32:47]
    v_mfma_f32_32x32x16_bf16 v[48:63], a[36:39], v[80:83], v[48:63]
    buffer_load_dwordx4 v[132:135], v6, s[68:71], s75 offen offset:0 sc1
    v_mfma_f32_32x32x16_bf16 v[64:79], a[36:39], v[84:87], v[64:79]
    v_mfma_f32_32x32x16_bf16 v[16:31], a[40:43], v[88:91], v[16:31]
    buffer_load_dwordx4 v[136:139], v246, s[68:71], s75 offen offset:1024 sc1
    v_mfma_f32_32x32x16_bf16 v[32:47], a[40:43], v[92:95], v[32:47]
    v_mfma_f32_32x32x16_bf16 v[48:63], a[44:47], v[88:91], v[48:63]
    buffer_load_dwordx4 v[140:143], v6, s[68:71], s75 offen offset:1024 sc1
    v_mfma_f32_32x32x16_bf16 v[64:79], a[44:47], v[92:95], v[64:79]
    s_add_u32 s75, s75, 2048
    s_and_b32 s75, s75, 0xffff
    s_waitcnt vmcnt(8)
    v_mfma_f32_32x32x16_bf16 v[16:31], a[48:51], v[96:99], v[16:31]
    buffer_load_dwordx4 v[80:83], v246, s[68:71], s75 offen offset:0 sc1
    v_mfma_f32_32x32x16_bf16 v[32:47], a[48:51], v[100:103], v[32:47]
    v_mfma_f32_32x32x16_bf16 v[48:63], a[52:55], v[96:99], v[48:63]
    buffer_load_dwordx4 v[84:87], v6, s[68:71], s75 offen offset:0 sc1
    v_mfma_f32_32x32x16_bf16 v[64:79], a[52:55], v[100:103], v[64:79]
    v_mfma_f32_32x32x16_bf16 v[16:31], a[56:59], v[104:107], v[16:31]
    buffer_load_dwordx4 v[88:91], v246, s[68:71], s75 offen offset:1024 sc1
    v_mfma_f32_32x32x16_bf16 v[32:47], a[56:59], v[108:111], v[32:47]
    v_mfma_f32_32x32x16_bf16 v[48:63], a[60:63], v[104:107], v[48:63]
    buffer_load_dwordx4 v[92:95], v6, s[68:71], s75 offen offset:1024 sc1
    v_mfma_f32_32x32x16_bf16 v[64:79], a[60:63], v[108:111], v[64:79]
    s_add_u32 s75, s75, 2048
    s_and_b32 s75, s75, 0xffff
    s_waitcnt vmcnt(8)
    v_mfma_f32_32x32x16_bf16 v[16:31], a[96:99], v[112:115], v[16:31]
    buffer_load_dwordx4 v[96:99], v246, s[68:71], s75 offen offset:0 sc1
    v_mfma_f32_32x32x16_bf16 v[32:47], a[96:99], v[116:119], v[32:47]
    v_mfma_f32_32x32x16_bf16 v[48:63], a[100:103], v[112:115], v[48:63]
    buffer_load_dwordx4 v[100:103], v6, s[68:71], s75 offen offset:0 sc1
    v_mfma_f32_32x32x16_bf16 v[64:79], a[100:103], v[116:119], v[64:79]
    v_mfma_f32_32x32x16_bf16 v[16:31], a[104:107], v[120:123], v[16:31]
    buffer_load_dwordx4 v[104:107], v246, s[68:71], s75 offen offset:1024 sc1
    v_mfma_f32_32x32x16_bf16 v[32:47], a[104:107], v[124:127], v[32:47]
    v_mfma_f32_32x32x16_bf16 v[48:63], a[108:111], v[120:123], v[48:63]
    buffer_load_dwordx4 v[108:111], v6, s[68:71], s75 offen offset:1024 sc1
    v_mfma_f32_32x32x16_bf16 v[64:79], a[108:111], v[124:127], v[64:79]
    s_add_u32 s75, s75, 2048
    s_and_b32 s75, s75, 0xffff
    s_waitcnt vmcnt(8)
    v_mfma_f32_32x32x16_bf16 v[16:31], a[112:115], v[128:131], v[16:31]
    buffer_load_dwordx4 v[112:115], v246, s[68:71], s75 offen offset:0 sc1
    v_mfma_f32_32x32x16_bf16 v[32:47], a[112:115], v[132:135], v[32:47]
    v_mfma_f32_32x32x16_bf16 v[48:63], a[116:119], v[128:131], v[48:63]
    buffer_load_dwordx4 v[116:119], v6, s[68:71], s75 offen offset:0 sc1
    v_mfma_f32_32x32x16_bf16 v[64:79], a[116:119], v[132:135], v[64:79]
    v_mfma_f32_32x32x16_bf16 v[16:31], a[120:123], v[136:139], v[16:31]
    buffer_load_dwordx4 v[120:123], v246, s[68:71], s75 offen offset:1024 sc1
    v_mfma_f32_32x32x16_bf16 v[32:47], a[120:123], v[140:143], v[32:47]
    v_mfma_f32_32x32x16_bf16 v[48:63], a[124:127], v[136:139], v[48:63]
    buffer_load_dwordx4 v[124:127], v6, s[68:71], s75 offen offset:1024 sc1
    v_mfma_f32_32x32x16_bf16 v[64:79], a[124:127], v[140:143], v[64:79]
    s_add_u32 s75, s75, 2048
    s_and_b32 s75, s75, 0xffff
    s_waitcnt vmcnt(8)
    v_mfma_f32_32x32x16_bf16 v[16:31], v[144:147], v[80:83], v[16:31]
    buffer_load_dwordx4 v[128:131], v246, s[68:71], s75 offen offset:0 sc1
    v_mfma_f32_32x32x16_bf16 v[32:47], v[144:147], v[84:87], v[32:47]
    v_mfma_f32_32x32x16_bf16 v[48:63], v[148:151], v[80:83], v[48:63]
    buffer_load_dwordx4 v[132:135], v6, s[68:71], s75 offen offset:0 sc1
    v_mfma_f32_32x32x16_bf16 v[64:79], v[148:151], v[84:87], v[64:79]
    v_mfma_f32_32x32x16_bf16 v[16:31], v[152:155], v[88:91], v[16:31]
    buffer_load_dwordx4 v[136:139], v246, s[68:71], s75 offen offset:1024 sc1
    v_mfma_f32_32x32x16_bf16 v[32:47], v[152:155], v[92:95], v[32:47]
    v_mfma_f32_32x32x16_bf16 v[48:63], v[156:159], v[88:91], v[48:63]
    buffer_load_dwordx4 v[140:143], v6, s[68:71], s75 offen offset:1024 sc1
    v_mfma_f32_32x32x16_bf16 v[64:79], v[156:159], v[92:95], v[64:79]
    s_add_u32 s75, s75, 2048
    s_and_b32 s75, s75, 0xffff
    s_waitcnt vmcnt(8)
    v_mfma_f32_32x32x16_bf16 v[16:31], v[160:163], v[96:99], v[16:31]
    buffer_load_dwordx4 v[80:83], v246, s[68:71], s75 offen offset:0 sc1
    v_mfma_f32_32x32x16_bf16 v[32:47], v[160:163], v[100:103], v[32:47]
    v_mfma_f32_32x32x16_bf16 v[48:63], v[164:167], v[96:99], v[48:63]
    buffer_load_dwordx4 v[84:87], v6, s[68:71], s75 offen offset:0 sc1
    v_mfma_f32_32x32x16_bf16 v[64:79], v[164:167], v[100:103], v[64:79]
    v_mfma_f32_32x32x16_bf16 v[16:31], v[168:171], v[104:107], v[16:31]
    buffer_load_dwordx4 v[88:91], v246, s[68:71], s75 offen offset:1024 sc1
    v_mfma_f32_32x32x16_bf16 v[32:47], v[168:171], v[108:111], v[32:47]
    v_mfma_f32_32x32x16_bf16 v[48:63], v[172:175], v[104:107], v[48:63]
    buffer_load_dwordx4 v[92:95], v6, s[68:71], s75 offen offset:1024 sc1
    v_mfma_f32_32x32x16_bf16 v[64:79], v[172:175], v[108:111], v[64:79]
    s_add_u32 s75, s75, 2048
    s_and_b32 s75, s75, 0xffff
    s_waitcnt vmcnt(8)
    v_mfma_f32_32x32x16_bf16 v[16:31], v[176:179], v[112:115], v[16:31]
    buffer_load_dwordx4 v[96:99], v246, s[68:71], s75 offen offset:0 sc1
    v_mfma_f32_32x32x16_bf16 v[32:47], v[176:179], v[116:119], v[32:47]
    v_mfma_f32_32x32x16_bf16 v[48:63], v[180:183], v[112:115], v[48:63]
    buffer_load_dwordx4 v[100:103], v6, s[68:71], s75 offen offset:0 sc1
    v_mfma_f32_32x32x16_bf16 v[64:79], v[180:183], v[116:119], v[64:79]
    v_mfma_f32_32x32x16_bf16 v[16:31], v[184:187], v[120:123], v[16:31]
    buffer_load_dwordx4 v[104:107], v246, s[68:71], s75 offen offset:1024 sc1
    v_mfma_f32_32x32x16_bf16 v[32:47], v[184:187], v[124:127], v[32:47]
    v_mfma_f32_32x32x16_bf16 v[48:63], v[188:191], v[120:123], v[48:63]
    buffer_load_dwordx4 v[108:111], v6, s[68:71], s75 offen offset:1024 sc1
    v_mfma_f32_32x32x16_bf16 v[64:79], v[188:191], v[124:127], v[64:79]
    s_add_u32 s75, s75, 2048
    s_and_b32 s75, s75, 0xffff
    s_waitcnt vmcnt(8)
    v_mfma_f32_32x32x16_bf16 v[16:31], v[192:195], v[128:131], v[16:31]
    buffer_load_dwordx4 v[112:115], v246, s[68:71], s75 offen offset:0 sc1
    v_mfma_f32_32x32x16_bf16 v[32:47], v[192:195], v[132:135], v[32:47]
    v_mfma_f32_32x32x16_bf16 v[48:63], v[196:199], v[128:131], v[48:63]
    buffer_load_dwordx4 v[116:119], v6, s[68:71], s75 offen offset:0 sc1
    v_mfma_f32_32x32x16_bf16 v[64:79], v[196:199], v[132:135], v[64:79]
    v_mfma_f32_32x32x16_bf16 v[16:31], v[200:203], v[136:139], v[16:31]
    buffer_load_dwordx4 v[120:123], v246, s[68:71], s75 offen offset:1024 sc1
    v_mfma_f32_32x32x16_bf16 v[32:47], v[200:203], v[140:143], v[32:47]
    v_mfma_f32_32x32x16_bf16 v[48:63], v[204:207], v[136:139], v[48:63]
    buffer_load_dwordx4 v[124:127], v6, s[68:71], s75 offen offset:1024 sc1
    v_mfma_f32_32x32x16_bf16 v[64:79], v[204:207], v[140:143], v[64:79]
    s_add_u32 s75, s75, 2048
    s_and_b32 s75, s75, 0xffff
    s_waitcnt vmcnt(8)
    v_mfma_f32_32x32x16_bf16 v[16:31], v[208:211], v[80:83], v[16:31]
    buffer_load_dwordx4 v[128:131], v246, s[68:71], s75 offen offset:0 sc1
    v_and_b32 v3, 15, v2
    v_mfma_f32_32x32x16_bf16 v[32:47], v[208:211], v[84:87], v[32:47]
    v_bfe_u32 v7, v2, 4, 1
    v_mfma_f32_32x32x16_bf16 v[48:63], v[212:215], v[80:83], v[48:63]
    buffer_load_dwordx4 v[132:135], v6, s[68:71], s75 offen offset:0 sc1
    v_lshlrev_b32 v3, 8, v3
    v_mfma_f32_32x32x16_bf16 v[64:79], v[212:215], v[84:87], v[64:79]
    v_lshl_add_u32 v3, v7, 14, v3
    v_mfma_f32_32x32x16_bf16 v[16:31], v[216:219], v[88:91], v[16:31]
    buffer_load_dwordx4 v[136:139], v246, s[68:71], s75 offen offset:1024 sc1
    v_lshrrev_b32 v7, 5, v2
    v_mfma_f32_32x32x16_bf16 v[32:47], v[216:219], v[92:95], v[32:47]
    v_and_b32 v1, 7, v2
    v_mfma_f32_32x32x16_bf16 v[48:63], v[220:223], v[88:91], v[48:63]
    buffer_load_dwordx4 v[140:143], v6, s[68:71], s75 offen offset:1024 sc1
    v_xor_b32 v7, v7, v1
    v_mfma_f32_32x32x16_bf16 v[64:79], v[220:223], v[92:95], v[64:79]
    s_add_u32 s75, s75, 2048
    s_and_b32 s75, s75, 0xffff
    v_lshl_add_u32 v3, v7, 4, v3
    s_waitcnt vmcnt(8)
    v_mfma_f32_32x32x16_bf16 v[16:31], v[224:227], v[96:99], v[16:31]
    buffer_load_dwordx4 v[80:83], v246, s[68:71], s75 offen offset:0 sc1
    ds_read_b64_tr_b16 a[128:129], v244 offset:0
    v_add_u32 v8, s76, v3
    v_mfma_f32_32x32x16_bf16 v[32:47], v[224:227], v[100:103], v[32:47]
    ds_read_b64_tr_b16 a[130:131], v244 offset:2048
    v_xor_b32 v9, 32, v8
    v_mfma_f32_32x32x16_bf16 v[48:63], v[228:231], v[96:99], v[48:63]
    buffer_load_dwordx4 v[84:87], v6, s[68:71], s75 offen offset:0 sc1
    ds_read_b64_tr_b16 a[132:133], v245 offset:0
    v_xor_b32 v10, 64, v8
    v_mfma_f32_32x32x16_bf16 v[64:79], v[228:231], v[100:103], v[64:79]
    ds_read_b64_tr_b16 a[134:135], v245 offset:2048
    v_xor_b32 v11, 96, v8
    v_mfma_f32_32x32x16_bf16 v[16:31], v[232:235], v[104:107], v[16:31]
    buffer_load_dwordx4 v[88:91], v246, s[68:71], s75 offen offset:1024 sc1
    ds_read_b64_tr_b16 a[136:137], v244 offset:1024
    v_lshrrev_b32 v3, 2, v0
    v_mfma_f32_32x32x16_bf16 v[32:47], v[232:235], v[108:111], v[32:47]
    ds_read_b64_tr_b16 a[138:139], v244 offset:3072
    v_and_b32 v1, 3, v0
    v_mfma_f32_32x32x16_bf16 v[48:63], v[236:239], v[104:107], v[48:63]
    buffer_load_dwordx4 v[92:95], v6, s[68:71], s75 offen offset:1024 sc1
    ds_read_b64_tr_b16 a[140:141], v245 offset:1024
    v_lshrrev_b32 v7, 4, v3
    v_mfma_f32_32x32x16_bf16 v[64:79], v[236:239], v[108:111], v[64:79]
    s_add_u32 s75, s75, 2048
    ds_read_b64_tr_b16 a[142:143], v245 offset:3072
    s_and_b32 s75, s75, 0xffff
    v_and_b32 v12, 15, v3
    s_waitcnt vmcnt(8) lgkmcnt(0)
    v_mfma_f32_32x32x16_bf16 v[16:31], a[128:131], v[112:115], v[16:31]
    buffer_load_dwordx4 v[96:99], v246, s[68:71], s75 offen offset:0 sc1
    ds_read_b64_tr_b16 a[144:145], v244 offset:16384
    v_lshlrev_b32 v12, 8, v12
    v_mfma_f32_32x32x16_bf16 v[32:47], a[128:131], v[116:119], v[32:47]
    ds_read_b64_tr_b16 a[146:147], v244 offset:18432
    v_lshl_add_u32 v7, v7, 14, v12
    v_mfma_f32_32x32x16_bf16 v[48:63], a[132:135], v[112:115], v[48:63]
    buffer_load_dwordx4 v[100:103], v6, s[68:71], s75 offen offset:0 sc1
    ds_read_b64_tr_b16 a[148:149], v245 offset:16384
    v_and_b32 v12, 7, v3
    v_mfma_f32_32x32x16_bf16 v[64:79], a[132:135], v[116:119], v[64:79]
    ds_read_b64_tr_b16 a[150:151], v245 offset:18432
    v_lshlrev_b32 v13, 2, v1
    v_mfma_f32_32x32x16_bf16 v[16:31], a[136:139], v[120:123], v[16:31]
    buffer_load_dwordx4 v[104:107], v246, s[68:71], s75 offen offset:1024 sc1
    ds_read_b64_tr_b16 a[152:153], v244 offset:17408
    v_xor_b32 v12, v12, v13
    v_mfma_f32_32x32x16_bf16 v[32:47], a[136:139], v[124:127], v[32:47]
    ds_read_b64_tr_b16 a[154:155], v244 offset:19456
    v_lshl_add_u32 v12, v12, 4, v7
    v_mfma_f32_32x32x16_bf16 v[48:63], a[140:143], v[120:123], v[48:63]
    buffer_load_dwordx4 v[108:111], v6, s[68:71], s75 offen offset:1024 sc1
    ds_read_b64_tr_b16 a[156:157], v245 offset:17408
    v_xor_b32 v13, 16, v12
    v_mfma_f32_32x32x16_bf16 v[64:79], a[140:143], v[124:127], v[64:79]
    s_add_u32 s75, s75, 2048
    ds_read_b64_tr_b16 a[158:159], v245 offset:19456
    s_and_b32 s75, s75, 0xffff
    v_xor_b32 v14, 32, v12
    s_waitcnt vmcnt(8) lgkmcnt(0)
    v_mfma_f32_32x32x16_bf16 v[16:31], a[144:147], v[128:131], v[16:31]
    buffer_load_dwordx4 v[112:115], v246, s[68:71], s75 offen offset:0 sc1
    ds_read_b64_tr_b16 a[128:129], v251 offset:49152
    v_xor_b32 v15, 48, v12
    v_mfma_f32_32x32x16_bf16 v[32:47], a[144:147], v[132:135], v[32:47]
    ds_read_b64_tr_b16 a[130:131], v251 offset:51200
    s_lshl_b32 s53, s72, 6
    v_mfma_f32_32x32x16_bf16 v[48:63], a[148:151], v[128:131], v[48:63]
    buffer_load_dwordx4 v[116:119], v6, s[68:71], s75 offen offset:0 sc1
    ds_read_b64_tr_b16 a[132:133], v252 offset:49152
    v_add_u32 v3, s53, v3
    v_mfma_f32_32x32x16_bf16 v[64:79], a[148:151], v[132:135], v[64:79]
    ds_read_b64_tr_b16 a[134:135], v252 offset:51200
    v_mul_u32_u24 v3, 1152, v3
    v_mfma_f32_32x32x16_bf16 v[16:31], a[152:155], v[136:139], v[16:31]
    buffer_load_dwordx4 v[120:123], v246, s[68:71], s75 offen offset:1024 sc1
    ds_read_b64_tr_b16 a[136:137], v251 offset:50176
    v_lshl_add_u32 v3, v1, 5, v3
    v_mfma_f32_32x32x16_bf16 v[32:47], a[152:155], v[140:143], v[32:47]
    ds_read_b64_tr_b16 a[138:139], v251 offset:52224
    s_lshl_b32 s53, s73, 7
    v_mfma_f32_32x32x16_bf16 v[48:63], a[156:159], v[136:139], v[48:63]
    buffer_load_dwordx4 v[124:127], v6, s[68:71], s75 offen offset:1024 sc1
    ds_read_b64_tr_b16 a[140:141], v252 offset:50176
    v_add_u32 v7, s53, v3
    v_mfma_f32_32x32x16_bf16 v[64:79], a[156:159], v[140:143], v[64:79]
    s_add_u32 s75, s75, 2048
    ds_read_b64_tr_b16 a[142:143], v252 offset:52224
    s_and_b32 s75, s75, 0xffff
    s_mov_b32 s4, s46
    s_waitcnt vmcnt(8) lgkmcnt(0)
    v_mfma_f32_32x32x16_bf16 v[16:31], a[128:131], v[80:83], v[16:31]
    buffer_load_dwordx4 v[128:131], v246, s[68:71], s75 offen offset:0 sc1
    ds_read_b64_tr_b16 a[144:145], v251 offset:0
    s_and_b32 s5, s47, 0xffff
    v_mfma_f32_32x32x16_bf16 v[32:47], a[128:131], v[84:87], v[32:47]
    ds_read_b64_tr_b16 a[146:147], v251 offset:2048
    s_mov_b32 s6, 1769472
    v_mfma_f32_32x32x16_bf16 v[48:63], a[132:135], v[80:83], v[48:63]
    buffer_load_dwordx4 v[132:135], v6, s[68:71], s75 offen offset:0 sc1
    ds_read_b64_tr_b16 a[148:149], v252 offset:0
    s_mov_b32 s7, 0x20000
    v_mfma_f32_32x32x16_bf16 v[64:79], a[132:135], v[84:87], v[64:79]
    ds_read_b64_tr_b16 a[150:151], v252 offset:2048
    v_mfma_f32_32x32x16_bf16 v[16:31], a[136:139], v[88:91], v[16:31]
    buffer_load_dwordx4 v[136:139], v246, s[68:71], s75 offen offset:1024 sc1
    ds_read_b64_tr_b16 a[152:153], v251 offset:1024
    v_mfma_f32_32x32x16_bf16 v[32:47], a[136:139], v[92:95], v[32:47]
    ds_read_b64_tr_b16 a[154:155], v251 offset:3072
    v_mfma_f32_32x32x16_bf16 v[48:63], a[140:143], v[88:91], v[48:63]
    buffer_load_dwordx4 v[140:143], v6, s[68:71], s75 offen offset:1024 sc1
    ds_read_b64_tr_b16 a[156:157], v252 offset:1024
    v_mfma_f32_32x32x16_bf16 v[64:79], a[140:143], v[92:95], v[64:79]
    s_add_u32 s75, s75, 2048
    ds_read_b64_tr_b16 a[158:159], v252 offset:3072
    s_and_b32 s75, s75, 0xffff
    s_waitcnt vmcnt(8) lgkmcnt(0)
    v_mfma_f32_32x32x16_bf16 v[16:31], a[144:147], v[96:99], v[16:31]
    buffer_load_dwordx4 v[80:83], v246, s[68:71], s75 offen offset:0 sc1
    ds_read_b64_tr_b16 a[128:129], v251 offset:16384
    v_mfma_f32_32x32x16_bf16 v[32:47], a[144:147], v[100:103], v[32:47]
    ds_read_b64_tr_b16 a[130:131], v251 offset:18432
    v_mfma_f32_32x32x16_bf16 v[48:63], a[148:151], v[96:99], v[48:63]
    buffer_load_dwordx4 v[84:87], v6, s[68:71], s75 offen offset:0 sc1
    ds_read_b64_tr_b16 a[132:133], v252 offset:16384
    v_mfma_f32_32x32x16_bf16 v[64:79], a[148:151], v[100:103], v[64:79]
    ds_read_b64_tr_b16 a[134:135], v252 offset:18432
    v_mfma_f32_32x32x16_bf16 v[16:31], a[152:155], v[104:107], v[16:31]
    buffer_load_dwordx4 v[88:91], v246, s[68:71], s75 offen offset:1024 sc1
    ds_read_b64_tr_b16 a[136:137], v251 offset:17408
    v_mfma_f32_32x32x16_bf16 v[32:47], a[152:155], v[108:111], v[32:47]
    ds_read_b64_tr_b16 a[138:139], v251 offset:19456
    v_mfma_f32_32x32x16_bf16 v[48:63], a[156:159], v[104:107], v[48:63]
    buffer_load_dwordx4 v[92:95], v6, s[68:71], s75 offen offset:1024 sc1
    ds_read_b64_tr_b16 a[140:141], v252 offset:17408
    v_mfma_f32_32x32x16_bf16 v[64:79], a[156:159], v[108:111], v[64:79]
    s_add_u32 s75, s75, 2048
    ds_read_b64_tr_b16 a[142:143], v252 offset:19456
    s_and_b32 s75, s75, 0xffff
    s_waitcnt vmcnt(8) lgkmcnt(0)
    v_mfma_f32_32x32x16_bf16 v[16:31], a[128:131], v[112:115], v[16:31]
    buffer_load_dwordx4 v[96:99], v246, s[68:71], s75 offen offset:0 sc1
    ds_read_b64_tr_b16 a[144:145], v251 offset:32768
    v_mfma_f32_32x32x16_bf16 v[32:47], a[128:131], v[116:119], v[32:47]
    ds_read_b64_tr_b16 a[146:147], v251 offset:34816
    v_mfma_f32_32x32x16_bf16 v[48:63], a[132:135], v[112:115], v[48:63]
    buffer_load_dwordx4 v[100:103], v6, s[68:71], s75 offen offset:0 sc1
    ds_read_b64_tr_b16 a[148:149], v252 offset:32768
    v_mfma_f32_32x32x16_bf16 v[64:79], a[132:135], v[116:119], v[64:79]
    ds_read_b64_tr_b16 a[150:151], v252 offset:34816
    v_mfma_f32_32x32x16_bf16 v[16:31], a[136:139], v[120:123], v[16:31]
    buffer_load_dwordx4 v[104:107], v246, s[68:71], s75 offen offset:1024 sc1
    ds_read_b64_tr_b16 a[152:153], v251 offset:33792
    v_mfma_f32_32x32x16_bf16 v[32:47], a[136:139], v[124:127], v[32:47]
    ds_read_b64_tr_b16 a[154:155], v251 offset:35840
    v_mfma_f32_32x32x16_bf16 v[48:63], a[140:143], v[120:123], v[48:63]
    buffer_load_dwordx4 v[108:111], v6, s[68:71], s75 offen offset:1024 sc1
    ds_read_b64_tr_b16 a[156:157], v252 offset:33792
    v_mfma_f32_32x32x16_bf16 v[64:79], a[140:143], v[124:127], v[64:79]
    s_add_u32 s75, s75, 2048
    ds_read_b64_tr_b16 a[158:159], v252 offset:35840
    s_and_b32 s75, s75, 0xffff
    s_waitcnt vmcnt(8) lgkmcnt(0)
    v_mfma_f32_32x32x16_bf16 v[16:31], a[144:147], v[128:131], v[16:31]
    buffer_load_dwordx4 v[112:115], v246, s[68:71], s75 offen offset:0 sc1
    ds_read_b64_tr_b16 a[128:129], v242 offset:0
    v_mfma_f32_32x32x16_bf16 v[32:47], a[144:147], v[132:135], v[32:47]
    ds_read_b64_tr_b16 a[130:131], v242 offset:2048
    v_mfma_f32_32x32x16_bf16 v[48:63], a[148:151], v[128:131], v[48:63]
    buffer_load_dwordx4 v[116:119], v6, s[68:71], s75 offen offset:0 sc1
    ds_read_b64_tr_b16 a[132:133], v243 offset:0
    v_mfma_f32_32x32x16_bf16 v[64:79], a[148:151], v[132:135], v[64:79]
    ds_read_b64_tr_b16 a[134:135], v243 offset:2048
    v_mfma_f32_32x32x16_bf16 v[16:31], a[152:155], v[136:139], v[16:31]
    buffer_load_dwordx4 v[120:123], v246, s[68:71], s75 offen offset:1024 sc1
    ds_read_b64_tr_b16 a[136:137], v242 offset:1024
    v_mfma_f32_32x32x16_bf16 v[32:47], a[152:155], v[140:143], v[32:47]
    ds_read_b64_tr_b16 a[138:139], v242 offset:3072
    v_mfma_f32_32x32x16_bf16 v[48:63], a[156:159], v[136:139], v[48:63]
    buffer_load_dwordx4 v[124:127], v6, s[68:71], s75 offen offset:1024 sc1
    ds_read_b64_tr_b16 a[140:141], v243 offset:1024
    v_mfma_f32_32x32x16_bf16 v[64:79], a[156:159], v[140:143], v[64:79]
    s_add_u32 s75, s75, 2048
    ds_read_b64_tr_b16 a[142:143], v243 offset:3072
    s_and_b32 s75, s75, 0xffff
    s_waitcnt vmcnt(8) lgkmcnt(0)
    v_mfma_f32_32x32x16_bf16 v[16:31], a[128:131], v[80:83], v[16:31]
    buffer_load_dwordx4 v[128:131], v246, s[68:71], s75 offen offset:0 sc1
    ds_read_b64_tr_b16 a[144:145], v242 offset:16384
    v_mfma_f32_32x32x16_bf16 v[32:47], a[128:131], v[84:87], v[32:47]
    ds_read_b64_tr_b16 a[146:147], v242 offset:18432
    v_mfma_f32_32x32x16_bf16 v[48:63], a[132:135], v[80:83], v[48:63]
    buffer_load_dwordx4 v[132:135], v6, s[68:71], s75 offen offset:0 sc1
    ds_read_b64_tr_b16 a[148:149], v243 offset:16384
    v_mfma_f32_32x32x16_bf16 v[64:79], a[132:135], v[84:87], v[64:79]
    ds_read_b64_tr_b16 a[150:151], v243 offset:18432
    v_mfma_f32_32x32x16_bf16 v[16:31], a[136:139], v[88:91], v[16:31]
    buffer_load_dwordx4 v[136:139], v246, s[68:71], s75 offen offset:1024 sc1
    ds_read_b64_tr_b16 a[152:153], v242 offset:17408
    v_mfma_f32_32x32x16_bf16 v[32:47], a[136:139], v[92:95], v[32:47]
    ds_read_b64_tr_b16 a[154:155], v242 offset:19456
    v_mfma_f32_32x32x16_bf16 v[48:63], a[140:143], v[88:91], v[48:63]
    buffer_load_dwordx4 v[140:143], v6, s[68:71], s75 offen offset:1024 sc1
    ds_read_b64_tr_b16 a[156:157], v243 offset:17408
    v_mfma_f32_32x32x16_bf16 v[64:79], a[140:143], v[92:95], v[64:79]
    s_add_u32 s75, s75, 2048
    ds_read_b64_tr_b16 a[158:159], v243 offset:19456
    s_and_b32 s75, s75, 0xffff
    s_waitcnt vmcnt(8) lgkmcnt(0)
    v_mfma_f32_32x32x16_bf16 v[16:31], a[144:147], v[96:99], v[16:31]
    ds_read_b64_tr_b16 a[128:129], v242 offset:32768
    v_mfma_f32_32x32x16_bf16 v[32:47], a[144:147], v[100:103], v[32:47]
    ds_read_b64_tr_b16 a[130:131], v242 offset:34816
    v_mfma_f32_32x32x16_bf16 v[48:63], a[148:151], v[96:99], v[48:63]
    ds_read_b64_tr_b16 a[132:133], v243 offset:32768
    v_mfma_f32_32x32x16_bf16 v[64:79], a[148:151], v[100:103], v[64:79]
    ds_read_b64_tr_b16 a[134:135], v243 offset:34816
    v_mfma_f32_32x32x16_bf16 v[16:31], a[152:155], v[104:107], v[16:31]
    ds_read_b64_tr_b16 a[136:137], v242 offset:33792
    v_mfma_f32_32x32x16_bf16 v[32:47], a[152:155], v[108:111], v[32:47]
    ds_read_b64_tr_b16 a[138:139], v242 offset:35840
    v_mfma_f32_32x32x16_bf16 v[48:63], a[156:159], v[104:107], v[48:63]
    ds_read_b64_tr_b16 a[140:141], v243 offset:33792
    v_mfma_f32_32x32x16_bf16 v[64:79], a[156:159], v[108:111], v[64:79]
    ds_read_b64_tr_b16 a[142:143], v243 offset:35840
    s_waitcnt vmcnt(4) lgkmcnt(0)
    v_mfma_f32_32x32x16_bf16 v[16:31], a[128:131], v[112:115], v[16:31]
    ds_read_b64_tr_b16 a[144:145], v242 offset:49152
    ds_read_b64_tr_b16 a[146:147], v242 offset:51200
    v_mfma_f32_32x32x16_bf16 v[32:47], a[128:131], v[116:119], v[32:47]
    ds_read_b64_tr_b16 a[148:149], v243 offset:49152
    ds_read_b64_tr_b16 a[150:151], v243 offset:51200
    v_mfma_f32_32x32x16_bf16 v[16:31], a[136:139], v[120:123], v[16:31]
    ds_read_b64_tr_b16 a[152:153], v242 offset:50176
    ds_read_b64_tr_b16 a[154:155], v242 offset:52224
    v_mfma_f32_32x32x16_bf16 v[32:47], a[136:139], v[124:127], v[32:47]
    ds_read_b64_tr_b16 a[156:157], v243 offset:50176
    ds_read_b64_tr_b16 a[158:159], v243 offset:52224
    v_mfma_f32_32x32x16_bf16 v[48:63], a[132:135], v[112:115], v[48:63]
    v_mfma_f32_32x32x16_bf16 v[64:79], a[132:135], v[116:119], v[64:79]
    s_waitcnt vmcnt(3) lgkmcnt(6)
    v_mfma_f32_32x32x16_bf16 v[16:31], a[144:147], v[128:131], v[16:31]
    s_waitcnt vmcnt(2)
    v_mfma_f32_32x32x16_bf16 v[32:47], a[144:147], v[132:135], v[32:47]
    s_waitcnt vmcnt(1) lgkmcnt(2)
    v_mfma_f32_32x32x16_bf16 v[16:31], a[152:155], v[136:139], v[16:31]
    s_waitcnt vmcnt(0)
    v_mfma_f32_32x32x16_bf16 v[32:47], a[152:155], v[140:143], v[32:47]
    v_mfma_f32_32x32x16_bf16 v[48:63], a[140:143], v[120:123], v[48:63]
    v_mfma_f32_32x32x16_bf16 v[64:79], a[140:143], v[124:127], v[64:79]
    v_mfma_f32_32x32x16_bf16 v[48:63], a[148:151], v[128:131], v[48:63]
    s_nop 6
    ds_write_b128 v8, v[16:19] offset:0
    ds_write_b128 v9, v[20:23] offset:0
    v_mfma_f32_32x32x16_bf16 v[64:79], a[148:151], v[132:135], v[64:79]
    ds_write_b128 v10, v[24:27] offset:0
    ds_write_b128 v11, v[28:31] offset:0
    s_waitcnt lgkmcnt(4)
    v_mfma_f32_32x32x16_bf16 v[48:63], a[156:159], v[136:139], v[48:63]
    ds_write_b128 v8, v[32:35] offset:32768
    ds_write_b128 v9, v[36:39] offset:32768
    v_mfma_f32_32x32x16_bf16 v[64:79], a[156:159], v[140:143], v[64:79]
    ds_write_b128 v10, v[40:43] offset:32768
    ds_write_b128 v11, v[44:47] offset:32768
    s_nop 6
    ds_write_b128 v8, v[48:51] offset:128
    ds_write_b128 v9, v[52:55] offset:128
    ds_write_b128 v10, v[56:59] offset:128
    ds_write_b128 v11, v[60:63] offset:128
    ds_write_b128 v8, v[64:67] offset:32896
    ds_write_b128 v9, v[68:71] offset:32896
    ds_write_b128 v10, v[72:75] offset:32896
    ds_write_b128 v11, v[76:79] offset:32896
    s_waitcnt lgkmcnt(0)
    s_barrier
    ds_read_b128 v[80:83], v12 offset:0
    ds_read_b128 v[84:87], v13 offset:0
    ds_read_b128 v[88:91], v14 offset:0
    ds_read_b128 v[92:95], v15 offset:0
    ds_read_b128 v[96:99], v12 offset:4096
    ds_read_b128 v[100:103], v13 offset:4096
    ds_read_b128 v[104:107], v14 offset:4096
    ds_read_b128 v[108:111], v15 offset:4096
    ds_read_b128 v[112:115], v12 offset:8192
    ds_read_b128 v[116:119], v13 offset:8192
    ds_read_b128 v[120:123], v14 offset:8192
    ds_read_b128 v[124:127], v15 offset:8192
    ds_read_b128 v[128:131], v12 offset:12288
    ds_read_b128 v[132:135], v13 offset:12288
    ds_read_b128 v[136:139], v14 offset:12288
    ds_read_b128 v[140:143], v15 offset:12288
    s_waitcnt lgkmcnt(11)
    v_add_f32 v80, v80, v96
    s_waitcnt lgkmcnt(3)
    v_add_f32 v112, v112, v128
    v_add_f32 v81, v81, v97
    v_add_f32 v113, v113, v129
    v_add_f32 v82, v82, v98
    v_add_f32 v114, v114, v130
    v_add_f32 v83, v83, v99
    v_add_f32 v115, v115, v131
    v_add_f32 v84, v84, v100
    s_waitcnt lgkmcnt(2)
    v_add_f32 v116, v116, v132
    v_add_f32 v85, v85, v101
    v_add_f32 v117, v117, v133
    v_add_f32 v86, v86, v102
    v_add_f32 v118, v118, v134
    v_add_f32 v87, v87, v103
    v_add_f32 v119, v119, v135
    v_add_f32 v88, v88, v104
    s_waitcnt lgkmcnt(1)
    v_add_f32 v120, v120, v136
    v_add_f32 v89, v89, v105
    v_add_f32 v121, v121, v137
    v_add_f32 v90, v90, v106
    v_add_f32 v122, v122, v138
    v_add_f32 v91, v91, v107
    v_add_f32 v123, v123, v139
    v_add_f32 v92, v92, v108
    s_waitcnt lgkmcnt(0)
    v_add_f32 v124, v124, v140
    v_add_f32 v93, v93, v109
    v_add_f32 v125, v125, v141
    v_add_f32 v94, v94, v110
    v_add_f32 v126, v126, v142
    v_add_f32 v95, v95, v111
    v_add_f32 v127, v127, v143
    v_add_f32 v80, v80, v112
    v_add_f32 v81, v81, v113
    v_add_f32 v82, v82, v114
    v_add_f32 v83, v83, v115
    v_add_f32 v84, v84, v116
    v_add_f32 v85, v85, v117
    v_add_f32 v86, v86, v118
    v_add_f32 v87, v87, v119
    v_add_f32 v88, v88, v120
    v_add_f32 v89, v89, v121
    v_add_f32 v90, v90, v122
    v_add_f32 v91, v91, v123
    v_add_f32 v92, v92, v124
    v_add_f32 v93, v93, v125
    v_add_f32 v94, v94, v126
    v_add_f32 v95, v95, v127
    v_cvt_pk_bf16_f32 v144, v80, v81
    v_cvt_pk_bf16_f32 v145, v82, v83
    v_cvt_pk_bf16_f32 v146, v84, v85
    v_cvt_pk_bf16_f32 v147, v86, v87
    v_cvt_pk_bf16_f32 v148, v88, v89
    v_cvt_pk_bf16_f32 v149, v90, v91
    v_cvt_pk_bf16_f32 v150, v92, v93
    v_cvt_pk_bf16_f32 v151, v94, v95
    buffer_store_dwordx4 v[144:147], v7, s[4:7], 0 offen
    buffer_store_dwordx4 v[148:151], v7, s[4:7], 0 offen offset:16
L_fin:
L_end:
    s_endpgm
L_stub_1:
    s_call_b64 s[30:31], L_rare0
    s_branch L_back_2
L_stub_3:
    s_call_b64 s[30:31], L_rare1
    s_branch L_back_4
L_stub_5:
    s_call_b64 s[30:31], L_rare2
    s_branch L_back_6
L_stub_7:
    s_call_b64 s[30:31], L_rare0
    s_branch L_back_8
L_stub_9:
    s_call_b64 s[30:31], L_rare1
    s_branch L_back_10
L_stub_11:
    s_call_b64 s[30:31], L_rare2
    s_branch L_back_12
L_stub_13:
    s_call_b64 s[30:31], L_rare0
    s_branch L_back_14
L_stub_15:
    s_call_b64 s[30:31], L_rare1
    s_branch L_back_16
L_stub_17:
    s_call_b64 s[30:31], L_rare2
    s_branch L_back_18
L_stub_19:
    s_call_b64 s[30:31], L_rare0
    s_branch L_back_20
L_stub_21:
    s_call_b64 s[30:31], L_rare1
    s_branch L_back_22
L_stub_23:
    s_call_b64 s[30:31], L_rare2
    s_branch L_back_24
L_stub_25:
    s_call_b64 s[30:31], L_rare0
    s_branch L_back_26
L_stub_27:
    s_call_b64 s[30:31], L_rare1
    s_branch L_back_28
L_stub_29:
    s_call_b64 s[30:31], L_rare2
    s_branch L_back_30
L_stub_31:
    s_call_b64 s[30:31], L_rare0
    s_branch L_back_32
L_stub_33:
    s_call_b64 s[30:31], L_rare1
    s_branch L_back_34
L_stub_35:
    s_call_b64 s[30:31], L_rare2
    s_branch L_back_36
L_stub_37:
    s_call_b64 s[30:31], L_rare0
    s_branch L_back_38
L_stub_39:
    s_call_b64 s[30:31], L_rare1
    s_branch L_back_40
L_stub_41:
    s_call_b64 s[30:31], L_rare2
    s_branch L_back_42
L_stub_43:
    s_call_b64 s[30:31], L_rare0
    s_branch L_back_44
L_stub_45:
    s_call_b64 s[30:31], L_rare1
    s_branch L_back_46
L_stub_47:
    s_call_b64 s[30:31], L_rare2
    s_branch L_back_48
L_stub_49:
    s_call_b64 s[30:31], L_rare0
    s_branch L_back_50
L_stub_51:
    s_call_b64 s[30:31], L_rare1
    s_branch L_back_52
L_stub_53:
    s_call_b64 s[30:31], L_rare2
    s_branch L_back_54
L_stub_55:
    s_call_b64 s[30:31], L_rare0
    s_branch L_back_56
L_stub_57:
    s_call_b64 s[30:31], L_rare1
    s_branch L_back_58
L_stub_59:
    s_call_b64 s[30:31], L_rare2
    s_branch L_back_60
L_stub_61:
    s_call_b64 s[30:31], L_rare0
    s_branch L_back_62
L_stub_63:
    s_call_b64 s[30:31], L_rare1
    s_branch L_back_64
L_stub_65:
    s_call_b64 s[30:31], L_rare2
    s_branch L_back_66
L_stub_67:
    s_call_b64 s[30:31], L_rare0
    s_branch L_back_68
L_stub_69:
    s_call_b64 s[30:31], L_rare1
    s_branch L_back_70
L_stub_71:
    s_call_b64 s[30:31], L_rare2
    s_branch L_back_72
L_stub_73:
    s_call_b64 s[30:31], L_rare0
    s_branch L_back_74
L_stub_75:
    s_call_b64 s[30:31], L_rare1
    s_branch L_back_76
L_stub_77:
    s_call_b64 s[30:31], L_rare2
    s_branch L_back_78
L_stub_79:
    s_call_b64 s[30:31], L_rare0
    s_branch L_back_80
L_stub_81:
    s_call_b64 s[30:31], L_rare1
    s_branch L_back_82
L_stub_83:
    s_call_b64 s[30:31], L_rare2
    s_branch L_back_84
L_stub_85:
    s_call_b64 s[30:31], L_rare0
    s_branch L_back_86
L_stub_87:
    s_call_b64 s[30:31], L_rare1
    s_branch L_back_88
L_stub_89:
    s_call_b64 s[30:31], L_rare2
    s_branch L_back_90
L_stub_91:
    s_call_b64 s[30:31], L_rare0
    s_branch L_back_92
L_stub_93:
    s_call_b64 s[30:31], L_rare1
    s_branch L_back_94
L_stub_95:
    s_call_b64 s[30:31], L_rare2
    s_branch L_back_96
L_stub_97:
    s_call_b64 s[30:31], L_rare0
    s_branch L_back_98
L_stub_99:
    s_call_b64 s[30:31], L_rare1
    s_branch L_back_100
L_stub_101:
    s_call_b64 s[30:31], L_rare2
    s_branch L_back_102
L_stub_103:
    s_call_b64 s[30:31], L_rare0
    s_branch L_back_104
L_stub_105:
    s_call_b64 s[30:31], L_rare1
    s_branch L_back_106
L_stub_107:
    s_call_b64 s[30:31], L_rare2
    s_branch L_back_108
L_stub_109:
    s_call_b64 s[30:31], L_rare0
    s_branch L_back_110
L_stub_111:
    s_call_b64 s[30:31], L_rare1
    s_branch L_back_112
L_stub_113:
    s_call_b64 s[30:31], L_rare2
    s_branch L_back_114
L_stub_115:
    s_call_b64 s[30:31], L_rare0
    s_branch L_back_116
L_stub_117:
    s_call_b64 s[30:31], L_rare1
    s_branch L_back_118
L_stub_119:
    s_call_b64 s[30:31], L_rare2
    s_branch L_back_120
L_stub_121:
    s_call_b64 s[30:31], L_rare0
    s_branch L_back_122
L_stub_123:
    s_call_b64 s[30:31], L_rare1
    s_branch L_back_124
L_stub_125:
    s_call_b64 s[30:31], L_rare2
    s_branch L_back_126
L_stub_127:
    s_call_b64 s[30:31], L_rare0
    s_branch L_back_128
L_stub_129:
    s_call_b64 s[30:31], L_rare1
    s_branch L_back_130
L_stub_131:
    s_call_b64 s[30:31], L_rare2
    s_branch L_back_132
L_stub_133:
    s_call_b64 s[30:31], L_rare0
    s_branch L_back_134
L_stub_135:
    s_call_b64 s[30:31], L_rare1
    s_branch L_back_136
L_stub_137:
    s_call_b64 s[30:31], L_rare2
    s_branch L_back_138
L_stub_139:
    s_call_b64 s[30:31], L_rare0
    s_branch L_back_140
L_stub_141:
    s_call_b64 s[30:31], L_rare1
    s_branch L_back_142
L_stub_143:
    s_call_b64 s[30:31], L_rare2
    s_branch L_back_144
L_stub_145:
    s_call_b64 s[30:31], L_rare0
    s_branch L_back_146
L_stub_147:
    s_call_b64 s[30:31], L_rare1
    s_branch L_back_148
L_stub_149:
    s_call_b64 s[30:31], L_rare2
    s_branch L_back_150
L_stub_151:
    s_call_b64 s[30:31], L_rare0
    s_branch L_back_152
L_stub_153:
    s_call_b64 s[30:31], L_rare1
    s_branch L_back_154
L_stub_155:
    s_call_b64 s[30:31], L_rare2
    s_branch L_back_156
L_stub_157:
    s_call_b64 s[30:31], L_rare0
    s_branch L_back_158
L_stub_159:
    s_call_b64 s[30:31], L_rare1
    s_branch L_back_160
L_stub_161:
    s_call_b64 s[30:31], L_rare2
    s_branch L_back_162
L_stub_163:
    s_call_b64 s[30:31], L_rare0
    s_branch L_back_164
L_stub_165:
    s_call_b64 s[30:31], L_rare1
    s_branch L_back_166
L_stub_167:
    s_call_b64 s[30:31], L_rare2
    s_branch L_back_168
L_stub_169:
    s_call_b64 s[30:31], L_rare0
    s_branch L_back_170
L_stub_171:
    s_call_b64 s[30:31], L_rare1
    s_branch L_back_172
L_stub_173:
    s_call_b64 s[30:31], L_rare2
    s_branch L_back_174
L_stub_175:
    s_call_b64 s[30:31], L_rare0
    s_branch L_back_176
L_stub_177:
    s_call_b64 s[30:31], L_rare1
    s_branch L_back_178
L_stub_179:
    s_call_b64 s[30:31], L_rare2
    s_branch L_back_180
L_stub_181:
    s_call_b64 s[30:31], L_rare0
    s_branch L_back_182
L_stub_183:
    s_call_b64 s[30:31], L_rare1
    s_branch L_back_184
L_stub_185:
    s_call_b64 s[30:31], L_rare2
    s_branch L_back_186
L_rare0:
    v_max3_f32 v12, v160, v161, v162
    v_max3_f32 v13, v163, v164, v165
    v_max3_f32 v12, v12, v166, v167
    v_max_f32 v12, v12, v13
    v_mov_b32 v13, v12
    s_nop 1
    v_permlane32_swap_b32 v12, v13
    v_max_f32 v12, v12, v13
    v_mov_b32 v13, v12
    s_nop 1
    v_permlane16_swap_b32 v12, v13
    v_max_f32 v12, v12, v13
    v_max_f32 v12, 0, v12
    v_exp_f32_e64 v13, -v12
    v_sub_f32 v196, v196, v12
    v_sub_f32 v197, v197, v12
    v_sub_f32 v198, v198, v12
    v_sub_f32 v199, v199, v12
    v_mul_f32 v220, v220, v13
    v_mul_f32 v16, v16, v13
    v_mul_f32 v17, v17, v13
    v_mul_f32 v18, v18, v13
    v_mul_f32 v19, v19, v13
    v_mul_f32 v20, v20, v13
    v_mul_f32 v21, v21, v13
    v_mul_f32 v22, v22, v13
    v_mul_f32 v23, v23, v13
    v_mul_f32 v24, v24, v13
    v_mul_f32 v25, v25, v13
    v_mul_f32 v26, v26, v13
    v_mul_f32 v27, v27, v13
    v_mul_f32 v28, v28, v13
    v_mul_f32 v29, v29, v13
    v_mul_f32 v30, v30, v13
    v_mul_f32 v31, v31, v13
    v_mul_f32 v32, v32, v13
    v_mul_f32 v33, v33, v13
    v_mul_f32 v34, v34, v13
    v_mul_f32 v35, v35, v13
    v_mul_f32 v36, v36, v13
    v_mul_f32 v37, v37, v13
    v_mul_f32 v38, v38, v13
    v_mul_f32 v39, v39, v13
    v_mul_f32 v40, v40, v13
    v_mul_f32 v41, v41, v13
    v_mul_f32 v42, v42, v13
    v_mul_f32 v43, v43, v13
    v_mul_f32 v44, v44, v13
    v_mul_f32 v45, v45, v13
    v_mul_f32 v46, v46, v13
    v_mul_f32 v47, v47, v13
    v_sub_f32 v160, v160, v12
    v_sub_f32 v161, v161, v12
    v_sub_f32 v162, v162, v12
    v_sub_f32 v163, v163, v12
    v_sub_f32 v164, v164, v12
    v_sub_f32 v165, v165, v12
    v_sub_f32 v166, v166, v12
    v_sub_f32 v167, v167, v12
    v_exp_f32 v4, v160
    v_exp_f32 v5, v161
    v_exp_f32 v6, v162
    v_exp_f32 v7, v163
    v_exp_f32 v8, v164
    v_exp_f32 v9, v165
    v_exp_f32 v10, v166
    v_exp_f32 v11, v167
    v_add_f32 v232, v4, v5
    v_cvt_pk_bf16_f32 v184, v4, v5
    v_add_f32 v13, v6, v7
    v_cvt_pk_bf16_f32 v185, v6, v7
    v_add_f32 v232, v232, v13
    v_add_f32 v14, v8, v9
    v_cvt_pk_bf16_f32 v186, v8, v9
    v_add_f32 v232, v232, v14
    v_add_f32 v15, v10, v11
    v_cvt_pk_bf16_f32 v187, v10, v11
    v_add_f32 v232, v232, v15
    s_setpc_b64 s[30:31]
L_rare1:
    v_max3_f32 v12, v168, v169, v170
    v_max3_f32 v13, v171, v172, v173
    v_max3_f32 v12, v12, v174, v175
    v_max_f32 v12, v12, v13
    v_mov_b32 v13, v12
    s_nop 1
    v_permlane32_swap_b32 v12, v13
    v_max_f32 v12, v12, v13
    v_mov_b32 v13, v12
    s_nop 1
    v_permlane16_swap_b32 v12, v13
    v_max_f32 v12, v12, v13
    v_max_f32 v12, 0, v12
    v_exp_f32_e64 v13, -v12
    v_sub_f32 v200, v200, v12
    v_sub_f32 v201, v201, v12
    v_sub_f32 v202, v202, v12
    v_sub_f32 v203, v203, v12
    v_mul_f32 v221, v221, v13
    v_mul_f32 v48, v48, v13
    v_mul_f32 v49, v49, v13
    v_mul_f32 v50, v50, v13
    v_mul_f32 v51, v51, v13
    v_mul_f32 v52, v52, v13
    v_mul_f32 v53, v53, v13
    v_mul_f32 v54, v54, v13
    v_mul_f32 v55, v55, v13
    v_mul_f32 v56, v56, v13
    v_mul_f32 v57, v57, v13
    v_mul_f32 v58, v58, v13
    v_mul_f32 v59, v59, v13
    v_mul_f32 v60, v60, v13
    v_mul_f32 v61, v61, v13
    v_mul_f32 v62, v62, v13
    v_mul_f32 v63, v63, v13
    v_mul_f32 v64, v64, v13
    v_mul_f32 v65, v65, v13
    v_mul_f32 v66, v66, v13
    v_mul_f32 v67, v67, v13
    v_mul_f32 v68, v68, v13
    v_mul_f32 v69, v69, v13
    v_mul_f32 v70, v70, v13
    v_mul_f32 v71, v71, v13
    v_mul_f32 v72, v72, v13
    v_mul_f32 v73, v73, v13
    v_mul_f32 v74, v74, v13
    v_mul_f32 v75, v75, v13
    v_mul_f32 v76, v76, v13
    v_mul_f32 v77, v77, v13
    v_mul_f32 v78, v78, v13
    v_mul_f32 v79, v79, v13
    v_sub_f32 v168, v168, v12
    v_sub_f32 v169, v169, v12
    v_sub_f32 v170, v170, v12
    v_sub_f32 v171, v171, v12
    v_sub_f32 v172, v172, v12
    v_sub_f32 v173, v173, v12
    v_sub_f32 v174, v174, v12
    v_sub_f32 v175, v175, v12
    v_exp_f32 v4, v168
    v_exp_f32 v5, v169
    v_exp_f32 v6, v170
    v_exp_f32 v7, v171
    v_exp_f32 v8, v172
    v_exp_f32 v9, v173
    v_exp_f32 v10, v174
    v_exp_f32 v11, v175
    v_add_f32 v233, v4, v5
    v_cvt_pk_bf16_f32 v188, v4, v5
    v_add_f32 v13, v6, v7
    v_cvt_pk_bf16_f32 v189, v6, v7
    v_add_f32 v233, v233, v13
    v_add_f32 v14, v8, v9
    v_cvt_pk_bf16_f32 v190, v8, v9
    v_add_f32 v233, v233, v14
    v_add_f32 v15, v10, v11
    v_cvt_pk_bf16_f32 v191, v10, v11
    v_add_f32 v233, v233, v15
    s_setpc_b64 s[30:31]
L_rare2:
    v_max3_f32 v12, v176, v177, v178
    v_max3_f32 v13, v179, v180, v181
    v_max3_f32 v12, v12, v182, v183
    v_max_f32 v12, v12, v13
    v_mov_b32 v13, v12
    s_nop 1
    v_permlane32_swap_b32 v12, v13
    v_max_f32 v12, v12, v13
    v_mov_b32 v13, v12
    s_nop 1
    v_permlane16_swap_b32 v12, v13
    v_max_f32 v12, v12, v13
    v_max_f32 v12, 0, v12
    v_exp_f32_e64 v13, -v12
    v_sub_f32 v204, v204, v12
    v_sub_f32 v205, v205, v12
    v_sub_f32 v206, v206, v12
    v_sub_f32 v207, v207, v12
    v_mul_f32 v222, v222, v13
    v_mul_f32 v80, v80, v13
    v_mul_f32 v81, v81, v13
    v_mul_f32 v82, v82, v13
    v_mul_f32 v83, v83, v13
    v_mul_f32 v84, v84, v13
    v_mul_f32 v85, v85, v13
    v_mul_f32 v86, v86, v13
    v_mul_f32 v87, v87, v13
    v_mul_f32 v88, v88, v13
    v_mul_f32 v89, v89, v13
    v_mul_f32 v90, v90, v13
    v_mul_f32 v91, v91, v13
    v_mul_f32 v92, v92, v13
    v_mul_f32 v93, v93, v13
    v_mul_f32 v94, v94, v13
    v_mul_f32 v95, v95, v13
    v_mul_f32 v96, v96, v13
    v_mul_f32 v97, v97, v13
    v_mul_f32 v98, v98, v13
    v_mul_f32 v99, v99, v13
    v_mul_f32 v100, v100, v13
    v_mul_f32 v101, v101, v13
    v_mul_f32 v102, v102, v13
    v_mul_f32 v103, v103, v13
    v_mul_f32 v104, v104, v13
    v_mul_f32 v105, v105, v13
    v_mul_f32 v106, v106, v13
    v_mul_f32 v107, v107, v13
    v_mul_f32 v108, v108, v13
    v_mul_f32 v109, v109, v13
    v_mul_f32 v110, v110, v13
    v_mul_f32 v111, v111, v13
    v_sub_f32 v176, v176, v12
    v_sub_f32 v177, v177, v12
    v_sub_f32 v178, v178, v12
    v_sub_f32 v179, v179, v12
    v_sub_f32 v180, v180, v12
    v_sub_f32 v181, v181, v12
    v_sub_f32 v182, v182, v12
    v_sub_f32 v183, v183, v12
    v_exp_f32 v4, v176
    v_exp_f32 v5, v177
    v_exp_f32 v6, v178
    v_exp_f32 v7, v179
    v_exp_f32 v8, v180
    v_exp_f32 v9, v181
    v_exp_f32 v10, v182
    v_exp_f32 v11, v183
    v_add_f32 v234, v4, v5
    v_cvt_pk_bf16_f32 v192, v4, v5
    v_add_f32 v13, v6, v7
    v_cvt_pk_bf16_f32 v193, v6, v7
    v_add_f32 v234, v234, v13
    v_add_f32 v14, v8, v9
    v_cvt_pk_bf16_f32 v194, v8, v9
    v_add_f32 v234, v234, v14
    v_add_f32 v15, v10, v11
    v_cvt_pk_bf16_f32 v195, v10, v11
    v_add_f32 v234, v234, v15
    s_setpc_b64 s[30:31]
L_code_end:
.section .rodata,"a"
.p2align 6
.amdhsa_kernel standalone__mha_block_cached__near_ridge_kernel
  .amdhsa_next_free_vgpr 512
  .amdhsa_next_free_sgpr 102
  .amdhsa_accum_offset 256
  .amdhsa_group_segment_fixed_size 0
  .amdhsa_kernarg_size 64
  .amdhsa_user_sgpr_count 2
  .amdhsa_user_sgpr_kernarg_segment_ptr 1
  .amdhsa_system_sgpr_workgroup_id_x 1
.end_amdhsa_kernel
```
